```python
import torch

def _softmax(x, axis=-1):
    return torch.softmax(x, dim=axis)
def _gelu(x):
    return torch.nn.functional.gelu(x, approximate="tanh")
def _silu(x):
    return torch.nn.functional.silu(x)
def _sigmoid(x):
    return torch.sigmoid(x)
def _layernorm(x, axis=-1, eps=1e-5):
    m = x.mean(dim=axis, keepdim=True)
    v = x.var(dim=axis, keepdim=True, unbiased=False)
    return (x - m) / torch.sqrt(v + eps)
def _scatter_add(tgt, idx, src, axis=0):
    return tgt.clone().index_add_(axis, idx, src)
def _segment_sum(src, seg, n):
    out = torch.zeros((n,) + src.shape[1:], dtype=src.dtype)
    return out.index_add_(0, seg, src)
def _pad(x, pw):
    flat = tuple(v for pair in reversed(pw) for v in pair)
    return torch.nn.functional.pad(x, flat)

kernel_name = 'concat_heads__gqa_block_cached__mha_block_cached__near_ridge'

def setup_inputs():

    _w = (lambda a: (lambda t: t.to(torch.bfloat16) if t.is_floating_point() else t)(torch.as_tensor(a)))
    def _A_setup():
        B, Sq, D = 8, 112, 448
        Hq, Hkv, Sk, Dh = 16, 8, 512, 256
        assert Hq % Hkv == 0, (Hq, Hkv)
        return {
            "x": _w((lambda *s: torch.randn(*s, dtype=torch.bfloat16) * 0.8)(B, Sq, D)),
            "k_cache": _w((lambda *s: torch.randn(*s, dtype=torch.bfloat16) * 0.8)(B, Hkv, Sk, Dh)),
            "v_cache": _w((lambda *s: torch.randn(*s, dtype=torch.bfloat16) * 0.05)(B, Hkv, Sk, Dh)),
            "wq": _w((lambda *s: torch.randn(*s, dtype=torch.bfloat16) * 0.8)(D, Hq * Dh) * (D ** -0.5)),
            "wo": _w((lambda *s: torch.randn(*s, dtype=torch.bfloat16) * 0.05)(Hq * Dh, D) * ((Hq * Dh) ** -0.5)),
        }
    _A_in = _A_setup()

    def _B_setup():
        B, Sq, D = 8, 112, 448
        H, Sk, Dh = 16, 512, 256
        return {
            "x": _w((lambda *s: torch.randn(*s, dtype=torch.bfloat16) * 0.8)(B, Sq, D)),
            "k_cache": _w((lambda *s: torch.randn(*s, dtype=torch.bfloat16) * 0.8)(B, H, Sk, Dh)),
            "v_cache": _w((lambda *s: torch.randn(*s, dtype=torch.bfloat16) * 0.05)(B, H, Sk, Dh)),
            "wq": _w((lambda *s: torch.randn(*s, dtype=torch.bfloat16) * 0.8)(D, H * Dh) * (D ** -0.5)),
            "wo": _w((lambda *s: torch.randn(*s, dtype=torch.bfloat16) * 0.05)(H * Dh, D) * ((H * Dh) ** -0.5)),
        }
    _B_in = _B_setup()

    return {
        "A_x": _A_in["x"],
        "A_k_cache": _A_in["k_cache"],
        "A_v_cache": _A_in["v_cache"],
        "A_wq": _A_in["wq"],
        "A_wo": _A_in["wo"],
        "B_x": _B_in["x"],
        "B_k_cache": _B_in["k_cache"],
        "B_v_cache": _B_in["v_cache"],
        "B_wq": _B_in["wq"],
        "B_wo": _B_in["wo"],
    }

def reference(A_x, A_k_cache, A_v_cache, A_wq, A_wo, B_x, B_k_cache, B_v_cache, B_wq, B_wo):
    def _A_ref(x, k_cache, v_cache, wq, wo):
        B, Sq, D = x.shape
        Hq, Dh = 16, 256
        Hkv = k_cache.shape[1]
        rep = Hq // Hkv
        q = (lambda x, *d: x.permute(*d))((x @ wq).reshape(B, Sq, Hq, Dh), 0, 2, 1, 3)
        k = (lambda x, n, axis: torch.repeat_interleave(x, n, dim=axis))(k_cache, rep, axis=1)
        v = (lambda x, n, axis: torch.repeat_interleave(x, n, dim=axis))(v_cache, rep, axis=1)
        scores = torch.einsum("bhqd,bhkd->bhqk", q, k) * (Dh ** -0.5)
        p = _softmax(scores, axis=-1)
        o = torch.einsum("bhqk,bhkd->bhqd", p, v)
        return (lambda x, *d: x.permute(*d))(o, 0, 2, 1, 3).reshape(B, Sq, Hq * Dh) @ wo

    def _B_ref(x, k_cache, v_cache, wq, wo):
        B, Sq, D = x.shape
        H, Dh = 16, 256
        q = (lambda x, *d: x.permute(*d))((x @ wq).reshape(B, Sq, H, Dh), 0, 2, 1, 3)
        scores = torch.einsum("bhqd,bhkd->bhqk", q, k_cache) * (Dh ** -0.5)
        p = _softmax(scores, axis=-1)
        o = torch.einsum("bhqk,bhkd->bhqd", p, v_cache)
        return (lambda x, *d: x.permute(*d))(o, 0, 2, 1, 3).reshape(B, Sq, H * Dh) @ wo

    a = _A_ref(A_x, A_k_cache, A_v_cache, A_wq, A_wo)
    b = _B_ref(B_x, B_k_cache, B_v_cache, B_wq, B_wo)
    return torch.concatenate([a, b], axis=-1)
```

```asm
; @launch grid=(256,1,1) block=(256,1,1) lds=163840
.amdgcn_target "amdgcn-amd-amdhsa--gfx950"
.text
.globl concat_heads__gqa_block_cached__mha_block_cached__near_ridge_kernel
.p2align 8
.type concat_heads__gqa_block_cached__mha_block_cached__near_ridge_kernel,@function
concat_heads__gqa_block_cached__mha_block_cached__near_ridge_kernel:
    s_cmp_ge_u32 s2, 256
    s_cbranch_scc1 L_exit
    s_lshr_b32 s5, s2, 3
    s_lshr_b32 s7, s5, 1
    s_and_b32 s7, s7, 1
    s_mul_i32 s3, s7, 40
    s_load_dwordx2 s[14:15], s[0:1], 96
    s_add_u32 s0, s0, s3
    s_addc_u32 s1, s1, 0
    s_load_dwordx4 s[8:11], s[0:1], 0
    s_load_dwordx4 s[52:55], s[0:1], 16
    s_load_dwordx2 s[96:97], s[0:1], 32
    v_lshrrev_b32 v1, 6, v0
    v_and_b32 v10, 63, v0
    s_and_b32 s4, s2, 7
    s_and_b32 s6, s5, 1
    v_readfirstlane_b32 s66, v1
    s_lshr_b32 s5, s5, 2
    s_lshl_b32 s3, s4, 1
    s_add_u32 s6, s3, s6
    v_lshlrev_b32 v0, 4, v10
    v_lshrrev_b32 v16, 3, v10
    v_and_b32 v17, 7, v10
    v_and_b32 v18, 6, v16
    v_xor_b32 v17, v17, v18
    v_lshlrev_b32 v17, 4, v17
    s_movk_i32 s3, 896
    v_mad_u32_u24 v9, v16, s3, v17
    s_and_b32 s3, s66, 1
    s_mul_i32 s3, s3, 50176
    v_add_u32 v8, s3, v9
    s_mul_i32 s13, s5, 7
    s_lshr_b32 s13, s13, 3
    s_and_b32 s3, s6, 1
    s_mul_i32 s3, s3, 3
    s_add_u32 s13, s13, s3
    s_add_u32 s13, s13, s4
    s_cmp_ge_u32 s13, 14
    s_cselect_b32 s3, 14, 0
    s_sub_u32 s13, s13, s3
    s_cmp_ge_u32 s13, 7
    s_cselect_b32 s3, 7, 0
    s_sub_u32 s13, s13, s3
    s_lshl_b32 s92, s13, 19
    s_lshr_b32 s3, s66, 1
    s_add_u32 s12, s13, s3
    s_cmp_ge_u32 s12, 7
    s_cselect_b32 s3, 7, 0
    s_sub_u32 s12, s12, s3
    s_lshl_b32 s12, s12, 7
    s_add_u32 s99, s13, 6
    s_cmp_ge_u32 s99, 7
    s_cselect_b32 s3, 7, 0
    s_sub_u32 s99, s99, s3
    s_lshl_b32 s99, s99, 7
    s_mul_i32 s95, s66, 7168
    s_mul_i32 s3, s5, 100352
    s_lshl_b32 s19, s6, 9
    s_waitcnt lgkmcnt(0)
    s_add_u32 s20, s8, s3
    s_addc_u32 s21, s9, 0
    s_and_b32 s21, s21, 0xffff
    s_mov_b32 s22, 100352
    s_mov_b32 s23, 0x20000
    s_add_u32 m0, s95, 0
    s_nop 0
    buffer_load_dwordx4 v8, s[20:23], s12 offen lds
    s_add_u32 m0, s95, 1024
    s_add_u32 s100, s12, 7168
    buffer_load_dwordx4 v8, s[20:23], s100 offen lds
    s_add_u32 m0, s95, 2048
    s_add_u32 s100, s12, 14336
    buffer_load_dwordx4 v8, s[20:23], s100 offen lds
    s_add_u32 m0, s95, 3072
    s_add_u32 s100, s12, 21504
    buffer_load_dwordx4 v8, s[20:23], s100 offen lds
    s_add_u32 m0, s95, 4096
    s_add_u32 s100, s12, 28672
    buffer_load_dwordx4 v8, s[20:23], s100 offen lds
    s_add_u32 m0, s95, 5120
    s_add_u32 s100, s12, 35840
    buffer_load_dwordx4 v8, s[20:23], s100 offen lds
    s_add_u32 m0, s95, 6144
    s_add_u32 s100, s12, 43008
    buffer_load_dwordx4 v8, s[20:23], s100 offen lds
    s_add_u32 s40, s54, s19
    s_addc_u32 s41, s55, 0
    s_and_b32 s41, s41, 0xffff
    s_sub_u32 s42, 3670016, s19
    s_mov_b32 s43, 0x20000
    s_add_u32 s44, s40, 130048
    s_addc_u32 s45, s41, 0
    s_sub_u32 s46, s42, 130048
    s_mov_b32 s47, 0x20000
    s_mov_b32 s16, s52
    s_mov_b32 s17, s53
    v_lshrrev_b32 v20, 2, v10
    v_and_b32 v21, 3, v10
    v_lshrrev_b32 v22, 5, v10
    v_bfe_u32 v23, v10, 4, 1
    v_and_b32 v24, 3, v20
    v_lshl_add_u32 v24, v23, 3, v24
    v_lshlrev_b32 v24, 13, v24
    v_xor_b32 v25, v21, v23
    v_lshlrev_b32 v25, 4, v25
    v_lshl_add_u32 v26, v22, 6, v25
    s_lshl_b32 s3, s66, 7
    v_add3_u32 v5, v24, v26, s3
    s_lshl_b32 s3, s66, 11
    s_add_u32 s52, s3, 100352
    s_movk_i32 s100, 0x2000
    s_add_u32 s53, s52, s100
    s_add_u32 s54, s53, s100
    s_add_u32 s55, s54, s100
    s_add_u32 s56, s55, s100
    s_add_u32 s57, s56, s100
    s_add_u32 s58, s57, s100
    s_mov_b32 s93, 32768
    s_mov_b32 s94, 229376
    s_mov_b32 m0, s52
    s_nop 0
    buffer_load_dwordx4 v5, s[40:43], s92 offen lds
    buffer_load_dwordx4 v5, s[44:47], s92 offen offset:1024 lds
    s_mov_b32 m0, s53
    s_add_u32 s92, s92, s93
    buffer_load_dwordx4 v5, s[40:43], s92 offen lds
    buffer_load_dwordx4 v5, s[44:47], s92 offen offset:1024 lds
    s_mov_b32 m0, s54
    s_add_u32 s92, s92, s94
    buffer_load_dwordx4 v5, s[40:43], s92 offen lds
    buffer_load_dwordx4 v5, s[44:47], s92 offen offset:1024 lds
    s_mov_b32 m0, s55
    s_add_u32 s92, s92, s93
    buffer_load_dwordx4 v5, s[40:43], s92 offen lds
    buffer_load_dwordx4 v5, s[44:47], s92 offen offset:1024 lds
    s_add_u32 m0, s95, 28672
    s_addk_i32 s12, 256
    s_cmp_ge_u32 s12, 896
    s_cselect_b32 s13, 896, 0
    s_sub_u32 s12, s12, s13
    buffer_load_dwordx4 v8, s[20:23], s12 offen lds
    s_lshl_b32 s67, s66, 8
    s_add_u32 s67, s67, 161792
    s_and_b32 s3, s66, 1
    s_mul_i32 s98, s3, 7168
    s_add_u32 s98, s98, 86016
    s_lshr_b32 s3, s66, 1
    s_mul_i32 s3, s3, 3
    s_mul_i32 s13, s3, 7168
    s_add_u32 s99, s99, s13
    s_lshl_b32 s3, s3, 10
    s_add_u32 s98, s98, s3
    s_lshr_b32 s3, s6, 1
    s_cmp_eq_u32 s7, 0
    s_cselect_b32 s3, s3, s6
    s_cselect_b32 s4, 8, 16
    s_mul_i32 s4, s4, s5
    s_add_u32 s4, s4, s3
    s_lshl_b32 s4, s4, 18
    s_add_u32 s24, s10, s4
    s_addc_u32 s25, s11, 0
    s_and_b32 s25, s25, 0xffff
    s_mov_b32 s26, 262144
    s_mov_b32 s27, 0x20000
    s_add_u32 s28, s24, 3072
    s_addc_u32 s29, s25, 0
    s_mov_b32 s30, 259072
    s_mov_b32 s31, 0x20000
    v_lshl_add_u32 v3, v16, 9, v17
    s_lshl_b32 s3, s66, 16
    v_add_u32 v3, s3, v3
    s_lshl_b32 s3, s66, 11
    s_mov_b32 s59, s3
    s_movk_i32 s100, 0x2000
    s_add_u32 s60, s59, s100
    s_add_u32 s61, s60, s100
    s_add_u32 s62, s61, s100
    s_add_u32 s63, s62, s100
    s_add_u32 s64, s63, s100
    s_add_u32 s65, s64, s100
    v_lshrrev_b32 v28, 4, v10
    v_and_b32 v29, 6, v10
    v_xor_b32 v28, v28, v29
    v_lshlrev_b32 v28, 4, v28
    v_and_b32 v29, 7, v10
    v_lshl_add_u32 v28, v29, 7, v28
    v_bfe_u32 v29, v10, 3, 1
    v_lshl_add_u32 v1, v29, 10, v28
    v_add_u32 v2, 0x10000, v1
    v_xor_b32 v11, 64, v1
    v_xor_b32 v12, 64, v2
    v_add_u32 v4, s52, v1
    v_xor_b32 v15, 64, v4
    v_add_u32 v156, s3, v1
    v_xor_b32 v158, 64, v156
    v_and_b32 v28, 7, v20
    v_lshlrev_b32 v28, 6, v28
    v_lshl_add_u32 v28, v22, 10, v28
    v_add_u32 v28, v28, v25
    v_and_b32 v29, 1, v21
    v_lshl_add_u32 v28, v29, 3, v28
    v_add_u32 v6, s52, v28
    v_xor_b32 v7, 8, v6
    v_add_u32 v159, s3, v28
    v_xor_b32 v160, 8, v159
    s_add_u32 s32, s16, s4
    s_addc_u32 s33, s17, 0
    s_and_b32 s33, s33, 0xffff
    s_mov_b32 s34, 262144
    s_mov_b32 s35, 0x20000
    s_add_u32 s36, s32, 3072
    s_addc_u32 s37, s33, 0
    s_mov_b32 s38, 259072
    s_mov_b32 s39, 0x20000
    s_lshl_b32 s3, s7, 3
    s_add_u32 s3, s3, s5
    s_mul_i32 s3, s3, 1605632
    s_add_u32 s48, s14, s3
    s_addc_u32 s49, s15, 0
    s_and_b32 s49, s49, 0xffff
    s_mov_b32 s50, 1605632
    s_mov_b32 s51, 0x20000
    s_mul_i32 s18, s6, 100352
    s_mul_i32 s3, s66, 28672
    s_add_u32 s18, s18, s3
    s_mov_b32 s68, 0x3db8aa3b
    s_mov_b32 s69, 0x3db8aa3b
    s_waitcnt vmcnt(7)
    ds_read_b64_tr_b16 a[0:1], v6 offset:0
    ds_read_b64_tr_b16 a[4:5], v7 offset:0
    ds_read_b64_tr_b16 a[8:9], v6 offset:512
    ds_read_b64_tr_b16 a[12:13], v7 offset:512
    s_add_u32 m0, s95, 29696
    s_add_u32 s100, s12, 7168
    buffer_load_dwordx4 v8, s[20:23], s100 offen lds
    s_add_u32 m0, s95, 30720
    s_add_u32 s100, s12, 14336
    buffer_load_dwordx4 v8, s[20:23], s100 offen lds
    s_add_u32 m0, s95, 31744
    s_add_u32 s100, s12, 21504
    buffer_load_dwordx4 v8, s[20:23], s100 offen lds
    s_add_u32 m0, s95, 32768
    s_add_u32 s100, s12, 28672
    buffer_load_dwordx4 v8, s[20:23], s100 offen lds
    s_add_u32 m0, s95, 33792
    s_add_u32 s100, s12, 35840
    buffer_load_dwordx4 v8, s[20:23], s100 offen lds
    s_add_u32 m0, s95, 34816
    s_add_u32 s100, s12, 43008
    buffer_load_dwordx4 v8, s[20:23], s100 offen lds
    s_mov_b32 m0, s56
    s_add_u32 s92, s92, s94
    s_cmp_ge_u32 s92, 3670016
    s_cselect_b32 s13, 3670016, 0
    s_sub_u32 s92, s92, s13
    buffer_load_dwordx4 v5, s[40:43], s92 offen lds
    buffer_load_dwordx4 v5, s[44:47], s92 offen offset:1024 lds
    s_waitcnt vmcnt(13)
    ds_read_b64_tr_b16 a[2:3], v6 offset:8192
    ds_read_b64_tr_b16 a[6:7], v7 offset:8192
    ds_read_b64_tr_b16 a[10:11], v6 offset:8704
    ds_read_b64_tr_b16 a[14:15], v7 offset:8704
    s_barrier
    ds_read_b128 v[128:131], v1 offset:0
    ds_read_b128 v[132:135], v1 offset:2048
    ds_read_b128 v[136:139], v1 offset:4096
    ds_read_b128 v[140:143], v1 offset:6144
    ds_read_b128 v[144:147], v1 offset:8192
    ds_read_b128 v[148:151], v1 offset:10240
    ds_read_b128 v[152:155], v1 offset:12288
    s_waitcnt lgkmcnt(7)
    s_waitcnt lgkmcnt(6)
    v_mfma_f32_16x16x32_bf16 v[16:19], a[0:3], v[128:131], 0
    s_mov_b32 m0, s52
    s_add_u32 s92, s92, s93
    buffer_load_dwordx4 v5, s[40:43], s92 offen lds
    v_mfma_f32_16x16x32_bf16 v[20:23], a[4:7], v[128:131], 0
    buffer_load_dwordx4 v5, s[44:47], s92 offen offset:1024 lds
    v_mfma_f32_16x16x32_bf16 v[24:27], a[8:11], v[128:131], 0
    v_mfma_f32_16x16x32_bf16 v[28:31], a[12:15], v[128:131], 0
    ds_read_b128 v[128:131], v11 offset:0
    s_waitcnt lgkmcnt(6)
    v_mfma_f32_16x16x32_bf16 v[32:35], a[0:3], v[132:135], 0
    s_waitcnt vmcnt(13)
    ds_read_b64_tr_b16 a[16:17], v6 offset:16384
    s_mov_b32 m0, s53
    v_mfma_f32_16x16x32_bf16 v[36:39], a[4:7], v[132:135], 0
    s_add_u32 s92, s92, s94
    buffer_load_dwordx4 v5, s[40:43], s92 offen lds
    v_mfma_f32_16x16x32_bf16 v[40:43], a[8:11], v[132:135], 0
    buffer_load_dwordx4 v5, s[44:47], s92 offen offset:1024 lds
    s_add_u32 m0, s95, 57344
    v_mfma_f32_16x16x32_bf16 v[44:47], a[12:15], v[132:135], 0
    ds_read_b128 v[132:135], v11 offset:2048
    s_addk_i32 s12, 256
    s_cmp_ge_u32 s12, 896
    s_cselect_b32 s13, 896, 0
    s_sub_u32 s12, s12, s13
    s_waitcnt lgkmcnt(7)
    v_mfma_f32_16x16x32_bf16 v[48:51], a[0:3], v[136:139], 0
    buffer_load_dwordx4 v8, s[20:23], s12 offen lds
    v_mfma_f32_16x16x32_bf16 v[52:55], a[4:7], v[136:139], 0
    ds_read_b64_tr_b16 a[20:21], v7 offset:16384
    v_mfma_f32_16x16x32_bf16 v[56:59], a[8:11], v[136:139], 0
    ds_read_b64_tr_b16 a[24:25], v6 offset:16896
    v_mfma_f32_16x16x32_bf16 v[60:63], a[12:15], v[136:139], 0
    ds_read_b128 v[136:139], v11 offset:4096
    s_waitcnt lgkmcnt(6)
    v_mfma_f32_16x16x32_bf16 v[64:67], a[0:3], v[140:143], 0
    ds_read_b64_tr_b16 a[28:29], v7 offset:16896
    s_waitcnt vmcnt(14)
    s_add_u32 m0, s95, 58368
    v_mfma_f32_16x16x32_bf16 v[68:71], a[4:7], v[140:143], 0
    s_add_u32 s100, s12, 7168
    buffer_load_dwordx4 v8, s[20:23], s100 offen lds
    v_mfma_f32_16x16x32_bf16 v[72:75], a[8:11], v[140:143], 0
    ds_read_b64_tr_b16 a[18:19], v6 offset:24576
    s_add_u32 m0, s95, 59392
    v_mfma_f32_16x16x32_bf16 v[76:79], a[12:15], v[140:143], 0
    ds_read_b128 v[140:143], v11 offset:6144
    s_add_u32 s100, s12, 14336
    v_mfma_f32_16x16x32_bf16 v[80:83], a[0:3], v[144:147], 0
    buffer_load_dwordx4 v8, s[20:23], s100 offen lds
    s_waitcnt vmcnt(15)
    s_add_u32 m0, s95, 60416
    v_mfma_f32_16x16x32_bf16 v[84:87], a[4:7], v[144:147], 0
    s_add_u32 s100, s12, 21504
    buffer_load_dwordx4 v8, s[20:23], s100 offen lds
    v_mfma_f32_16x16x32_bf16 v[88:91], a[8:11], v[144:147], 0
    ds_read_b64_tr_b16 a[22:23], v7 offset:24576
    v_mfma_f32_16x16x32_bf16 v[92:95], a[12:15], v[144:147], 0
    ds_read_b128 v[144:147], v11 offset:8192
    v_mfma_f32_16x16x32_bf16 v[96:99], a[0:3], v[148:151], 0
    ds_read_b64_tr_b16 a[26:27], v6 offset:25088
    v_mfma_f32_16x16x32_bf16 v[100:103], a[4:7], v[148:151], 0
    ds_read_b64_tr_b16 a[30:31], v7 offset:25088
    v_mfma_f32_16x16x32_bf16 v[104:107], a[8:11], v[148:151], 0
    v_mfma_f32_16x16x32_bf16 v[108:111], a[12:15], v[148:151], 0
    ds_read_b128 v[148:151], v11 offset:10240
    v_mfma_f32_16x16x32_bf16 v[112:115], a[0:3], v[152:155], 0
    v_mfma_f32_16x16x32_bf16 v[116:119], a[4:7], v[152:155], 0
    v_mfma_f32_16x16x32_bf16 v[120:123], a[8:11], v[152:155], 0
    v_mfma_f32_16x16x32_bf16 v[124:127], a[12:15], v[152:155], 0
    ds_read_b128 v[152:155], v11 offset:12288
    s_waitcnt lgkmcnt(2)
    v_mfma_f32_16x16x32_bf16 v[16:19], a[16:19], v[128:131], v[16:19]
    v_mfma_f32_16x16x32_bf16 v[20:23], a[20:23], v[128:131], v[20:23]
    v_mfma_f32_16x16x32_bf16 v[24:27], a[24:27], v[128:131], v[24:27]
    v_mfma_f32_16x16x32_bf16 v[28:31], a[28:31], v[128:131], v[28:31]
    ds_read_b128 v[128:131], v1 offset:14336
    v_mfma_f32_16x16x32_bf16 v[32:35], a[16:19], v[132:135], v[32:35]
    v_mfma_f32_16x16x32_bf16 v[36:39], a[20:23], v[132:135], v[36:39]
    v_mfma_f32_16x16x32_bf16 v[40:43], a[24:27], v[132:135], v[40:43]
    v_mfma_f32_16x16x32_bf16 v[44:47], a[28:31], v[132:135], v[44:47]
    ds_read_b128 v[132:135], v1 offset:16384
    v_mfma_f32_16x16x32_bf16 v[48:51], a[16:19], v[136:139], v[48:51]
    v_mfma_f32_16x16x32_bf16 v[52:55], a[20:23], v[136:139], v[52:55]
    v_mfma_f32_16x16x32_bf16 v[56:59], a[24:27], v[136:139], v[56:59]
    v_mfma_f32_16x16x32_bf16 v[60:63], a[28:31], v[136:139], v[60:63]
    ds_read_b128 v[136:139], v1 offset:18432
    v_mfma_f32_16x16x32_bf16 v[64:67], a[16:19], v[140:143], v[64:67]
    s_waitcnt vmcnt(8)
    ds_read_b64_tr_b16 a[0:1], v6 offset:32768
    s_add_u32 m0, s95, 61440
    v_mfma_f32_16x16x32_bf16 v[68:71], a[20:23], v[140:143], v[68:71]
    s_add_u32 s100, s12, 28672
    buffer_load_dwordx4 v8, s[20:23], s100 offen lds
    v_mfma_f32_16x16x32_bf16 v[72:75], a[24:27], v[140:143], v[72:75]
    ds_read_b64_tr_b16 a[4:5], v7 offset:32768
    s_add_u32 m0, s95, 62464
    v_mfma_f32_16x16x32_bf16 v[76:79], a[28:31], v[140:143], v[76:79]
    ds_read_b128 v[140:143], v1 offset:20480
    s_add_u32 s100, s12, 35840
    v_mfma_f32_16x16x32_bf16 v[80:83], a[16:19], v[144:147], v[80:83]
    buffer_load_dwordx4 v8, s[20:23], s100 offen lds
    s_add_u32 m0, s95, 63488
    v_mfma_f32_16x16x32_bf16 v[84:87], a[20:23], v[144:147], v[84:87]
    s_add_u32 s100, s12, 43008
    buffer_load_dwordx4 v8, s[20:23], s100 offen lds
    v_mfma_f32_16x16x32_bf16 v[88:91], a[24:27], v[144:147], v[88:91]
    ds_read_b64_tr_b16 a[8:9], v6 offset:33280
    s_add_u32 m0, s98, 0
    s_add_u32 s100, s99, 0
    v_mfma_f32_16x16x32_bf16 v[92:95], a[28:31], v[144:147], v[92:95]
    ds_read_b128 v[144:147], v1 offset:22528
    s_waitcnt lgkmcnt(5)
    v_mfma_f32_16x16x32_bf16 v[96:99], a[16:19], v[148:151], v[96:99]
    buffer_load_dwordx4 v8, s[20:23], s100 offen lds
    s_add_u32 m0, s98, 1024
    v_mfma_f32_16x16x32_bf16 v[100:103], a[20:23], v[148:151], v[100:103]
    s_add_u32 s100, s99, 7168
    buffer_load_dwordx4 v8, s[20:23], s100 offen lds
    v_mfma_f32_16x16x32_bf16 v[104:107], a[24:27], v[148:151], v[104:107]
    ds_read_b64_tr_b16 a[12:13], v7 offset:33280
    s_add_u32 m0, s98, 2048
    v_mfma_f32_16x16x32_bf16 v[108:111], a[28:31], v[148:151], v[108:111]
    ds_read_b128 v[148:151], v1 offset:24576
    s_add_u32 s100, s99, 14336
    v_mfma_f32_16x16x32_bf16 v[112:115], a[16:19], v[152:155], v[112:115]
    buffer_load_dwordx4 v8, s[20:23], s100 offen lds
    s_add_u32 m0, s98, 3072
    v_mfma_f32_16x16x32_bf16 v[116:119], a[20:23], v[152:155], v[116:119]
    s_add_u32 s100, s99, 21504
    buffer_load_dwordx4 v8, s[20:23], s100 offen lds
    v_mfma_f32_16x16x32_bf16 v[120:123], a[24:27], v[152:155], v[120:123]
    s_waitcnt vmcnt(13)
    ds_read_b64_tr_b16 a[2:3], v6 offset:0
    s_mov_b32 m0, s54
    v_mfma_f32_16x16x32_bf16 v[124:127], a[28:31], v[152:155], v[124:127]
    ds_read_b128 v[152:155], v1 offset:26624
    s_add_u32 s92, s92, s93
    buffer_load_dwordx4 v5, s[40:43], s92 offen lds
    buffer_load_dwordx4 v5, s[44:47], s92 offen offset:1024 lds
    ds_read_b64_tr_b16 a[6:7], v7 offset:0
    ds_read_b64_tr_b16 a[10:11], v6 offset:512
    ds_read_b64_tr_b16 a[14:15], v7 offset:512
    s_waitcnt lgkmcnt(0)
    v_mfma_f32_16x16x32_bf16 v[16:19], a[0:3], v[128:131], v[16:19]
    s_waitcnt vmcnt(13)
    ds_read_b64_tr_b16 a[16:17], v6 offset:8192
    s_mov_b32 m0, s52
    v_mfma_f32_16x16x32_bf16 v[20:23], a[4:7], v[128:131], v[20:23]
    s_add_u32 s92, s92, s94
    s_cmp_ge_u32 s92, 3670016
    s_cselect_b32 s13, 3670016, 0
    s_sub_u32 s92, s92, s13
    v_mfma_f32_16x16x32_bf16 v[24:27], a[8:11], v[128:131], v[24:27]
    buffer_load_dwordx4 v5, s[40:43], s92 offen lds
    v_mfma_f32_16x16x32_bf16 v[28:31], a[12:15], v[128:131], v[28:31]
    ds_read_b128 v[128:131], v11 offset:14336
    v_mfma_f32_16x16x32_bf16 v[32:35], a[0:3], v[132:135], v[32:35]
    buffer_load_dwordx4 v5, s[44:47], s92 offen offset:1024 lds
    s_waitcnt vmcnt(13)
    s_mov_b32 m0, s55
    v_mfma_f32_16x16x32_bf16 v[36:39], a[4:7], v[132:135], v[36:39]
    s_add_u32 s92, s92, s93
    buffer_load_dwordx4 v5, s[40:43], s92 offen lds
    v_mfma_f32_16x16x32_bf16 v[40:43], a[8:11], v[132:135], v[40:43]
    buffer_load_dwordx4 v5, s[44:47], s92 offen offset:1024 lds
    s_waitcnt vmcnt(14)
    s_mov_b32 m0, s56
    v_mfma_f32_16x16x32_bf16 v[44:47], a[12:15], v[132:135], v[44:47]
    ds_read_b128 v[132:135], v11 offset:16384
    s_add_u32 s92, s92, s94
    v_mfma_f32_16x16x32_bf16 v[48:51], a[0:3], v[136:139], v[48:51]
    buffer_load_dwordx4 v5, s[40:43], s92 offen lds
    v_mfma_f32_16x16x32_bf16 v[52:55], a[4:7], v[136:139], v[52:55]
    buffer_load_dwordx4 v5, s[44:47], s92 offen offset:1024 lds
    s_waitcnt vmcnt(15)
    v_mfma_f32_16x16x32_bf16 v[56:59], a[8:11], v[136:139], v[56:59]
    ds_read_b64_tr_b16 a[20:21], v7 offset:8192
    v_mfma_f32_16x16x32_bf16 v[60:63], a[12:15], v[136:139], v[60:63]
    ds_read_b128 v[136:139], v11 offset:18432
    v_mfma_f32_16x16x32_bf16 v[64:67], a[0:3], v[140:143], v[64:67]
    ds_read_b64_tr_b16 a[24:25], v6 offset:8704
    v_mfma_f32_16x16x32_bf16 v[68:71], a[4:7], v[140:143], v[68:71]
    ds_read_b64_tr_b16 a[28:29], v7 offset:8704
    s_waitcnt vmcnt(6)
    s_mov_b32 m0, s57
    v_mfma_f32_16x16x32_bf16 v[72:75], a[8:11], v[140:143], v[72:75]
    s_add_u32 s92, s92, s93
    buffer_load_dwordx4 v5, s[40:43], s92 offen lds
    v_mfma_f32_16x16x32_bf16 v[76:79], a[12:15], v[140:143], v[76:79]
    ds_read_b128 v[140:143], v11 offset:20480
    v_mfma_f32_16x16x32_bf16 v[80:83], a[0:3], v[144:147], v[80:83]
    buffer_load_dwordx4 v5, s[44:47], s92 offen offset:1024 lds
    s_mov_b32 m0, s58
    s_add_u32 s92, s92, s94
    s_cmp_ge_u32 s92, 3670016
    s_cselect_b32 s13, 3670016, 0
    s_sub_u32 s92, s92, s13
    v_mfma_f32_16x16x32_bf16 v[84:87], a[4:7], v[144:147], v[84:87]
    buffer_load_dwordx4 v5, s[40:43], s92 offen lds
    v_mfma_f32_16x16x32_bf16 v[88:91], a[8:11], v[144:147], v[88:91]
    buffer_load_dwordx4 v5, s[44:47], s92 offen offset:1024 lds
    s_waitcnt lgkmcnt(1)
    s_mov_b32 m0, s53
    v_mfma_f32_16x16x32_bf16 v[92:95], a[12:15], v[144:147], v[92:95]
    ds_read_b128 v[144:147], v11 offset:22528
    s_add_u32 s92, s92, s93
    v_mfma_f32_16x16x32_bf16 v[96:99], a[0:3], v[148:151], v[96:99]
    buffer_load_dwordx4 v5, s[40:43], s92 offen lds
    v_mfma_f32_16x16x32_bf16 v[100:103], a[4:7], v[148:151], v[100:103]
    buffer_load_dwordx4 v5, s[44:47], s92 offen offset:1024 lds
    v_mfma_f32_16x16x32_bf16 v[104:107], a[8:11], v[148:151], v[104:107]
    ds_read_b64_tr_b16 a[18:19], v6 offset:16384
    v_mfma_f32_16x16x32_bf16 v[108:111], a[12:15], v[148:151], v[108:111]
    ds_read_b128 v[148:151], v11 offset:24576
    v_mfma_f32_16x16x32_bf16 v[112:115], a[0:3], v[152:155], v[112:115]
    ds_read_b64_tr_b16 a[22:23], v7 offset:16384
    v_mfma_f32_16x16x32_bf16 v[116:119], a[4:7], v[152:155], v[116:119]
    ds_read_b64_tr_b16 a[26:27], v6 offset:16896
    v_mfma_f32_16x16x32_bf16 v[120:123], a[8:11], v[152:155], v[120:123]
    ds_read_b64_tr_b16 a[30:31], v7 offset:16896
    s_waitcnt vmcnt(10)
    v_mfma_f32_16x16x32_bf16 v[124:127], a[12:15], v[152:155], v[124:127]
    ds_read_b128 v[152:155], v11 offset:26624
    s_waitcnt lgkmcnt(1)
    v_mfma_f32_16x16x32_bf16 v[16:19], a[16:19], v[128:131], v[16:19]
    s_barrier
    ds_read_b64_tr_b16 a[32:33], v6 offset:0
    s_mov_b32 m0, s54
    v_mfma_f32_16x16x32_bf16 v[20:23], a[20:23], v[128:131], v[20:23]
    s_add_u32 s92, s92, s94
    buffer_load_dwordx4 v5, s[40:43], s92 offen lds
    v_mfma_f32_16x16x32_bf16 v[24:27], a[24:27], v[128:131], v[24:27]
    buffer_load_dwordx4 v5, s[44:47], s92 offen offset:1024 lds
    v_mfma_f32_16x16x32_bf16 v[28:31], a[28:31], v[128:131], v[28:31]
    ds_read_b128 v[128:131], v1 offset:28672
    v_mfma_f32_16x16x32_bf16 v[32:35], a[16:19], v[132:135], v[32:35]
    ds_read_b64_tr_b16 a[36:37], v7 offset:0
    v_mfma_f32_16x16x32_bf16 v[36:39], a[20:23], v[132:135], v[36:39]
    ds_read_b64_tr_b16 a[40:41], v6 offset:512
    v_mfma_f32_16x16x32_bf16 v[40:43], a[24:27], v[132:135], v[40:43]
    ds_read_b64_tr_b16 a[44:45], v7 offset:512
    s_waitcnt vmcnt(10)
    v_mfma_f32_16x16x32_bf16 v[44:47], a[28:31], v[132:135], v[44:47]
    ds_read_b128 v[132:135], v1 offset:30720
    v_mfma_f32_16x16x32_bf16 v[48:51], a[16:19], v[136:139], v[48:51]
    ds_read_b64_tr_b16 a[34:35], v6 offset:24576
    v_mfma_f32_16x16x32_bf16 v[52:55], a[20:23], v[136:139], v[52:55]
    ds_read_b64_tr_b16 a[38:39], v7 offset:24576
    v_mfma_f32_16x16x32_bf16 v[56:59], a[24:27], v[136:139], v[56:59]
    ds_read_b64_tr_b16 a[42:43], v6 offset:25088
    v_mfma_f32_16x16x32_bf16 v[60:63], a[28:31], v[136:139], v[60:63]
    ds_read_b128 v[136:139], v1 offset:32768
    v_mfma_f32_16x16x32_bf16 v[64:67], a[16:19], v[140:143], v[64:67]
    ds_read_b64_tr_b16 a[46:47], v7 offset:25088
    s_waitcnt vmcnt(8)
    v_mfma_f32_16x16x32_bf16 v[68:71], a[20:23], v[140:143], v[68:71]
    ds_read_b64_tr_b16 a[0:1], v6 offset:32768
    s_waitcnt lgkmcnt(7)
    s_mov_b32 m0, s52
    v_mfma_f32_16x16x32_bf16 v[72:75], a[24:27], v[140:143], v[72:75]
    s_add_u32 s92, s92, s93
    buffer_load_dwordx4 v5, s[40:43], s92 offen lds
    v_mfma_f32_16x16x32_bf16 v[76:79], a[28:31], v[140:143], v[76:79]
    ds_read_b128 v[140:143], v1 offset:34816
    v_mfma_f32_16x16x32_bf16 v[80:83], a[16:19], v[144:147], v[80:83]
    buffer_load_dwordx4 v5, s[44:47], s92 offen offset:1024 lds
    v_mfma_f32_16x16x32_bf16 v[84:87], a[20:23], v[144:147], v[84:87]
    ds_read_b64_tr_b16 a[4:5], v7 offset:32768
    v_mfma_f32_16x16x32_bf16 v[88:91], a[24:27], v[144:147], v[88:91]
    ds_read_b64_tr_b16 a[8:9], v6 offset:33280
    v_mfma_f32_16x16x32_bf16 v[92:95], a[28:31], v[144:147], v[92:95]
    ds_read_b128 v[144:147], v1 offset:36864
    s_waitcnt lgkmcnt(5)
    s_mov_b32 m0, s55
    v_mfma_f32_16x16x32_bf16 v[96:99], a[16:19], v[148:151], v[96:99]
    s_add_u32 s92, s92, s94
    s_cmp_ge_u32 s92, 3670016
    s_cselect_b32 s13, 3670016, 0
    s_sub_u32 s92, s92, s13
    v_mfma_f32_16x16x32_bf16 v[100:103], a[20:23], v[148:151], v[100:103]
    buffer_load_dwordx4 v5, s[40:43], s92 offen lds
    v_mfma_f32_16x16x32_bf16 v[104:107], a[24:27], v[148:151], v[104:107]
    buffer_load_dwordx4 v5, s[44:47], s92 offen offset:1024 lds
    v_mfma_f32_16x16x32_bf16 v[108:111], a[28:31], v[148:151], v[108:111]
    ds_read_b128 v[148:151], v1 offset:38912
    v_mfma_f32_16x16x32_bf16 v[112:115], a[16:19], v[152:155], v[112:115]
    ds_read_b64_tr_b16 a[12:13], v7 offset:33280
    v_mfma_f32_16x16x32_bf16 v[116:119], a[20:23], v[152:155], v[116:119]
    v_mfma_f32_16x16x32_bf16 v[120:123], a[24:27], v[152:155], v[120:123]
    v_mfma_f32_16x16x32_bf16 v[124:127], a[28:31], v[152:155], v[124:127]
    ds_read_b128 v[152:155], v1 offset:40960
    v_mfma_f32_16x16x32_bf16 v[16:19], a[32:35], v[128:131], v[16:19]
    s_barrier
    s_mov_b32 m0, s59
    s_add_u32 s92, s92, s93
    v_mfma_f32_16x16x32_bf16 v[20:23], a[36:39], v[128:131], v[20:23]
    buffer_load_dwordx4 v5, s[40:43], s92 offen lds
    v_mfma_f32_16x16x32_bf16 v[24:27], a[40:43], v[128:131], v[24:27]
    buffer_load_dwordx4 v5, s[44:47], s92 offen offset:1024 lds
    s_mov_b32 m0, s60
    s_add_u32 s92, s92, s94
    v_mfma_f32_16x16x32_bf16 v[28:31], a[44:47], v[128:131], v[28:31]
    ds_read_b128 v[128:131], v11 offset:28672
    v_mfma_f32_16x16x32_bf16 v[32:35], a[32:35], v[132:135], v[32:35]
    buffer_load_dwordx4 v5, s[40:43], s92 offen lds
    v_mfma_f32_16x16x32_bf16 v[36:39], a[36:39], v[132:135], v[36:39]
    buffer_load_dwordx4 v5, s[44:47], s92 offen offset:1024 lds
    v_mfma_f32_16x16x32_bf16 v[40:43], a[40:43], v[132:135], v[40:43]
    v_mfma_f32_16x16x32_bf16 v[44:47], a[44:47], v[132:135], v[44:47]
    ds_read_b128 v[132:135], v11 offset:30720
    v_mfma_f32_16x16x32_bf16 v[48:51], a[32:35], v[136:139], v[48:51]
    v_mfma_f32_16x16x32_bf16 v[52:55], a[36:39], v[136:139], v[52:55]
    v_mfma_f32_16x16x32_bf16 v[56:59], a[40:43], v[136:139], v[56:59]
    v_mfma_f32_16x16x32_bf16 v[60:63], a[44:47], v[136:139], v[60:63]
    ds_read_b128 v[136:139], v11 offset:32768
    s_waitcnt lgkmcnt(3)
    v_mfma_f32_16x16x32_bf16 v[64:67], a[32:35], v[140:143], v[64:67]
    s_waitcnt vmcnt(14)
    ds_read_b64_tr_b16 a[2:3], v6 offset:40960
    s_mov_b32 m0, s56
    v_mfma_f32_16x16x32_bf16 v[68:71], a[36:39], v[140:143], v[68:71]
    s_add_u32 s92, s92, s93
    buffer_load_dwordx4 v5, s[40:43], s92 offen lds
    v_mfma_f32_16x16x32_bf16 v[72:75], a[40:43], v[140:143], v[72:75]
    buffer_load_dwordx4 v5, s[44:47], s92 offen offset:1024 lds
    v_mfma_f32_16x16x32_bf16 v[76:79], a[44:47], v[140:143], v[76:79]
    ds_read_b128 v[140:143], v11 offset:34816
    v_mfma_f32_16x16x32_bf16 v[80:83], a[32:35], v[144:147], v[80:83]
    ds_read_b64_tr_b16 a[6:7], v7 offset:40960
    v_mfma_f32_16x16x32_bf16 v[84:87], a[36:39], v[144:147], v[84:87]
    ds_read_b64_tr_b16 a[10:11], v6 offset:41472
    v_mfma_f32_16x16x32_bf16 v[88:91], a[40:43], v[144:147], v[88:91]
    ds_read_b64_tr_b16 a[14:15], v7 offset:41472
    v_mfma_f32_16x16x32_bf16 v[92:95], a[44:47], v[144:147], v[92:95]
    ds_read_b128 v[144:147], v11 offset:36864
    s_waitcnt vmcnt(14)
    s_mov_b32 m0, s61
    v_mfma_f32_16x16x32_bf16 v[96:99], a[32:35], v[148:151], v[96:99]
    s_add_u32 s92, s92, s94
    s_cmp_ge_u32 s92, 3670016
    s_cselect_b32 s13, 3670016, 0
    s_sub_u32 s92, s92, s13
    v_mfma_f32_16x16x32_bf16 v[100:103], a[36:39], v[148:151], v[100:103]
    buffer_load_dwordx4 v5, s[40:43], s92 offen lds
    v_mfma_f32_16x16x32_bf16 v[104:107], a[40:43], v[148:151], v[104:107]
    buffer_load_dwordx4 v5, s[44:47], s92 offen offset:1024 lds
    v_mfma_f32_16x16x32_bf16 v[108:111], a[44:47], v[148:151], v[108:111]
    ds_read_b128 v[148:151], v11 offset:38912
    v_mfma_f32_16x16x32_bf16 v[112:115], a[32:35], v[152:155], v[112:115]
    ds_read_b64_tr_b16 a[16:17], v6 offset:49152
    v_mfma_f32_16x16x32_bf16 v[116:119], a[36:39], v[152:155], v[116:119]
    ds_read_b64_tr_b16 a[20:21], v7 offset:49152
    v_mfma_f32_16x16x32_bf16 v[120:123], a[40:43], v[152:155], v[120:123]
    ds_read_b64_tr_b16 a[24:25], v6 offset:49664
    v_mfma_f32_16x16x32_bf16 v[124:127], a[44:47], v[152:155], v[124:127]
    ds_read_b128 v[152:155], v11 offset:40960
    s_waitcnt lgkmcnt(6)
    v_mfma_f32_16x16x32_bf16 v[16:19], a[0:3], v[128:131], v[16:19]
    ds_read_b64_tr_b16 a[28:29], v7 offset:49664
    s_waitcnt vmcnt(14)
    s_mov_b32 m0, s57
    v_mfma_f32_16x16x32_bf16 v[20:23], a[4:7], v[128:131], v[20:23]
    s_add_u32 s92, s92, s93
    buffer_load_dwordx4 v5, s[40:43], s92 offen lds
    v_mfma_f32_16x16x32_bf16 v[24:27], a[8:11], v[128:131], v[24:27]
    buffer_load_dwordx4 v5, s[44:47], s92 offen offset:1024 lds
    v_mfma_f32_16x16x32_bf16 v[28:31], a[12:15], v[128:131], v[28:31]
    ds_read_b128 v[128:131], v1 offset:43008
    v_mfma_f32_16x16x32_bf16 v[32:35], a[0:3], v[132:135], v[32:35]
    ds_read_b64_tr_b16 a[18:19], v6 offset:8192
    v_mfma_f32_16x16x32_bf16 v[36:39], a[4:7], v[132:135], v[36:39]
    ds_read_b64_tr_b16 a[22:23], v7 offset:8192
    v_mfma_f32_16x16x32_bf16 v[40:43], a[8:11], v[132:135], v[40:43]
    ds_read_b64_tr_b16 a[26:27], v6 offset:8704
    v_mfma_f32_16x16x32_bf16 v[44:47], a[12:15], v[132:135], v[44:47]
    ds_read_b128 v[132:135], v1 offset:45056
    v_mfma_f32_16x16x32_bf16 v[48:51], a[0:3], v[136:139], v[48:51]
    ds_read_b64_tr_b16 a[30:31], v7 offset:8704
    s_waitcnt vmcnt(14)
    s_waitcnt lgkmcnt(6)
    v_mfma_f32_16x16x32_bf16 v[52:55], a[4:7], v[136:139], v[52:55]
    s_mov_b32 m0, s58
    s_add_u32 s92, s92, s94
    buffer_load_dwordx4 v5, s[40:43], s92 offen lds
    v_mfma_f32_16x16x32_bf16 v[56:59], a[8:11], v[136:139], v[56:59]
    buffer_load_dwordx4 v5, s[44:47], s92 offen offset:1024 lds
    v_mfma_f32_16x16x32_bf16 v[60:63], a[12:15], v[136:139], v[60:63]
    ds_read_b128 v[136:139], v1 offset:47104
    v_mfma_f32_16x16x32_bf16 v[64:67], a[0:3], v[140:143], v[64:67]
    ds_read_b64_tr_b16 a[32:33], v6 offset:16384
    v_mfma_f32_16x16x32_bf16 v[68:71], a[4:7], v[140:143], v[68:71]
    ds_read_b64_tr_b16 a[36:37], v7 offset:16384
    v_mfma_f32_16x16x32_bf16 v[72:75], a[8:11], v[140:143], v[72:75]
    ds_read_b64_tr_b16 a[40:41], v6 offset:16896
    v_mfma_f32_16x16x32_bf16 v[76:79], a[12:15], v[140:143], v[76:79]
    ds_read_b128 v[140:143], v1 offset:49152
    v_mfma_f32_16x16x32_bf16 v[80:83], a[0:3], v[144:147], v[80:83]
    ds_read_b64_tr_b16 a[44:45], v7 offset:16896
    s_waitcnt vmcnt(14)
    s_waitcnt lgkmcnt(6)
    v_mfma_f32_16x16x32_bf16 v[84:87], a[4:7], v[144:147], v[84:87]
    s_mov_b32 m0, s53
    s_add_u32 s92, s92, s93
    buffer_load_dwordx4 v5, s[40:43], s92 offen lds
    v_mfma_f32_16x16x32_bf16 v[88:91], a[8:11], v[144:147], v[88:91]
    buffer_load_dwordx4 v5, s[44:47], s92 offen offset:1024 lds
    v_mfma_f32_16x16x32_bf16 v[92:95], a[12:15], v[144:147], v[92:95]
    ds_read_b128 v[144:147], v1 offset:51200
    v_mfma_f32_16x16x32_bf16 v[96:99], a[0:3], v[148:151], v[96:99]
    ds_read_b64_tr_b16 a[34:35], v6 offset:0
    v_mfma_f32_16x16x32_bf16 v[100:103], a[4:7], v[148:151], v[100:103]
    ds_read_b64_tr_b16 a[38:39], v7 offset:0
    v_mfma_f32_16x16x32_bf16 v[104:107], a[8:11], v[148:151], v[104:107]
    ds_read_b64_tr_b16 a[42:43], v6 offset:512
    v_mfma_f32_16x16x32_bf16 v[108:111], a[12:15], v[148:151], v[108:111]
    ds_read_b128 v[148:151], v1 offset:53248
    v_mfma_f32_16x16x32_bf16 v[112:115], a[0:3], v[152:155], v[112:115]
    ds_read_b64_tr_b16 a[46:47], v7 offset:512
    s_waitcnt vmcnt(14)
    s_waitcnt lgkmcnt(6)
    v_mfma_f32_16x16x32_bf16 v[116:119], a[4:7], v[152:155], v[116:119]
    s_mov_b32 m0, s54
    s_add_u32 s92, s92, s94
    s_cmp_ge_u32 s92, 3670016
    s_cselect_b32 s13, 3670016, 0
    s_sub_u32 s92, s92, s13
    v_mfma_f32_16x16x32_bf16 v[120:123], a[8:11], v[152:155], v[120:123]
    buffer_load_dwordx4 v5, s[40:43], s92 offen lds
    v_mfma_f32_16x16x32_bf16 v[124:127], a[12:15], v[152:155], v[124:127]
    ds_read_b128 v[152:155], v1 offset:55296
    v_mfma_f32_16x16x32_bf16 v[16:19], a[16:19], v[128:131], v[16:19]
    buffer_load_dwordx4 v5, s[44:47], s92 offen offset:1024 lds
    v_mfma_f32_16x16x32_bf16 v[20:23], a[20:23], v[128:131], v[20:23]
    ds_read_b64_tr_b16 a[48:49], v6 offset:24576
    v_mfma_f32_16x16x32_bf16 v[24:27], a[24:27], v[128:131], v[24:27]
    ds_read_b64_tr_b16 a[52:53], v7 offset:24576
    v_mfma_f32_16x16x32_bf16 v[28:31], a[28:31], v[128:131], v[28:31]
    ds_read_b128 v[128:131], v11 offset:43008
    v_mfma_f32_16x16x32_bf16 v[32:35], a[16:19], v[132:135], v[32:35]
    ds_read_b64_tr_b16 a[56:57], v6 offset:25088
    v_mfma_f32_16x16x32_bf16 v[36:39], a[20:23], v[132:135], v[36:39]
    ds_read_b64_tr_b16 a[60:61], v7 offset:25088
    s_waitcnt vmcnt(14)
    s_waitcnt lgkmcnt(6)
    v_mfma_f32_16x16x32_bf16 v[40:43], a[24:27], v[132:135], v[40:43]
    s_mov_b32 m0, s52
    s_add_u32 s92, s92, s93
    buffer_load_dwordx4 v5, s[40:43], s92 offen lds
    v_mfma_f32_16x16x32_bf16 v[44:47], a[28:31], v[132:135], v[44:47]
    ds_read_b128 v[132:135], v11 offset:45056
    v_mfma_f32_16x16x32_bf16 v[48:51], a[16:19], v[136:139], v[48:51]
    buffer_load_dwordx4 v5, s[44:47], s92 offen offset:1024 lds
    v_mfma_f32_16x16x32_bf16 v[52:55], a[20:23], v[136:139], v[52:55]
    ds_read_b64_tr_b16 a[50:51], v159 offset:0
    v_mfma_f32_16x16x32_bf16 v[56:59], a[24:27], v[136:139], v[56:59]
    ds_read_b64_tr_b16 a[54:55], v160 offset:0
    v_mfma_f32_16x16x32_bf16 v[60:63], a[28:31], v[136:139], v[60:63]
    ds_read_b128 v[136:139], v11 offset:47104
    v_mfma_f32_16x16x32_bf16 v[64:67], a[16:19], v[140:143], v[64:67]
    ds_read_b64_tr_b16 a[58:59], v159 offset:512
    v_mfma_f32_16x16x32_bf16 v[68:71], a[20:23], v[140:143], v[68:71]
    ds_read_b64_tr_b16 a[62:63], v160 offset:512
    s_waitcnt vmcnt(14)
    s_waitcnt lgkmcnt(6)
    v_mfma_f32_16x16x32_bf16 v[72:75], a[24:27], v[140:143], v[72:75]
    s_mov_b32 m0, s55
    s_add_u32 s92, s92, s94
    buffer_load_dwordx4 v5, s[40:43], s92 offen lds
    v_mfma_f32_16x16x32_bf16 v[76:79], a[28:31], v[140:143], v[76:79]
    ds_read_b128 v[140:143], v11 offset:49152
    v_mfma_f32_16x16x32_bf16 v[80:83], a[16:19], v[144:147], v[80:83]
    buffer_load_dwordx4 v5, s[44:47], s92 offen offset:1024 lds
    v_mfma_f32_16x16x32_bf16 v[84:87], a[20:23], v[144:147], v[84:87]
    ds_read_b64_tr_b16 a[0:1], v159 offset:8192
    v_mfma_f32_16x16x32_bf16 v[88:91], a[24:27], v[144:147], v[88:91]
    ds_read_b64_tr_b16 a[4:5], v160 offset:8192
    v_mfma_f32_16x16x32_bf16 v[92:95], a[28:31], v[144:147], v[92:95]
    ds_read_b128 v[144:147], v11 offset:51200
    v_mfma_f32_16x16x32_bf16 v[96:99], a[16:19], v[148:151], v[96:99]
    ds_read_b64_tr_b16 a[8:9], v159 offset:8704
    v_mfma_f32_16x16x32_bf16 v[100:103], a[20:23], v[148:151], v[100:103]
    ds_read_b64_tr_b16 a[12:13], v160 offset:8704
    s_waitcnt vmcnt(14)
    s_waitcnt lgkmcnt(6)
    v_mfma_f32_16x16x32_bf16 v[104:107], a[24:27], v[148:151], v[104:107]
    s_mov_b32 m0, s59
    s_add_u32 s92, s92, s93
    buffer_load_dwordx4 v5, s[40:43], s92 offen lds
    v_mfma_f32_16x16x32_bf16 v[108:111], a[28:31], v[148:151], v[108:111]
    ds_read_b128 v[148:151], v11 offset:53248
    v_mfma_f32_16x16x32_bf16 v[112:115], a[16:19], v[152:155], v[112:115]
    buffer_load_dwordx4 v5, s[44:47], s92 offen offset:1024 lds
    v_mfma_f32_16x16x32_bf16 v[116:119], a[20:23], v[152:155], v[116:119]
    ds_read_b64_tr_b16 a[2:3], v6 offset:32768
    v_mfma_f32_16x16x32_bf16 v[120:123], a[24:27], v[152:155], v[120:123]
    ds_read_b64_tr_b16 a[6:7], v7 offset:32768
    v_mfma_f32_16x16x32_bf16 v[124:127], a[28:31], v[152:155], v[124:127]
    ds_read_b128 v[152:155], v11 offset:55296
    v_mfma_f32_16x16x32_bf16 v[16:19], a[32:35], v[128:131], v[16:19]
    s_barrier
    ds_read_b64_tr_b16 a[10:11], v6 offset:33280
    v_mfma_f32_16x16x32_bf16 v[20:23], a[36:39], v[128:131], v[20:23]
    ds_read_b64_tr_b16 a[14:15], v7 offset:33280
    s_waitcnt vmcnt(14)
    s_waitcnt lgkmcnt(6)
    v_mfma_f32_16x16x32_bf16 v[24:27], a[40:43], v[128:131], v[24:27]
    s_mov_b32 m0, s60
    s_mov_b32 s70, 0
    buffer_load_dwordx4 v3, s[24:27], s70 offen nt lds
    v_mfma_f32_16x16x32_bf16 v[28:31], a[44:47], v[128:131], v[28:31]
    ds_read_b128 v[128:131], v1 offset:57344
    v_mfma_f32_16x16x32_bf16 v[32:35], a[32:35], v[132:135], v[32:35]
    buffer_load_dwordx4 v3, s[28:31], s70 offen offset:1024 nt lds
    v_mfma_f32_16x16x32_bf16 v[36:39], a[36:39], v[132:135], v[36:39]
    ds_read_b64_tr_b16 a[16:17], v159 offset:16384
    v_mfma_f32_16x16x32_bf16 v[40:43], a[40:43], v[132:135], v[40:43]
    ds_read_b64_tr_b16 a[20:21], v160 offset:16384
    v_mfma_f32_16x16x32_bf16 v[44:47], a[44:47], v[132:135], v[44:47]
    ds_read_b128 v[132:135], v1 offset:59392
    v_mfma_f32_16x16x32_bf16 v[48:51], a[32:35], v[136:139], v[48:51]
    ds_read_b64_tr_b16 a[24:25], v159 offset:16896
    v_mfma_f32_16x16x32_bf16 v[52:55], a[36:39], v[136:139], v[52:55]
    ds_read_b64_tr_b16 a[28:29], v160 offset:16896
    s_waitcnt vmcnt(14)
    s_waitcnt lgkmcnt(6)
    v_mfma_f32_16x16x32_bf16 v[56:59], a[40:43], v[136:139], v[56:59]
    s_mov_b32 m0, s56
    s_addk_i32 s70, 8192
    buffer_load_dwordx4 v3, s[24:27], s70 offen nt lds
    v_mfma_f32_16x16x32_bf16 v[60:63], a[44:47], v[136:139], v[60:63]
    ds_read_b128 v[136:139], v1 offset:61440
    v_mfma_f32_16x16x32_bf16 v[64:67], a[32:35], v[140:143], v[64:67]
    buffer_load_dwordx4 v3, s[28:31], s70 offen offset:1024 nt lds
    v_mfma_f32_16x16x32_bf16 v[68:71], a[36:39], v[140:143], v[68:71]
    ds_read_b64_tr_b16 a[18:19], v6 offset:40960
    v_mfma_f32_16x16x32_bf16 v[72:75], a[40:43], v[140:143], v[72:75]
    ds_read_b64_tr_b16 a[22:23], v7 offset:40960
    v_mfma_f32_16x16x32_bf16 v[76:79], a[44:47], v[140:143], v[76:79]
    ds_read_b128 v[140:143], v1 offset:63488
    v_mfma_f32_16x16x32_bf16 v[80:83], a[32:35], v[144:147], v[80:83]
    ds_read_b64_tr_b16 a[26:27], v6 offset:41472
    v_mfma_f32_16x16x32_bf16 v[84:87], a[36:39], v[144:147], v[84:87]
    ds_read_b64_tr_b16 a[30:31], v7 offset:41472
    s_waitcnt vmcnt(14)
    s_waitcnt lgkmcnt(6)
    v_mfma_f32_16x16x32_bf16 v[88:91], a[40:43], v[144:147], v[88:91]
    s_mov_b32 m0, s61
    s_addk_i32 s70, -8064
    buffer_load_dwordx4 v3, s[24:27], s70 offen nt lds
    v_mfma_f32_16x16x32_bf16 v[92:95], a[44:47], v[144:147], v[92:95]
    ds_read_b128 v[144:147], v2 offset:0
    v_mfma_f32_16x16x32_bf16 v[96:99], a[32:35], v[148:151], v[96:99]
    buffer_load_dwordx4 v3, s[28:31], s70 offen offset:1024 nt lds
    v_mfma_f32_16x16x32_bf16 v[100:103], a[36:39], v[148:151], v[100:103]
    ds_read_b64_tr_b16 a[64:65], v6 offset:49152
    v_mfma_f32_16x16x32_bf16 v[104:107], a[40:43], v[148:151], v[104:107]
    ds_read_b64_tr_b16 a[68:69], v7 offset:49152
    v_mfma_f32_16x16x32_bf16 v[108:111], a[44:47], v[148:151], v[108:111]
    ds_read_b128 v[148:151], v2 offset:2048
    v_mfma_f32_16x16x32_bf16 v[112:115], a[32:35], v[152:155], v[112:115]
    ds_read_b64_tr_b16 a[72:73], v6 offset:49664
    v_mfma_f32_16x16x32_bf16 v[116:119], a[36:39], v[152:155], v[116:119]
    ds_read_b64_tr_b16 a[76:77], v7 offset:49664
    s_waitcnt vmcnt(14)
    s_waitcnt lgkmcnt(6)
    v_mfma_f32_16x16x32_bf16 v[120:123], a[40:43], v[152:155], v[120:123]
    s_mov_b32 m0, s57
    s_addk_i32 s70, 8192
    buffer_load_dwordx4 v3, s[24:27], s70 offen nt lds
    v_mfma_f32_16x16x32_bf16 v[124:127], a[44:47], v[152:155], v[124:127]
    ds_read_b128 v[152:155], v2 offset:4096
    v_mfma_f32_16x16x32_bf16 v[16:19], a[48:51], v[128:131], v[16:19]
    s_barrier
    buffer_load_dwordx4 v3, s[28:31], s70 offen offset:1024 nt lds
    v_mfma_f32_16x16x32_bf16 v[20:23], a[52:55], v[128:131], v[20:23]
    ds_read_b64_tr_b16 a[66:67], v6 offset:8192
    v_mfma_f32_16x16x32_bf16 v[24:27], a[56:59], v[128:131], v[24:27]
    ds_read_b64_tr_b16 a[70:71], v7 offset:8192
    v_mfma_f32_16x16x32_bf16 v[28:31], a[60:63], v[128:131], v[28:31]
    ds_read_b128 v[128:131], v11 offset:57344
    v_mfma_f32_16x16x32_bf16 v[32:35], a[48:51], v[132:135], v[32:35]
    ds_read_b64_tr_b16 a[74:75], v6 offset:8704
    v_mfma_f32_16x16x32_bf16 v[36:39], a[52:55], v[132:135], v[36:39]
    ds_read_b64_tr_b16 a[78:79], v7 offset:8704
    v_mfma_f32_16x16x32_bf16 v[40:43], a[56:59], v[132:135], v[40:43]
    v_mfma_f32_16x16x32_bf16 v[44:47], a[60:63], v[132:135], v[44:47]
    ds_read_b128 v[132:135], v11 offset:59392
    s_waitcnt vmcnt(14)
    s_mov_b32 m0, s62
    v_mfma_f32_16x16x32_bf16 v[48:51], a[48:51], v[136:139], v[48:51]
    s_addk_i32 s70, -8064
    buffer_load_dwordx4 v3, s[24:27], s70 offen nt lds
    v_mfma_f32_16x16x32_bf16 v[52:55], a[52:55], v[136:139], v[52:55]
    buffer_load_dwordx4 v3, s[28:31], s70 offen offset:1024 nt lds
    v_mfma_f32_16x16x32_bf16 v[56:59], a[56:59], v[136:139], v[56:59]
    ds_read_b64_tr_b16 a[32:33], v6 offset:16384
    v_mfma_f32_16x16x32_bf16 v[60:63], a[60:63], v[136:139], v[60:63]
    ds_read_b128 v[136:139], v11 offset:61440
    v_mfma_f32_16x16x32_bf16 v[64:67], a[48:51], v[140:143], v[64:67]
    ds_read_b64_tr_b16 a[36:37], v7 offset:16384
    v_mfma_f32_16x16x32_bf16 v[68:71], a[52:55], v[140:143], v[68:71]
    ds_read_b64_tr_b16 a[40:41], v6 offset:16896
    v_mfma_f32_16x16x32_bf16 v[72:75], a[56:59], v[140:143], v[72:75]
    ds_read_b64_tr_b16 a[44:45], v7 offset:16896
    v_mfma_f32_16x16x32_bf16 v[76:79], a[60:63], v[140:143], v[76:79]
    ds_read_b128 v[140:143], v11 offset:63488
    s_waitcnt vmcnt(14)
    s_mov_b32 m0, s63
    s_waitcnt lgkmcnt(7)
    v_mfma_f32_16x16x32_bf16 v[80:83], a[48:51], v[144:147], v[80:83]
    s_addk_i32 s70, 8192
    buffer_load_dwordx4 v3, s[24:27], s70 offen nt lds
    v_mfma_f32_16x16x32_bf16 v[84:87], a[52:55], v[144:147], v[84:87]
    buffer_load_dwordx4 v3, s[28:31], s70 offen offset:1024 nt lds
    v_mfma_f32_16x16x32_bf16 v[88:91], a[56:59], v[144:147], v[88:91]
    ds_read_b64_tr_b16 a[34:35], v6 offset:0
    v_mfma_f32_16x16x32_bf16 v[92:95], a[60:63], v[144:147], v[92:95]
    ds_read_b128 v[144:147], v12 offset:0
    v_mfma_f32_16x16x32_bf16 v[96:99], a[48:51], v[148:151], v[96:99]
    ds_read_b64_tr_b16 a[38:39], v7 offset:0
    v_mfma_f32_16x16x32_bf16 v[100:103], a[52:55], v[148:151], v[100:103]
    ds_read_b64_tr_b16 a[42:43], v6 offset:512
    v_mfma_f32_16x16x32_bf16 v[104:107], a[56:59], v[148:151], v[104:107]
    ds_read_b64_tr_b16 a[46:47], v7 offset:512
    v_mfma_f32_16x16x32_bf16 v[108:111], a[60:63], v[148:151], v[108:111]
    ds_read_b128 v[148:151], v12 offset:2048
    s_waitcnt vmcnt(14)
    s_mov_b32 m0, s53
    v_mfma_f32_16x16x32_bf16 v[112:115], a[48:51], v[152:155], v[112:115]
    s_addk_i32 s70, -8064
    buffer_load_dwordx4 v3, s[24:27], s70 offen nt lds
    v_mfma_f32_16x16x32_bf16 v[116:119], a[52:55], v[152:155], v[116:119]
    buffer_load_dwordx4 v3, s[28:31], s70 offen offset:1024 nt lds
    v_mfma_f32_16x16x32_bf16 v[120:123], a[56:59], v[152:155], v[120:123]
    ds_read_b64_tr_b16 a[80:81], v6 offset:24576
    v_mfma_f32_16x16x32_bf16 v[124:127], a[60:63], v[152:155], v[124:127]
    ds_read_b128 v[152:155], v12 offset:4096
    v_mfma_f32_16x16x32_bf16 v[16:19], a[0:3], v[128:131], v[16:19]
    ds_read_b64_tr_b16 a[84:85], v7 offset:24576
    v_mfma_f32_16x16x32_bf16 v[20:23], a[4:7], v[128:131], v[20:23]
    ds_read_b64_tr_b16 a[88:89], v6 offset:25088
    v_mfma_f32_16x16x32_bf16 v[24:27], a[8:11], v[128:131], v[24:27]
    ds_read_b64_tr_b16 a[92:93], v7 offset:25088
    v_mfma_f32_16x16x32_bf16 v[28:31], a[12:15], v[128:131], v[28:31]
    ds_read_b128 v[128:131], v2 offset:6144
    s_waitcnt vmcnt(14)
    s_mov_b32 m0, s58
    s_waitcnt lgkmcnt(8)
    v_mfma_f32_16x16x32_bf16 v[32:35], a[0:3], v[132:135], v[32:35]
    s_addk_i32 s70, 8192
    buffer_load_dwordx4 v3, s[24:27], s70 offen nt lds
    v_mfma_f32_16x16x32_bf16 v[36:39], a[4:7], v[132:135], v[36:39]
    buffer_load_dwordx4 v3, s[28:31], s70 offen offset:1024 nt lds
    v_mfma_f32_16x16x32_bf16 v[40:43], a[8:11], v[132:135], v[40:43]
    ds_read_b64_tr_b16 a[82:83], v159 offset:0
    v_mfma_f32_16x16x32_bf16 v[44:47], a[12:15], v[132:135], v[44:47]
    ds_read_b128 v[132:135], v2 offset:8192
    v_mfma_f32_16x16x32_bf16 v[48:51], a[0:3], v[136:139], v[48:51]
    ds_read_b64_tr_b16 a[86:87], v160 offset:0
    v_mfma_f32_16x16x32_bf16 v[52:55], a[4:7], v[136:139], v[52:55]
    ds_read_b64_tr_b16 a[90:91], v159 offset:512
    v_mfma_f32_16x16x32_bf16 v[56:59], a[8:11], v[136:139], v[56:59]
    ds_read_b64_tr_b16 a[94:95], v160 offset:512
    v_mfma_f32_16x16x32_bf16 v[60:63], a[12:15], v[136:139], v[60:63]
    ds_read_b128 v[136:139], v2 offset:10240
    v_mfma_f32_16x16x32_bf16 v[64:67], a[0:3], v[140:143], v[64:67]
    v_mfma_f32_16x16x32_bf16 v[68:71], a[4:7], v[140:143], v[68:71]
    v_mfma_f32_16x16x32_bf16 v[72:75], a[8:11], v[140:143], v[72:75]
    v_mfma_f32_16x16x32_bf16 v[76:79], a[12:15], v[140:143], v[76:79]
    ds_read_b128 v[140:143], v2 offset:12288
    v_mfma_f32_16x16x32_bf16 v[80:83], a[0:3], v[144:147], v[80:83]
    v_mfma_f32_16x16x32_bf16 v[84:87], a[4:7], v[144:147], v[84:87]
    v_mfma_f32_16x16x32_bf16 v[88:91], a[8:11], v[144:147], v[88:91]
    v_mfma_f32_16x16x32_bf16 v[92:95], a[12:15], v[144:147], v[92:95]
    ds_read_b128 v[144:147], v2 offset:14336
    s_waitcnt lgkmcnt(4)
    v_mfma_f32_16x16x32_bf16 v[96:99], a[0:3], v[148:151], v[96:99]
    v_mfma_f32_16x16x32_bf16 v[100:103], a[4:7], v[148:151], v[100:103]
    v_mfma_f32_16x16x32_bf16 v[104:107], a[8:11], v[148:151], v[104:107]
    v_mfma_f32_16x16x32_bf16 v[108:111], a[12:15], v[148:151], v[108:111]
    ds_read_b128 v[148:151], v2 offset:16384
    v_mfma_f32_16x16x32_bf16 v[112:115], a[0:3], v[152:155], v[112:115]
    v_mfma_f32_16x16x32_bf16 v[116:119], a[4:7], v[152:155], v[116:119]
    v_mfma_f32_16x16x32_bf16 v[120:123], a[8:11], v[152:155], v[120:123]
    v_mfma_f32_16x16x32_bf16 v[124:127], a[12:15], v[152:155], v[124:127]
    ds_read_b128 v[152:155], v2 offset:18432
    v_mfma_f32_16x16x32_bf16 v[16:19], a[16:19], v[128:131], v[16:19]
    v_mfma_f32_16x16x32_bf16 v[20:23], a[20:23], v[128:131], v[20:23]
    v_mfma_f32_16x16x32_bf16 v[24:27], a[24:27], v[128:131], v[24:27]
    v_mfma_f32_16x16x32_bf16 v[28:31], a[28:31], v[128:131], v[28:31]
    ds_read_b128 v[128:131], v12 offset:6144
    v_mfma_f32_16x16x32_bf16 v[32:35], a[16:19], v[132:135], v[32:35]
    v_mfma_f32_16x16x32_bf16 v[36:39], a[20:23], v[132:135], v[36:39]
    v_mfma_f32_16x16x32_bf16 v[40:43], a[24:27], v[132:135], v[40:43]
    v_mfma_f32_16x16x32_bf16 v[44:47], a[28:31], v[132:135], v[44:47]
    ds_read_b128 v[132:135], v12 offset:8192
    s_waitcnt lgkmcnt(3)
    v_mfma_f32_16x16x32_bf16 v[48:51], a[16:19], v[136:139], v[48:51]
    v_mfma_f32_16x16x32_bf16 v[52:55], a[20:23], v[136:139], v[52:55]
    v_mfma_f32_16x16x32_bf16 v[56:59], a[24:27], v[136:139], v[56:59]
    v_mfma_f32_16x16x32_bf16 v[60:63], a[28:31], v[136:139], v[60:63]
    ds_read_b128 v[136:139], v12 offset:10240
    v_mfma_f32_16x16x32_bf16 v[64:67], a[16:19], v[140:143], v[64:67]
    v_mfma_f32_16x16x32_bf16 v[68:71], a[20:23], v[140:143], v[68:71]
    v_mfma_f32_16x16x32_bf16 v[72:75], a[24:27], v[140:143], v[72:75]
    v_mfma_f32_16x16x32_bf16 v[76:79], a[28:31], v[140:143], v[76:79]
    ds_read_b128 v[140:143], v12 offset:12288
    v_mfma_f32_16x16x32_bf16 v[80:83], a[16:19], v[144:147], v[80:83]
    v_mfma_f32_16x16x32_bf16 v[84:87], a[20:23], v[144:147], v[84:87]
    v_mfma_f32_16x16x32_bf16 v[88:91], a[24:27], v[144:147], v[88:91]
    v_mfma_f32_16x16x32_bf16 v[92:95], a[28:31], v[144:147], v[92:95]
    ds_read_b128 v[144:147], v12 offset:14336
    v_mfma_f32_16x16x32_bf16 v[96:99], a[16:19], v[148:151], v[96:99]
    v_mfma_f32_16x16x32_bf16 v[100:103], a[20:23], v[148:151], v[100:103]
    v_mfma_f32_16x16x32_bf16 v[104:107], a[24:27], v[148:151], v[104:107]
    v_mfma_f32_16x16x32_bf16 v[108:111], a[28:31], v[148:151], v[108:111]
    ds_read_b128 v[148:151], v12 offset:16384
    s_waitcnt lgkmcnt(3)
    v_mfma_f32_16x16x32_bf16 v[112:115], a[16:19], v[152:155], v[112:115]
    v_mfma_f32_16x16x32_bf16 v[116:119], a[20:23], v[152:155], v[116:119]
    v_mfma_f32_16x16x32_bf16 v[120:123], a[24:27], v[152:155], v[120:123]
    v_mfma_f32_16x16x32_bf16 v[124:127], a[28:31], v[152:155], v[124:127]
    ds_read_b128 v[152:155], v12 offset:18432
    v_mfma_f32_16x16x32_bf16 v[16:19], a[64:67], v[128:131], v[16:19]
    v_mfma_f32_16x16x32_bf16 v[20:23], a[68:71], v[128:131], v[20:23]
    v_mfma_f32_16x16x32_bf16 v[24:27], a[72:75], v[128:131], v[24:27]
    v_mfma_f32_16x16x32_bf16 v[28:31], a[76:79], v[128:131], v[28:31]
    ds_read_b128 v[128:131], v2 offset:20480
    v_mfma_f32_16x16x32_bf16 v[32:35], a[64:67], v[132:135], v[32:35]
    v_mfma_f32_16x16x32_bf16 v[36:39], a[68:71], v[132:135], v[36:39]
    v_mfma_f32_16x16x32_bf16 v[40:43], a[72:75], v[132:135], v[40:43]
    v_mfma_f32_16x16x32_bf16 v[44:47], a[76:79], v[132:135], v[44:47]
    ds_read_b128 v[132:135], v2 offset:22528
    v_mfma_f32_16x16x32_bf16 v[48:51], a[64:67], v[136:139], v[48:51]
    v_mfma_f32_16x16x32_bf16 v[52:55], a[68:71], v[136:139], v[52:55]
    v_mfma_f32_16x16x32_bf16 v[56:59], a[72:75], v[136:139], v[56:59]
    v_mfma_f32_16x16x32_bf16 v[60:63], a[76:79], v[136:139], v[60:63]
    ds_read_b128 v[136:139], v2 offset:24576
    s_waitcnt lgkmcnt(3)
    v_mfma_f32_16x16x32_bf16 v[64:67], a[64:67], v[140:143], v[64:67]
    v_mfma_f32_16x16x32_bf16 v[68:71], a[68:71], v[140:143], v[68:71]
    v_mfma_f32_16x16x32_bf16 v[72:75], a[72:75], v[140:143], v[72:75]
    v_mfma_f32_16x16x32_bf16 v[76:79], a[76:79], v[140:143], v[76:79]
    ds_read_b128 v[140:143], v2 offset:26624
    v_mfma_f32_16x16x32_bf16 v[80:83], a[64:67], v[144:147], v[80:83]
    v_mfma_f32_16x16x32_bf16 v[84:87], a[68:71], v[144:147], v[84:87]
    v_mfma_f32_16x16x32_bf16 v[88:91], a[72:75], v[144:147], v[88:91]
    s_waitcnt vmcnt(14)
    ds_read_b128 a[0:3], v156 offset:8192
    s_mov_b32 m0, s59
    v_mfma_f32_16x16x32_bf16 v[92:95], a[76:79], v[144:147], v[92:95]
    ds_read_b128 v[144:147], v2 offset:28672
    s_addk_i32 s70, 7808
    v_mfma_f32_16x16x32_bf16 v[96:99], a[64:67], v[148:151], v[96:99]
    buffer_load_dwordx4 v3, s[24:27], s70 offen nt lds
    v_mfma_f32_16x16x32_bf16 v[100:103], a[68:71], v[148:151], v[100:103]
    buffer_load_dwordx4 v3, s[28:31], s70 offen offset:1024 nt lds
    v_mfma_f32_16x16x32_bf16 v[104:107], a[72:75], v[148:151], v[104:107]
    ds_read_b128 a[4:7], v158 offset:8192
    v_mfma_f32_16x16x32_bf16 v[108:111], a[76:79], v[148:151], v[108:111]
    ds_read_b128 v[148:151], v2 offset:30720
    v_mfma_f32_16x16x32_bf16 v[112:115], a[64:67], v[152:155], v[112:115]
    v_mfma_f32_16x16x32_bf16 v[116:119], a[68:71], v[152:155], v[116:119]
    v_mfma_f32_16x16x32_bf16 v[120:123], a[72:75], v[152:155], v[120:123]
    v_mfma_f32_16x16x32_bf16 v[124:127], a[76:79], v[152:155], v[124:127]
    ds_read_b128 v[152:155], v2 offset:32768
    s_waitcnt lgkmcnt(5)
    v_mfma_f32_16x16x32_bf16 v[16:19], a[32:35], v[128:131], v[16:19]
    v_mfma_f32_16x16x32_bf16 v[20:23], a[36:39], v[128:131], v[20:23]
    v_mfma_f32_16x16x32_bf16 v[24:27], a[40:43], v[128:131], v[24:27]
    v_mfma_f32_16x16x32_bf16 v[28:31], a[44:47], v[128:131], v[28:31]
    ds_read_b128 v[128:131], v12 offset:20480
    v_mfma_f32_16x16x32_bf16 v[32:35], a[32:35], v[132:135], v[32:35]
    v_mfma_f32_16x16x32_bf16 v[36:39], a[36:39], v[132:135], v[36:39]
    v_mfma_f32_16x16x32_bf16 v[40:43], a[40:43], v[132:135], v[40:43]
    v_mfma_f32_16x16x32_bf16 v[44:47], a[44:47], v[132:135], v[44:47]
    ds_read_b128 v[132:135], v12 offset:22528
    v_mfma_f32_16x16x32_bf16 v[48:51], a[32:35], v[136:139], v[48:51]
    v_mfma_f32_16x16x32_bf16 v[52:55], a[36:39], v[136:139], v[52:55]
    v_mfma_f32_16x16x32_bf16 v[56:59], a[40:43], v[136:139], v[56:59]
    v_mfma_f32_16x16x32_bf16 v[60:63], a[44:47], v[136:139], v[60:63]
    ds_read_b128 v[136:139], v12 offset:24576
    v_mfma_f32_16x16x32_bf16 v[64:67], a[32:35], v[140:143], v[64:67]
    v_mfma_f32_16x16x32_bf16 v[68:71], a[36:39], v[140:143], v[68:71]
    v_mfma_f32_16x16x32_bf16 v[72:75], a[40:43], v[140:143], v[72:75]
    v_mfma_f32_16x16x32_bf16 v[76:79], a[44:47], v[140:143], v[76:79]
    ds_read_b128 v[140:143], v12 offset:26624
    s_waitcnt vmcnt(14)
    s_mov_b32 m0, s52
    s_waitcnt lgkmcnt(3)
    v_mfma_f32_16x16x32_bf16 v[80:83], a[32:35], v[144:147], v[80:83]
    s_addk_i32 s70, 8192
    buffer_load_dwordx4 v3, s[24:27], s70 offen nt lds
    v_mfma_f32_16x16x32_bf16 v[84:87], a[36:39], v[144:147], v[84:87]
    buffer_load_dwordx4 v3, s[28:31], s70 offen offset:1024 nt lds
    v_mfma_f32_16x16x32_bf16 v[88:91], a[40:43], v[144:147], v[88:91]
    ds_read_b128 a[8:11], v4 offset:32768
    v_mfma_f32_16x16x32_bf16 v[92:95], a[44:47], v[144:147], v[92:95]
    ds_read_b128 v[144:147], v12 offset:28672
    v_mfma_f32_16x16x32_bf16 v[96:99], a[32:35], v[148:151], v[96:99]
    ds_read_b128 a[12:15], v15 offset:32768
    v_mfma_f32_16x16x32_bf16 v[100:103], a[36:39], v[148:151], v[100:103]
    v_mfma_f32_16x16x32_bf16 v[104:107], a[40:43], v[148:151], v[104:107]
    v_mfma_f32_16x16x32_bf16 v[108:111], a[44:47], v[148:151], v[108:111]
    ds_read_b128 v[148:151], v12 offset:30720
    v_mfma_f32_16x16x32_bf16 v[112:115], a[32:35], v[152:155], v[112:115]
    v_mfma_f32_16x16x32_bf16 v[116:119], a[36:39], v[152:155], v[116:119]
    v_mfma_f32_16x16x32_bf16 v[120:123], a[40:43], v[152:155], v[120:123]
    v_mfma_f32_16x16x32_bf16 v[124:127], a[44:47], v[152:155], v[124:127]
    ds_read_b128 v[152:155], v12 offset:32768
    v_mfma_f32_16x16x32_bf16 v[16:19], a[80:83], v[128:131], v[16:19]
    v_mfma_f32_16x16x32_bf16 v[20:23], a[84:87], v[128:131], v[20:23]
    v_mfma_f32_16x16x32_bf16 v[24:27], a[88:91], v[128:131], v[24:27]
    v_mfma_f32_16x16x32_bf16 v[28:31], a[92:95], v[128:131], v[28:31]
    s_waitcnt lgkmcnt(2)
    v_mfma_f32_16x16x32_bf16 v[32:35], a[80:83], v[132:135], v[32:35]
    v_mfma_f32_16x16x32_bf16 v[36:39], a[84:87], v[132:135], v[36:39]
    v_mfma_f32_16x16x32_bf16 v[40:43], a[88:91], v[132:135], v[40:43]
    v_mfma_f32_16x16x32_bf16 v[44:47], a[92:95], v[132:135], v[44:47]
    v_mfma_f32_16x16x32_bf16 v[48:51], a[80:83], v[136:139], v[48:51]
    v_mfma_f32_16x16x32_bf16 v[52:55], a[84:87], v[136:139], v[52:55]
    v_mfma_f32_16x16x32_bf16 v[56:59], a[88:91], v[136:139], v[56:59]
    v_mfma_f32_16x16x32_bf16 v[60:63], a[92:95], v[136:139], v[60:63]
    v_mfma_f32_16x16x32_bf16 v[64:67], a[80:83], v[140:143], v[64:67]
    s_waitcnt vmcnt(14)
    ds_read_b128 a[16:19], v156 offset:16384
    s_mov_b32 m0, s60
    v_mfma_f32_16x16x32_bf16 v[68:71], a[84:87], v[140:143], v[68:71]
    s_addk_i32 s70, -8064
    buffer_load_dwordx4 v3, s[24:27], s70 offen nt lds
    v_mfma_f32_16x16x32_bf16 v[72:75], a[88:91], v[140:143], v[72:75]
    buffer_load_dwordx4 v3, s[28:31], s70 offen offset:1024 nt lds
    v_mfma_f32_16x16x32_bf16 v[76:79], a[92:95], v[140:143], v[76:79]
    ds_read_b128 a[20:23], v158 offset:16384
    v_mfma_f32_16x16x32_bf16 v[80:83], a[80:83], v[144:147], v[80:83]
    v_mfma_f32_16x16x32_bf16 v[84:87], a[84:87], v[144:147], v[84:87]
    v_mfma_f32_16x16x32_bf16 v[88:91], a[88:91], v[144:147], v[88:91]
    v_mfma_f32_16x16x32_bf16 v[92:95], a[92:95], v[144:147], v[92:95]
    s_waitcnt lgkmcnt(2)
    v_mfma_f32_16x16x32_bf16 v[96:99], a[80:83], v[148:151], v[96:99]
    v_mfma_f32_16x16x32_bf16 v[100:103], a[84:87], v[148:151], v[100:103]
    v_mfma_f32_16x16x32_bf16 v[104:107], a[88:91], v[148:151], v[104:107]
    v_mfma_f32_16x16x32_bf16 v[108:111], a[92:95], v[148:151], v[108:111]
    v_mfma_f32_16x16x32_bf16 v[112:115], a[80:83], v[152:155], v[112:115]
    v_mfma_f32_16x16x32_bf16 v[116:119], a[84:87], v[152:155], v[116:119]
    v_mfma_f32_16x16x32_bf16 v[120:123], a[88:91], v[152:155], v[120:123]
    v_mfma_f32_16x16x32_bf16 v[124:127], a[92:95], v[152:155], v[124:127]
    v_bfe_u32 v13, v10, 4, 1
    v_lshl_add_u32 v11, v13, 3, v0
    s_mul_i32 s3, s66, 14336
    s_add_u32 s3, s3, 43008
    v_add_u32 v11, s3, v11
    v_xor_b32 v12, 8, v11
    s_barrier
    v_cvt_pk_bf16_f32 v164, v16, v17
    v_cvt_pk_bf16_f32 v165, v18, v19
    ds_write_b64 v11, v[164:165] offset:0
    v_cvt_pk_bf16_f32 v166, v20, v21
    v_cvt_pk_bf16_f32 v167, v22, v23
    ds_write_b64 v12, v[166:167] offset:0
    v_cvt_pk_bf16_f32 v168, v24, v25
    v_cvt_pk_bf16_f32 v169, v26, v27
    ds_write_b64 v11, v[168:169] offset:7168
    v_cvt_pk_bf16_f32 v170, v28, v29
    v_cvt_pk_bf16_f32 v171, v30, v31
    ds_write_b64 v12, v[170:171] offset:7168
    v_cvt_pk_bf16_f32 v172, v32, v33
    v_cvt_pk_bf16_f32 v173, v34, v35
    ds_write_b64 v11, v[172:173] offset:1024
    v_cvt_pk_bf16_f32 v174, v36, v37
    v_cvt_pk_bf16_f32 v175, v38, v39
    ds_write_b64 v12, v[174:175] offset:1024
    v_cvt_pk_bf16_f32 v176, v40, v41
    v_cvt_pk_bf16_f32 v177, v42, v43
    ds_write_b64 v11, v[176:177] offset:8192
    v_cvt_pk_bf16_f32 v178, v44, v45
    v_cvt_pk_bf16_f32 v179, v46, v47
    ds_write_b64 v12, v[178:179] offset:8192
    v_cvt_pk_bf16_f32 v180, v48, v49
    v_cvt_pk_bf16_f32 v181, v50, v51
    ds_write_b64 v11, v[180:181] offset:2048
    v_cvt_pk_bf16_f32 v182, v52, v53
    v_cvt_pk_bf16_f32 v183, v54, v55
    ds_write_b64 v12, v[182:183] offset:2048
    v_cvt_pk_bf16_f32 v184, v56, v57
    v_cvt_pk_bf16_f32 v185, v58, v59
    ds_write_b64 v11, v[184:185] offset:9216
    v_cvt_pk_bf16_f32 v186, v60, v61
    v_cvt_pk_bf16_f32 v187, v62, v63
    ds_write_b64 v12, v[186:187] offset:9216
    v_cvt_pk_bf16_f32 v188, v64, v65
    v_cvt_pk_bf16_f32 v189, v66, v67
    ds_write_b64 v11, v[188:189] offset:3072
    v_cvt_pk_bf16_f32 v190, v68, v69
    v_cvt_pk_bf16_f32 v191, v70, v71
    ds_write_b64 v12, v[190:191] offset:3072
    s_waitcnt vmcnt(14)
    ds_read_b128 a[24:27], v4 offset:40960
    s_mov_b32 m0, s54
    v_cvt_pk_bf16_f32 v192, v72, v73
    v_cvt_pk_bf16_f32 v193, v74, v75
    ds_write_b64 v11, v[192:193] offset:10240
    v_cvt_pk_bf16_f32 v194, v76, v77
    v_cvt_pk_bf16_f32 v195, v78, v79
    ds_write_b64 v12, v[194:195] offset:10240
    s_addk_i32 s70, 8192
    buffer_load_dwordx4 v3, s[24:27], s70 offen nt lds
    v_cvt_pk_bf16_f32 v164, v80, v81
    v_cvt_pk_bf16_f32 v165, v82, v83
    ds_write_b64 v11, v[164:165] offset:4096
    v_cvt_pk_bf16_f32 v166, v84, v85
    v_cvt_pk_bf16_f32 v167, v86, v87
    ds_write_b64 v12, v[166:167] offset:4096
    buffer_load_dwordx4 v3, s[28:31], s70 offen offset:1024 nt lds
    v_cvt_pk_bf16_f32 v168, v88, v89
    v_cvt_pk_bf16_f32 v169, v90, v91
    ds_write_b64 v11, v[168:169] offset:11264
    v_cvt_pk_bf16_f32 v170, v92, v93
    v_cvt_pk_bf16_f32 v171, v94, v95
    ds_write_b64 v12, v[170:171] offset:11264
    ds_read_b128 a[28:31], v15 offset:40960
    v_cvt_pk_bf16_f32 v172, v96, v97
    v_cvt_pk_bf16_f32 v173, v98, v99
    ds_write_b64 v11, v[172:173] offset:5120
    v_cvt_pk_bf16_f32 v174, v100, v101
    v_cvt_pk_bf16_f32 v175, v102, v103
    ds_write_b64 v12, v[174:175] offset:5120
    v_cvt_pk_bf16_f32 v176, v104, v105
    v_cvt_pk_bf16_f32 v177, v106, v107
    ds_write_b64 v11, v[176:177] offset:12288
    v_cvt_pk_bf16_f32 v178, v108, v109
    v_cvt_pk_bf16_f32 v179, v110, v111
    ds_write_b64 v12, v[178:179] offset:12288
    v_cvt_pk_bf16_f32 v180, v112, v113
    v_cvt_pk_bf16_f32 v181, v114, v115
    ds_write_b64 v11, v[180:181] offset:6144
    v_cvt_pk_bf16_f32 v182, v116, v117
    v_cvt_pk_bf16_f32 v183, v118, v119
    ds_write_b64 v12, v[182:183] offset:6144
    v_cvt_pk_bf16_f32 v184, v120, v121
    v_cvt_pk_bf16_f32 v185, v122, v123
    ds_write_b64 v11, v[184:185] offset:13312
    v_cvt_pk_bf16_f32 v186, v124, v125
    v_cvt_pk_bf16_f32 v187, v126, v127
    ds_write_b64 v12, v[186:187] offset:13312
    v_lshrrev_b32 v24, 2, v10
    v_and_b32 v24, 7, v24
    v_and_b32 v25, 3, v10
    v_lshrrev_b32 v16, 5, v10
    v_lshlrev_b32 v17, 1, v13
    v_xor_b32 v18, v25, v17
    v_lshlrev_b32 v18, 4, v18
    v_lshl_add_u32 v18, v16, 6, v18
    v_lshl_add_u32 v18, v24, 9, v18
    s_lshl_b32 s3, s66, 7
    v_add_u32 v5, s3, v18
    v_lshlrev_b32 v18, 6, v24
    v_lshl_add_u32 v18, v16, 10, v18
    v_lshrrev_b32 v19, 1, v25
    v_add_u32 v19, v19, v17
    v_lshl_add_u32 v18, v19, 4, v18
    v_and_b32 v19, 1, v25
    v_lshl_add_u32 v18, v19, 3, v18
    v_add_u32 v6, s52, v18
    v_xor_b32 v7, 32, v6
    v_mov_b32 v1, v156
    v_mov_b32 v252, v15
    v_mov_b32 v253, v158
    v_add_u32 v2, 43008, v0
    s_mul_i32 s3, s6, 229376
    s_add_u32 s40, s96, s3
    s_addc_u32 s41, s97, 0
    s_and_b32 s41, s41, 0xffff
    s_mov_b32 s42, 229376
    s_mov_b32 s43, 0x20000
    s_add_u32 s44, s40, 6144
    s_addc_u32 s45, s41, 0
    s_mov_b32 s46, 223232
    s_mov_b32 s47, 0x20000
    s_waitcnt lgkmcnt(0)
    s_barrier
    ds_read_b128 v[232:235], v2 offset:0
    ds_read_b128 v[236:239], v2 offset:1024
    ds_read_b128 v[240:243], v2 offset:2048
    ds_read_b128 v[244:247], v2 offset:3072
    s_waitcnt lgkmcnt(3)
    v_mfma_f32_16x16x32_bf16 v[8:11], a[0:3], v[232:235], 0
    ds_read_b128 v[248:251], v2 offset:4096
    v_mfma_f32_16x16x32_bf16 v[12:15], a[8:11], v[232:235], 0
    s_waitcnt lgkmcnt(3)
    v_mfma_f32_16x16x32_bf16 v[40:43], a[0:3], v[236:239], 0
    ds_read_b128 v[232:235], v2 offset:5120
    v_mfma_f32_16x16x32_bf16 v[44:47], a[8:11], v[236:239], 0
    s_waitcnt lgkmcnt(3)
    v_mfma_f32_16x16x32_bf16 v[72:75], a[0:3], v[240:243], 0
    ds_read_b128 v[236:239], v2 offset:6144
    v_mfma_f32_16x16x32_bf16 v[76:79], a[8:11], v[240:243], 0
    s_waitcnt lgkmcnt(2)
    v_mfma_f32_16x16x32_bf16 v[104:107], a[0:3], v[244:247], 0
    ds_read_b128 v[240:243], v2 offset:7168
    s_waitcnt vmcnt(14)
    s_mov_b32 m0, s61
    v_mfma_f32_16x16x32_bf16 v[108:111], a[8:11], v[244:247], 0
    s_addk_i32 s70, -8064
    buffer_load_dwordx4 v3, s[24:27], s70 offen nt lds
    v_mfma_f32_16x16x32_bf16 v[136:139], a[0:3], v[248:251], 0
    ds_read_b128 v[244:247], v2 offset:8192
    v_mfma_f32_16x16x32_bf16 v[140:143], a[8:11], v[248:251], 0
    buffer_load_dwordx4 v3, s[28:31], s70 offen offset:1024 nt lds
    s_waitcnt lgkmcnt(2)
    v_mfma_f32_16x16x32_bf16 v[168:171], a[0:3], v[232:235], 0
    ds_read_b128 v[248:251], v2 offset:9216
    v_mfma_f32_16x16x32_bf16 v[172:175], a[8:11], v[232:235], 0
    ds_read_b128 a[32:35], v1 offset:24576
    v_mfma_f32_16x16x32_bf16 v[200:203], a[0:3], v[236:239], 0
    ds_read_b128 v[232:235], v2 offset:10240
    v_mfma_f32_16x16x32_bf16 v[204:207], a[8:11], v[236:239], 0
    ds_read_b128 a[36:39], v253 offset:24576
    s_waitcnt lgkmcnt(4)
    v_mfma_f32_16x16x32_bf16 v[8:11], a[4:7], v[240:243], v[8:11]
    ds_read_b128 v[236:239], v2 offset:11264
    v_mfma_f32_16x16x32_bf16 v[12:15], a[12:15], v[240:243], v[12:15]
    v_mfma_f32_16x16x32_bf16 v[40:43], a[4:7], v[244:247], v[40:43]
    ds_read_b128 v[240:243], v2 offset:12288
    v_mfma_f32_16x16x32_bf16 v[44:47], a[12:15], v[244:247], v[44:47]
    s_waitcnt lgkmcnt(3)
    v_mfma_f32_16x16x32_bf16 v[72:75], a[4:7], v[248:251], v[72:75]
    ds_read_b128 v[244:247], v2 offset:13312
    v_mfma_f32_16x16x32_bf16 v[76:79], a[12:15], v[248:251], v[76:79]
    v_mfma_f32_16x16x32_bf16 v[104:107], a[4:7], v[232:235], v[104:107]
    ds_read_b128 v[248:251], v2 offset:14336
    v_mfma_f32_16x16x32_bf16 v[108:111], a[12:15], v[232:235], v[108:111]
    s_waitcnt lgkmcnt(2)
    v_mfma_f32_16x16x32_bf16 v[136:139], a[4:7], v[236:239], v[136:139]
    ds_read_b128 v[232:235], v2 offset:15360
    v_mfma_f32_16x16x32_bf16 v[140:143], a[12:15], v[236:239], v[140:143]
    v_mfma_f32_16x16x32_bf16 v[168:171], a[4:7], v[240:243], v[168:171]
    ds_read_b128 v[236:239], v2 offset:16384
    v_mfma_f32_16x16x32_bf16 v[172:175], a[12:15], v[240:243], v[172:175]
    s_waitcnt lgkmcnt(2)
    v_mfma_f32_16x16x32_bf16 v[200:203], a[4:7], v[244:247], v[200:203]
    ds_read_b128 v[240:243], v2 offset:17408
    v_mfma_f32_16x16x32_bf16 v[204:207], a[12:15], v[244:247], v[204:207]
    v_mfma_f32_16x16x32_bf16 v[8:11], a[16:19], v[248:251], v[8:11]
    ds_read_b128 v[244:247], v2 offset:18432
    v_mfma_f32_16x16x32_bf16 v[12:15], a[24:27], v[248:251], v[12:15]
    s_waitcnt lgkmcnt(2)
    v_mfma_f32_16x16x32_bf16 v[40:43], a[16:19], v[232:235], v[40:43]
    ds_read_b128 v[248:251], v2 offset:19456
    v_mfma_f32_16x16x32_bf16 v[44:47], a[24:27], v[232:235], v[44:47]
    s_waitcnt vmcnt(14)
    ds_read_b128 a[40:43], v1 offset:32768
    s_mov_b32 m0, s62
    v_mfma_f32_16x16x32_bf16 v[72:75], a[16:19], v[236:239], v[72:75]
    ds_read_b128 v[232:235], v2 offset:20480
    s_addk_i32 s70, 8192
    v_mfma_f32_16x16x32_bf16 v[76:79], a[24:27], v[236:239], v[76:79]
    buffer_load_dwordx4 v3, s[24:27], s70 offen nt lds
    s_waitcnt lgkmcnt(3)
    v_mfma_f32_16x16x32_bf16 v[104:107], a[16:19], v[240:243], v[104:107]
    ds_read_b128 v[236:239], v2 offset:21504
    v_mfma_f32_16x16x32_bf16 v[108:111], a[24:27], v[240:243], v[108:111]
    buffer_load_dwordx4 v3, s[28:31], s70 offen offset:1024 nt lds
    v_mfma_f32_16x16x32_bf16 v[136:139], a[16:19], v[244:247], v[136:139]
    ds_read_b128 v[240:243], v2 offset:22528
    v_mfma_f32_16x16x32_bf16 v[140:143], a[24:27], v[244:247], v[140:143]
    ds_read_b128 a[44:47], v253 offset:32768
    s_waitcnt lgkmcnt(3)
    v_mfma_f32_16x16x32_bf16 v[168:171], a[16:19], v[248:251], v[168:171]
    ds_read_b128 v[244:247], v2 offset:23552
    v_mfma_f32_16x16x32_bf16 v[172:175], a[24:27], v[248:251], v[172:175]
    v_mfma_f32_16x16x32_bf16 v[200:203], a[16:19], v[232:235], v[200:203]
    ds_read_b128 v[248:251], v2 offset:24576
    v_mfma_f32_16x16x32_bf16 v[204:207], a[24:27], v[232:235], v[204:207]
    s_waitcnt lgkmcnt(3)
    v_mfma_f32_16x16x32_bf16 v[8:11], a[20:23], v[236:239], v[8:11]
    ds_read_b128 v[232:235], v2 offset:25600
    v_mfma_f32_16x16x32_bf16 v[12:15], a[28:31], v[236:239], v[12:15]
    v_mfma_f32_16x16x32_bf16 v[40:43], a[20:23], v[240:243], v[40:43]
    ds_read_b128 v[236:239], v2 offset:26624
    v_mfma_f32_16x16x32_bf16 v[44:47], a[28:31], v[240:243], v[44:47]
    s_waitcnt lgkmcnt(2)
    v_mfma_f32_16x16x32_bf16 v[72:75], a[20:23], v[244:247], v[72:75]
    ds_read_b128 v[240:243], v2 offset:27648
    v_mfma_f32_16x16x32_bf16 v[76:79], a[28:31], v[244:247], v[76:79]
    v_mfma_f32_16x16x32_bf16 v[104:107], a[20:23], v[248:251], v[104:107]
    ds_read_b128 v[244:247], v2 offset:28672
    v_mfma_f32_16x16x32_bf16 v[108:111], a[28:31], v[248:251], v[108:111]
    s_waitcnt lgkmcnt(2)
    v_mfma_f32_16x16x32_bf16 v[136:139], a[20:23], v[232:235], v[136:139]
    ds_read_b128 v[248:251], v2 offset:29696
    v_mfma_f32_16x16x32_bf16 v[140:143], a[28:31], v[232:235], v[140:143]
    v_mfma_f32_16x16x32_bf16 v[168:171], a[20:23], v[236:239], v[168:171]
    ds_read_b128 v[232:235], v2 offset:30720
    v_mfma_f32_16x16x32_bf16 v[172:175], a[28:31], v[236:239], v[172:175]
    s_waitcnt lgkmcnt(2)
    v_mfma_f32_16x16x32_bf16 v[200:203], a[20:23], v[240:243], v[200:203]
    ds_read_b128 v[236:239], v2 offset:31744
    v_mfma_f32_16x16x32_bf16 v[204:207], a[28:31], v[240:243], v[204:207]
    v_mfma_f32_16x16x32_bf16 v[8:11], a[32:35], v[244:247], v[8:11]
    ds_read_b128 v[240:243], v2 offset:32768
    s_waitcnt vmcnt(14)
    s_mov_b32 m0, s63
    v_mfma_f32_16x16x32_bf16 v[12:15], a[40:43], v[244:247], v[12:15]
    s_addk_i32 s70, -8064
    buffer_load_dwordx4 v3, s[24:27], s70 offen nt lds
    s_waitcnt lgkmcnt(2)
    v_mfma_f32_16x16x32_bf16 v[40:43], a[32:35], v[248:251], v[40:43]
    ds_read_b128 v[244:247], v2 offset:33792
    v_mfma_f32_16x16x32_bf16 v[44:47], a[40:43], v[248:251], v[44:47]
    buffer_load_dwordx4 v3, s[28:31], s70 offen offset:1024 nt lds
    v_mfma_f32_16x16x32_bf16 v[72:75], a[32:35], v[232:235], v[72:75]
    ds_read_b128 v[248:251], v2 offset:34816
    v_mfma_f32_16x16x32_bf16 v[76:79], a[40:43], v[232:235], v[76:79]
    ds_read_b128 a[0:3], v4 offset:8192
    s_waitcnt lgkmcnt(3)
    v_mfma_f32_16x16x32_bf16 v[104:107], a[32:35], v[236:239], v[104:107]
    ds_read_b128 v[232:235], v2 offset:35840
    v_mfma_f32_16x16x32_bf16 v[108:111], a[40:43], v[236:239], v[108:111]
    ds_read_b128 a[4:7], v252 offset:8192
    v_mfma_f32_16x16x32_bf16 v[136:139], a[32:35], v[240:243], v[136:139]
    ds_read_b128 v[236:239], v2 offset:36864
    v_mfma_f32_16x16x32_bf16 v[140:143], a[40:43], v[240:243], v[140:143]
    s_waitcnt lgkmcnt(4)
    v_mfma_f32_16x16x32_bf16 v[168:171], a[32:35], v[244:247], v[168:171]
    ds_read_b128 v[240:243], v2 offset:37888
    v_mfma_f32_16x16x32_bf16 v[172:175], a[40:43], v[244:247], v[172:175]
    v_mfma_f32_16x16x32_bf16 v[200:203], a[32:35], v[248:251], v[200:203]
    ds_read_b128 v[244:247], v2 offset:38912
    s_waitcnt vmcnt(14)
    s_mov_b32 m0, s55
    v_mfma_f32_16x16x32_bf16 v[204:207], a[40:43], v[248:251], v[204:207]
    s_addk_i32 s70, 8192
    buffer_load_dwordx4 v3, s[24:27], s70 offen nt lds
    s_waitcnt lgkmcnt(0)
    v_mfma_f32_16x16x32_bf16 v[8:11], a[36:39], v[232:235], v[8:11]
    ds_read_b128 v[248:251], v2 offset:39936
    v_mfma_f32_16x16x32_bf16 v[12:15], a[44:47], v[232:235], v[12:15]
    buffer_load_dwordx4 v3, s[28:31], s70 offen offset:1024 nt lds
    v_mfma_f32_16x16x32_bf16 v[40:43], a[36:39], v[236:239], v[40:43]
    ds_read_b128 v[232:235], v2 offset:40960
    v_mfma_f32_16x16x32_bf16 v[44:47], a[44:47], v[236:239], v[44:47]
    ds_read_b128 a[8:11], v4 offset:49152
    v_mfma_f32_16x16x32_bf16 v[72:75], a[36:39], v[240:243], v[72:75]
    ds_read_b128 v[236:239], v2 offset:41984
    v_mfma_f32_16x16x32_bf16 v[76:79], a[44:47], v[240:243], v[76:79]
    ds_read_b128 a[12:15], v252 offset:49152
    v_mfma_f32_16x16x32_bf16 v[104:107], a[36:39], v[244:247], v[104:107]
    ds_read_b128 v[240:243], v2 offset:43008
    v_mfma_f32_16x16x32_bf16 v[108:111], a[44:47], v[244:247], v[108:111]
    s_waitcnt lgkmcnt(4)
    v_mfma_f32_16x16x32_bf16 v[136:139], a[36:39], v[248:251], v[136:139]
    ds_read_b128 v[244:247], v2 offset:44032
    v_mfma_f32_16x16x32_bf16 v[140:143], a[44:47], v[248:251], v[140:143]
    v_mfma_f32_16x16x32_bf16 v[168:171], a[36:39], v[232:235], v[168:171]
    ds_read_b128 v[248:251], v2 offset:45056
    v_mfma_f32_16x16x32_bf16 v[172:175], a[44:47], v[232:235], v[172:175]
    s_waitcnt lgkmcnt(2)
    v_mfma_f32_16x16x32_bf16 v[200:203], a[36:39], v[236:239], v[200:203]
    ds_read_b128 v[232:235], v2 offset:46080
    v_mfma_f32_16x16x32_bf16 v[204:207], a[44:47], v[236:239], v[204:207]
    v_mfma_f32_16x16x32_bf16 v[8:11], a[0:3], v[240:243], v[8:11]
    ds_read_b128 v[236:239], v2 offset:47104
    v_mfma_f32_16x16x32_bf16 v[12:15], a[8:11], v[240:243], v[12:15]
    s_waitcnt lgkmcnt(2)
    v_mfma_f32_16x16x32_bf16 v[40:43], a[0:3], v[244:247], v[40:43]
    ds_read_b128 v[240:243], v2 offset:48128
    v_mfma_f32_16x16x32_bf16 v[44:47], a[8:11], v[244:247], v[44:47]
    v_mfma_f32_16x16x32_bf16 v[72:75], a[0:3], v[248:251], v[72:75]
    ds_read_b128 v[244:247], v2 offset:49152
    v_mfma_f32_16x16x32_bf16 v[76:79], a[8:11], v[248:251], v[76:79]
    s_waitcnt lgkmcnt(2)
    v_mfma_f32_16x16x32_bf16 v[104:107], a[0:3], v[232:235], v[104:107]
    ds_read_b128 v[248:251], v2 offset:50176
    v_mfma_f32_16x16x32_bf16 v[108:111], a[8:11], v[232:235], v[108:111]
    v_mfma_f32_16x16x32_bf16 v[136:139], a[0:3], v[236:239], v[136:139]
    ds_read_b128 v[232:235], v2 offset:51200
    v_mfma_f32_16x16x32_bf16 v[140:143], a[8:11], v[236:239], v[140:143]
    s_waitcnt lgkmcnt(2)
    v_mfma_f32_16x16x32_bf16 v[168:171], a[0:3], v[240:243], v[168:171]
    ds_read_b128 v[236:239], v2 offset:52224
    s_waitcnt vmcnt(14)
    s_mov_b32 m0, s53
    v_mfma_f32_16x16x32_bf16 v[172:175], a[8:11], v[240:243], v[172:175]
    s_addk_i32 s70, 7808
    buffer_load_dwordx4 v3, s[24:27], s70 offen nt lds
    v_mfma_f32_16x16x32_bf16 v[200:203], a[0:3], v[244:247], v[200:203]
    ds_read_b128 v[240:243], v2 offset:53248
    v_mfma_f32_16x16x32_bf16 v[204:207], a[8:11], v[244:247], v[204:207]
    buffer_load_dwordx4 v3, s[28:31], s70 offen offset:1024 nt lds
    s_waitcnt lgkmcnt(2)
    v_mfma_f32_16x16x32_bf16 v[8:11], a[4:7], v[248:251], v[8:11]
    ds_read_b128 v[244:247], v2 offset:54272
    v_mfma_f32_16x16x32_bf16 v[12:15], a[12:15], v[248:251], v[12:15]
    ds_read_b128 a[16:19], v1 offset:0
    v_mfma_f32_16x16x32_bf16 v[40:43], a[4:7], v[232:235], v[40:43]
    ds_read_b128 v[248:251], v2 offset:55296
    v_mfma_f32_16x16x32_bf16 v[44:47], a[12:15], v[232:235], v[44:47]
    ds_read_b128 a[20:23], v253 offset:0
    s_waitcnt vmcnt(14)
    s_mov_b32 m0, s56
    s_waitcnt lgkmcnt(0)
    v_mfma_f32_16x16x32_bf16 v[72:75], a[4:7], v[236:239], v[72:75]
    ds_read_b128 v[232:235], v2 offset:56320
    s_addk_i32 s70, 8192
    v_mfma_f32_16x16x32_bf16 v[76:79], a[12:15], v[236:239], v[76:79]
    buffer_load_dwordx4 v3, s[24:27], s70 offen nt lds
    v_mfma_f32_16x16x32_bf16 v[104:107], a[4:7], v[240:243], v[104:107]
    ds_read_b128 v[236:239], v2 offset:0
    v_mfma_f32_16x16x32_bf16 v[108:111], a[12:15], v[240:243], v[108:111]
    buffer_load_dwordx4 v3, s[28:31], s70 offen offset:1024 nt lds
    v_mfma_f32_16x16x32_bf16 v[136:139], a[4:7], v[244:247], v[136:139]
    ds_read_b128 v[240:243], v2 offset:1024
    v_mfma_f32_16x16x32_bf16 v[140:143], a[12:15], v[244:247], v[140:143]
    ds_read_b128 a[24:27], v4 offset:0
    v_mfma_f32_16x16x32_bf16 v[168:171], a[4:7], v[248:251], v[168:171]
    ds_read_b128 v[244:247], v2 offset:2048
    v_mfma_f32_16x16x32_bf16 v[172:175], a[12:15], v[248:251], v[172:175]
    ds_read_b128 a[28:31], v252 offset:0
    s_waitcnt lgkmcnt(4)
    v_mfma_f32_16x16x32_bf16 v[200:203], a[4:7], v[232:235], v[200:203]
    ds_read_b128 v[248:251], v2 offset:3072
    v_mfma_f32_16x16x32_bf16 v[204:207], a[12:15], v[232:235], v[204:207]
    v_mfma_f32_16x16x32_bf16 v[16:19], a[16:19], v[236:239], 0
    ds_read_b128 v[232:235], v2 offset:4096
    s_waitcnt lgkmcnt(2)
    v_mfma_f32_16x16x32_bf16 v[20:23], a[24:27], v[236:239], 0
    v_mfma_f32_16x16x32_bf16 v[48:51], a[16:19], v[240:243], 0
    ds_read_b128 v[236:239], v2 offset:5120
    v_mfma_f32_16x16x32_bf16 v[52:55], a[24:27], v[240:243], 0
    v_mfma_f32_16x16x32_bf16 v[80:83], a[16:19], v[244:247], 0
    ds_read_b128 v[240:243], v2 offset:6144
    v_mfma_f32_16x16x32_bf16 v[84:87], a[24:27], v[244:247], 0
    s_waitcnt lgkmcnt(2)
    v_mfma_f32_16x16x32_bf16 v[112:115], a[16:19], v[248:251], 0
    ds_read_b128 v[244:247], v2 offset:7168
    v_mfma_f32_16x16x32_bf16 v[116:119], a[24:27], v[248:251], 0
    v_mfma_f32_16x16x32_bf16 v[144:147], a[16:19], v[232:235], 0
    ds_read_b128 v[248:251], v2 offset:8192
    v_mfma_f32_16x16x32_bf16 v[148:151], a[24:27], v[232:235], 0
    s_waitcnt lgkmcnt(2)
    v_mfma_f32_16x16x32_bf16 v[176:179], a[16:19], v[236:239], 0
    ds_read_b128 v[232:235], v2 offset:9216
    v_mfma_f32_16x16x32_bf16 v[180:183], a[24:27], v[236:239], 0
    v_mfma_f32_16x16x32_bf16 v[208:211], a[16:19], v[240:243], 0
    ds_read_b128 v[236:239], v2 offset:10240
    s_waitcnt vmcnt(14)
    s_mov_b32 m0, s59
    v_mfma_f32_16x16x32_bf16 v[212:215], a[24:27], v[240:243], 0
    s_addk_i32 s70, -8064
    buffer_load_dwordx4 v3, s[24:27], s70 offen nt lds
    s_waitcnt lgkmcnt(1)
    v_mfma_f32_16x16x32_bf16 v[16:19], a[20:23], v[244:247], v[16:19]
    ds_read_b128 v[240:243], v2 offset:11264
    v_mfma_f32_16x16x32_bf16 v[20:23], a[28:31], v[244:247], v[20:23]
    buffer_load_dwordx4 v3, s[28:31], s70 offen offset:1024 nt lds
    v_mfma_f32_16x16x32_bf16 v[48:51], a[20:23], v[248:251], v[48:51]
    ds_read_b128 v[244:247], v2 offset:12288
    v_mfma_f32_16x16x32_bf16 v[52:55], a[28:31], v[248:251], v[52:55]
    ds_read_b128 a[0:3], v1 offset:8192
    v_mfma_f32_16x16x32_bf16 v[80:83], a[20:23], v[232:235], v[80:83]
    ds_read_b128 v[248:251], v2 offset:13312
    v_mfma_f32_16x16x32_bf16 v[84:87], a[28:31], v[232:235], v[84:87]
    ds_read_b128 a[4:7], v253 offset:8192
    s_waitcnt vmcnt(14)
    s_mov_b32 m0, s52
    s_waitcnt lgkmcnt(0)
    v_mfma_f32_16x16x32_bf16 v[112:115], a[20:23], v[236:239], v[112:115]
    ds_read_b128 v[232:235], v2 offset:14336
    s_addk_i32 s70, 8192
    v_mfma_f32_16x16x32_bf16 v[116:119], a[28:31], v[236:239], v[116:119]
    buffer_load_dwordx4 v3, s[24:27], s70 offen nt lds
    v_mfma_f32_16x16x32_bf16 v[144:147], a[20:23], v[240:243], v[144:147]
    ds_read_b128 v[236:239], v2 offset:15360
    v_mfma_f32_16x16x32_bf16 v[148:151], a[28:31], v[240:243], v[148:151]
    buffer_load_dwordx4 v3, s[28:31], s70 offen offset:1024 nt lds
    v_mfma_f32_16x16x32_bf16 v[176:179], a[20:23], v[244:247], v[176:179]
    ds_read_b128 v[240:243], v2 offset:16384
    v_mfma_f32_16x16x32_bf16 v[180:183], a[28:31], v[244:247], v[180:183]
    ds_read_b128 a[8:11], v4 offset:16384
    v_mfma_f32_16x16x32_bf16 v[208:211], a[20:23], v[248:251], v[208:211]
    ds_read_b128 v[244:247], v2 offset:17408
    v_mfma_f32_16x16x32_bf16 v[212:215], a[28:31], v[248:251], v[212:215]
    ds_read_b128 a[12:15], v252 offset:16384
    s_waitcnt lgkmcnt(4)
    v_mfma_f32_16x16x32_bf16 v[16:19], a[0:3], v[232:235], v[16:19]
    ds_read_b128 v[248:251], v2 offset:18432
    s_waitcnt lgkmcnt(1)
    v_mfma_f32_16x16x32_bf16 v[20:23], a[8:11], v[232:235], v[20:23]
    v_mfma_f32_16x16x32_bf16 v[48:51], a[0:3], v[236:239], v[48:51]
    ds_read_b128 v[232:235], v2 offset:19456
    v_mfma_f32_16x16x32_bf16 v[52:55], a[8:11], v[236:239], v[52:55]
    v_mfma_f32_16x16x32_bf16 v[80:83], a[0:3], v[240:243], v[80:83]
    ds_read_b128 v[236:239], v2 offset:20480
    v_mfma_f32_16x16x32_bf16 v[84:87], a[8:11], v[240:243], v[84:87]
    v_mfma_f32_16x16x32_bf16 v[112:115], a[0:3], v[244:247], v[112:115]
    ds_read_b128 v[240:243], v2 offset:21504
    v_mfma_f32_16x16x32_bf16 v[116:119], a[8:11], v[244:247], v[116:119]
    s_waitcnt lgkmcnt(2)
    v_mfma_f32_16x16x32_bf16 v[144:147], a[0:3], v[248:251], v[144:147]
    ds_read_b128 v[244:247], v2 offset:22528
    v_mfma_f32_16x16x32_bf16 v[148:151], a[8:11], v[248:251], v[148:151]
    v_mfma_f32_16x16x32_bf16 v[176:179], a[0:3], v[232:235], v[176:179]
    ds_read_b128 v[248:251], v2 offset:23552
    v_mfma_f32_16x16x32_bf16 v[180:183], a[8:11], v[232:235], v[180:183]
    s_waitcnt lgkmcnt(2)
    v_mfma_f32_16x16x32_bf16 v[208:211], a[0:3], v[236:239], v[208:211]
    ds_read_b128 v[232:235], v2 offset:24576
    s_waitcnt vmcnt(14)
    s_mov_b32 m0, s60
    v_mfma_f32_16x16x32_bf16 v[212:215], a[8:11], v[236:239], v[212:215]
    s_addk_i32 s70, -8064
    buffer_load_dwordx4 v3, s[24:27], s70 offen nt lds
    v_mfma_f32_16x16x32_bf16 v[16:19], a[4:7], v[240:243], v[16:19]
    ds_read_b128 v[236:239], v2 offset:25600
    v_mfma_f32_16x16x32_bf16 v[20:23], a[12:15], v[240:243], v[20:23]
    buffer_load_dwordx4 v3, s[28:31], s70 offen offset:1024 nt lds
    s_waitcnt lgkmcnt(1)
    v_mfma_f32_16x16x32_bf16 v[48:51], a[4:7], v[244:247], v[48:51]
    ds_read_b128 v[240:243], v2 offset:26624
    v_mfma_f32_16x16x32_bf16 v[52:55], a[12:15], v[244:247], v[52:55]
    ds_read_b128 a[16:19], v1 offset:16384
    v_mfma_f32_16x16x32_bf16 v[80:83], a[4:7], v[248:251], v[80:83]
    ds_read_b128 v[244:247], v2 offset:27648
    v_mfma_f32_16x16x32_bf16 v[84:87], a[12:15], v[248:251], v[84:87]
    ds_read_b128 a[20:23], v253 offset:16384
    s_waitcnt vmcnt(14)
    s_mov_b32 m0, s54
    v_mfma_f32_16x16x32_bf16 v[112:115], a[4:7], v[232:235], v[112:115]
    ds_read_b128 v[248:251], v2 offset:28672
    s_addk_i32 s70, 8192
    v_mfma_f32_16x16x32_bf16 v[116:119], a[12:15], v[232:235], v[116:119]
    buffer_load_dwordx4 v3, s[24:27], s70 offen nt lds
    s_waitcnt lgkmcnt(1)
    v_mfma_f32_16x16x32_bf16 v[144:147], a[4:7], v[236:239], v[144:147]
    ds_read_b128 v[232:235], v2 offset:29696
    v_mfma_f32_16x16x32_bf16 v[148:151], a[12:15], v[236:239], v[148:151]
    buffer_load_dwordx4 v3, s[28:31], s70 offen offset:1024 nt lds
    v_mfma_f32_16x16x32_bf16 v[176:179], a[4:7], v[240:243], v[176:179]
    ds_read_b128 v[236:239], v2 offset:30720
    v_mfma_f32_16x16x32_bf16 v[180:183], a[12:15], v[240:243], v[180:183]
    ds_read_b128 a[24:27], v1 offset:24576
    v_mfma_f32_16x16x32_bf16 v[208:211], a[4:7], v[244:247], v[208:211]
    ds_read_b128 v[240:243], v2 offset:31744
    v_mfma_f32_16x16x32_bf16 v[212:215], a[12:15], v[244:247], v[212:215]
    ds_read_b128 a[28:31], v253 offset:24576
    s_waitcnt lgkmcnt(4)
    v_mfma_f32_16x16x32_bf16 v[16:19], a[16:19], v[248:251], v[16:19]
    ds_read_b128 v[244:247], v2 offset:32768
    s_waitcnt lgkmcnt(1)
    v_mfma_f32_16x16x32_bf16 v[20:23], a[24:27], v[248:251], v[20:23]
    v_mfma_f32_16x16x32_bf16 v[48:51], a[16:19], v[232:235], v[48:51]
    ds_read_b128 v[248:251], v2 offset:33792
    v_mfma_f32_16x16x32_bf16 v[52:55], a[24:27], v[232:235], v[52:55]
    v_mfma_f32_16x16x32_bf16 v[80:83], a[16:19], v[236:239], v[80:83]
    ds_read_b128 v[232:235], v2 offset:34816
    v_mfma_f32_16x16x32_bf16 v[84:87], a[24:27], v[236:239], v[84:87]
    v_mfma_f32_16x16x32_bf16 v[112:115], a[16:19], v[240:243], v[112:115]
    ds_read_b128 v[236:239], v2 offset:35840
    v_mfma_f32_16x16x32_bf16 v[116:119], a[24:27], v[240:243], v[116:119]
    s_waitcnt lgkmcnt(2)
    v_mfma_f32_16x16x32_bf16 v[144:147], a[16:19], v[244:247], v[144:147]
    ds_read_b128 v[240:243], v2 offset:36864
    v_mfma_f32_16x16x32_bf16 v[148:151], a[24:27], v[244:247], v[148:151]
    v_mfma_f32_16x16x32_bf16 v[176:179], a[16:19], v[248:251], v[176:179]
    ds_read_b128 v[244:247], v2 offset:37888
    v_mfma_f32_16x16x32_bf16 v[180:183], a[24:27], v[248:251], v[180:183]
    s_waitcnt lgkmcnt(2)
    v_mfma_f32_16x16x32_bf16 v[208:211], a[16:19], v[232:235], v[208:211]
    ds_read_b128 v[248:251], v2 offset:38912
    s_waitcnt vmcnt(14)
    s_mov_b32 m0, s61
    v_mfma_f32_16x16x32_bf16 v[212:215], a[24:27], v[232:235], v[212:215]
    s_addk_i32 s70, -8064
    buffer_load_dwordx4 v3, s[24:27], s70 offen nt lds
    v_mfma_f32_16x16x32_bf16 v[16:19], a[20:23], v[236:239], v[16:19]
    ds_read_b128 v[232:235], v2 offset:39936
    v_mfma_f32_16x16x32_bf16 v[20:23], a[28:31], v[236:239], v[20:23]
    buffer_load_dwordx4 v3, s[28:31], s70 offen offset:1024 nt lds
    s_waitcnt lgkmcnt(1)
    v_mfma_f32_16x16x32_bf16 v[48:51], a[20:23], v[240:243], v[48:51]
    ds_read_b128 v[236:239], v2 offset:40960
    v_mfma_f32_16x16x32_bf16 v[52:55], a[28:31], v[240:243], v[52:55]
    ds_read_b128 a[0:3], v1 offset:32768
    v_mfma_f32_16x16x32_bf16 v[80:83], a[20:23], v[244:247], v[80:83]
    ds_read_b128 v[240:243], v2 offset:41984
    v_mfma_f32_16x16x32_bf16 v[84:87], a[28:31], v[244:247], v[84:87]
    ds_read_b128 a[4:7], v253 offset:32768
    s_waitcnt vmcnt(14)
    s_mov_b32 m0, s62
    v_mfma_f32_16x16x32_bf16 v[112:115], a[20:23], v[248:251], v[112:115]
    ds_read_b128 v[244:247], v2 offset:43008
    s_addk_i32 s70, 8192
    v_mfma_f32_16x16x32_bf16 v[116:119], a[28:31], v[248:251], v[116:119]
    buffer_load_dwordx4 v3, s[24:27], s70 offen nt lds
    s_waitcnt lgkmcnt(1)
    v_mfma_f32_16x16x32_bf16 v[144:147], a[20:23], v[232:235], v[144:147]
    ds_read_b128 v[248:251], v2 offset:44032
    v_mfma_f32_16x16x32_bf16 v[148:151], a[28:31], v[232:235], v[148:151]
    buffer_load_dwordx4 v3, s[28:31], s70 offen offset:1024 nt lds
    v_mfma_f32_16x16x32_bf16 v[176:179], a[20:23], v[236:239], v[176:179]
    ds_read_b128 v[232:235], v2 offset:45056
    v_mfma_f32_16x16x32_bf16 v[180:183], a[28:31], v[236:239], v[180:183]
    ds_read_b128 a[8:11], v4 offset:24576
    v_mfma_f32_16x16x32_bf16 v[208:211], a[20:23], v[240:243], v[208:211]
    ds_read_b128 v[236:239], v2 offset:46080
    v_mfma_f32_16x16x32_bf16 v[212:215], a[28:31], v[240:243], v[212:215]
    ds_read_b128 a[12:15], v252 offset:24576
    s_waitcnt lgkmcnt(4)
    v_mfma_f32_16x16x32_bf16 v[16:19], a[0:3], v[244:247], v[16:19]
    ds_read_b128 v[240:243], v2 offset:47104
    s_waitcnt lgkmcnt(1)
    v_mfma_f32_16x16x32_bf16 v[20:23], a[8:11], v[244:247], v[20:23]
    v_mfma_f32_16x16x32_bf16 v[48:51], a[0:3], v[248:251], v[48:51]
    ds_read_b128 v[244:247], v2 offset:48128
    v_mfma_f32_16x16x32_bf16 v[52:55], a[8:11], v[248:251], v[52:55]
    v_mfma_f32_16x16x32_bf16 v[80:83], a[0:3], v[232:235], v[80:83]
    ds_read_b128 v[248:251], v2 offset:49152
    v_mfma_f32_16x16x32_bf16 v[84:87], a[8:11], v[232:235], v[84:87]
    v_mfma_f32_16x16x32_bf16 v[112:115], a[0:3], v[236:239], v[112:115]
    ds_read_b128 v[232:235], v2 offset:50176
    v_mfma_f32_16x16x32_bf16 v[116:119], a[8:11], v[236:239], v[116:119]
    s_waitcnt lgkmcnt(2)
    v_mfma_f32_16x16x32_bf16 v[144:147], a[0:3], v[240:243], v[144:147]
    ds_read_b128 v[236:239], v2 offset:51200
    v_mfma_f32_16x16x32_bf16 v[148:151], a[8:11], v[240:243], v[148:151]
    v_mfma_f32_16x16x32_bf16 v[176:179], a[0:3], v[244:247], v[176:179]
    ds_read_b128 v[240:243], v2 offset:52224
    v_mfma_f32_16x16x32_bf16 v[180:183], a[8:11], v[244:247], v[180:183]
    s_waitcnt lgkmcnt(2)
    v_mfma_f32_16x16x32_bf16 v[208:211], a[0:3], v[248:251], v[208:211]
    ds_read_b128 v[244:247], v2 offset:53248
    s_waitcnt vmcnt(14)
    s_mov_b32 m0, s63
    v_mfma_f32_16x16x32_bf16 v[212:215], a[8:11], v[248:251], v[212:215]
    s_addk_i32 s70, 7808
    buffer_load_dwordx4 v3, s[24:27], s70 offen nt lds
    v_mfma_f32_16x16x32_bf16 v[16:19], a[4:7], v[232:235], v[16:19]
    ds_read_b128 v[248:251], v2 offset:54272
    v_mfma_f32_16x16x32_bf16 v[20:23], a[12:15], v[232:235], v[20:23]
    buffer_load_dwordx4 v3, s[28:31], s70 offen offset:1024 nt lds
    s_waitcnt lgkmcnt(1)
    v_mfma_f32_16x16x32_bf16 v[48:51], a[4:7], v[236:239], v[48:51]
    ds_read_b128 v[232:235], v2 offset:55296
    v_mfma_f32_16x16x32_bf16 v[52:55], a[12:15], v[236:239], v[52:55]
    ds_read_b128 a[16:19], v4 offset:8192
    v_mfma_f32_16x16x32_bf16 v[80:83], a[4:7], v[240:243], v[80:83]
    ds_read_b128 v[236:239], v2 offset:56320
    v_mfma_f32_16x16x32_bf16 v[84:87], a[12:15], v[240:243], v[84:87]
    ds_read_b128 a[20:23], v252 offset:8192
    s_waitcnt vmcnt(14)
    s_mov_b32 m0, s55
    v_mfma_f32_16x16x32_bf16 v[112:115], a[4:7], v[244:247], v[112:115]
    ds_read_b128 v[240:243], v2 offset:0
    s_addk_i32 s70, 8192
    v_mfma_f32_16x16x32_bf16 v[116:119], a[12:15], v[244:247], v[116:119]
    buffer_load_dwordx4 v3, s[24:27], s70 offen nt lds
    s_waitcnt lgkmcnt(1)
    v_mfma_f32_16x16x32_bf16 v[144:147], a[4:7], v[248:251], v[144:147]
    ds_read_b128 v[244:247], v2 offset:1024
    v_mfma_f32_16x16x32_bf16 v[148:151], a[12:15], v[248:251], v[148:151]
    buffer_load_dwordx4 v3, s[28:31], s70 offen offset:1024 nt lds
    v_mfma_f32_16x16x32_bf16 v[176:179], a[4:7], v[232:235], v[176:179]
    ds_read_b128 v[248:251], v2 offset:2048
    v_mfma_f32_16x16x32_bf16 v[180:183], a[12:15], v[232:235], v[180:183]
    ds_read_b128 a[24:27], v4 offset:32768
    v_mfma_f32_16x16x32_bf16 v[208:211], a[4:7], v[236:239], v[208:211]
    ds_read_b128 v[232:235], v2 offset:3072
    v_mfma_f32_16x16x32_bf16 v[212:215], a[12:15], v[236:239], v[212:215]
    ds_read_b128 a[28:31], v252 offset:32768
    s_waitcnt lgkmcnt(4)
    v_mfma_f32_16x16x32_bf16 v[24:27], a[16:19], v[240:243], 0
    ds_read_b128 v[236:239], v2 offset:4096
    s_waitcnt lgkmcnt(1)
    v_mfma_f32_16x16x32_bf16 v[28:31], a[24:27], v[240:243], 0
    v_mfma_f32_16x16x32_bf16 v[56:59], a[16:19], v[244:247], 0
    ds_read_b128 v[240:243], v2 offset:5120
    v_mfma_f32_16x16x32_bf16 v[60:63], a[24:27], v[244:247], 0
    v_mfma_f32_16x16x32_bf16 v[88:91], a[16:19], v[248:251], 0
    ds_read_b128 v[244:247], v2 offset:6144
    v_mfma_f32_16x16x32_bf16 v[92:95], a[24:27], v[248:251], 0
    v_mfma_f32_16x16x32_bf16 v[120:123], a[16:19], v[232:235], 0
    ds_read_b128 v[248:251], v2 offset:7168
    v_mfma_f32_16x16x32_bf16 v[124:127], a[24:27], v[232:235], 0
    s_waitcnt lgkmcnt(2)
    v_mfma_f32_16x16x32_bf16 v[152:155], a[16:19], v[236:239], 0
    ds_read_b128 v[232:235], v2 offset:8192
    v_mfma_f32_16x16x32_bf16 v[156:159], a[24:27], v[236:239], 0
    v_mfma_f32_16x16x32_bf16 v[184:187], a[16:19], v[240:243], 0
    ds_read_b128 v[236:239], v2 offset:9216
    v_mfma_f32_16x16x32_bf16 v[188:191], a[24:27], v[240:243], 0
    s_waitcnt lgkmcnt(2)
    v_mfma_f32_16x16x32_bf16 v[216:219], a[16:19], v[244:247], 0
    ds_read_b128 v[240:243], v2 offset:10240
    s_waitcnt vmcnt(14)
    s_mov_b32 m0, s53
    v_mfma_f32_16x16x32_bf16 v[220:223], a[24:27], v[244:247], 0
    s_addk_i32 s70, -8064
    buffer_load_dwordx4 v3, s[24:27], s70 offen nt lds
    v_mfma_f32_16x16x32_bf16 v[24:27], a[20:23], v[248:251], v[24:27]
    ds_read_b128 v[244:247], v2 offset:11264
    v_mfma_f32_16x16x32_bf16 v[28:31], a[28:31], v[248:251], v[28:31]
    buffer_load_dwordx4 v3, s[28:31], s70 offen offset:1024 nt lds
    s_waitcnt lgkmcnt(1)
    v_mfma_f32_16x16x32_bf16 v[56:59], a[20:23], v[232:235], v[56:59]
    ds_read_b128 v[248:251], v2 offset:12288
    v_mfma_f32_16x16x32_bf16 v[60:63], a[28:31], v[232:235], v[60:63]
    ds_read_b128 a[0:3], v1 offset:0
    v_mfma_f32_16x16x32_bf16 v[88:91], a[20:23], v[236:239], v[88:91]
    ds_read_b128 v[232:235], v2 offset:13312
    v_mfma_f32_16x16x32_bf16 v[92:95], a[28:31], v[236:239], v[92:95]
    ds_read_b128 a[4:7], v253 offset:0
    s_waitcnt vmcnt(14)
    s_mov_b32 m0, s56
    v_mfma_f32_16x16x32_bf16 v[120:123], a[20:23], v[240:243], v[120:123]
    ds_read_b128 v[236:239], v2 offset:14336
    s_addk_i32 s70, 8192
    v_mfma_f32_16x16x32_bf16 v[124:127], a[28:31], v[240:243], v[124:127]
    buffer_load_dwordx4 v3, s[24:27], s70 offen nt lds
    s_waitcnt lgkmcnt(1)
    v_mfma_f32_16x16x32_bf16 v[152:155], a[20:23], v[244:247], v[152:155]
    ds_read_b128 v[240:243], v2 offset:15360
    v_mfma_f32_16x16x32_bf16 v[156:159], a[28:31], v[244:247], v[156:159]
    buffer_load_dwordx4 v3, s[28:31], s70 offen offset:1024 nt lds
    v_mfma_f32_16x16x32_bf16 v[184:187], a[20:23], v[248:251], v[184:187]
    ds_read_b128 v[244:247], v2 offset:16384
    v_mfma_f32_16x16x32_bf16 v[188:191], a[28:31], v[248:251], v[188:191]
    ds_read_b128 a[8:11], v4 offset:0
    v_mfma_f32_16x16x32_bf16 v[216:219], a[20:23], v[232:235], v[216:219]
    ds_read_b128 v[248:251], v2 offset:17408
    v_mfma_f32_16x16x32_bf16 v[220:223], a[28:31], v[232:235], v[220:223]
    ds_read_b128 a[12:15], v252 offset:0
    s_waitcnt lgkmcnt(4)
    v_mfma_f32_16x16x32_bf16 v[24:27], a[0:3], v[236:239], v[24:27]
    ds_read_b128 v[232:235], v2 offset:18432
    s_waitcnt lgkmcnt(1)
    v_mfma_f32_16x16x32_bf16 v[28:31], a[8:11], v[236:239], v[28:31]
    v_mfma_f32_16x16x32_bf16 v[56:59], a[0:3], v[240:243], v[56:59]
    ds_read_b128 v[236:239], v2 offset:19456
    v_mfma_f32_16x16x32_bf16 v[60:63], a[8:11], v[240:243], v[60:63]
    v_mfma_f32_16x16x32_bf16 v[88:91], a[0:3], v[244:247], v[88:91]
    ds_read_b128 v[240:243], v2 offset:20480
    v_mfma_f32_16x16x32_bf16 v[92:95], a[8:11], v[244:247], v[92:95]
    v_mfma_f32_16x16x32_bf16 v[120:123], a[0:3], v[248:251], v[120:123]
    ds_read_b128 v[244:247], v2 offset:21504
    v_mfma_f32_16x16x32_bf16 v[124:127], a[8:11], v[248:251], v[124:127]
    s_waitcnt lgkmcnt(2)
    v_mfma_f32_16x16x32_bf16 v[152:155], a[0:3], v[232:235], v[152:155]
    ds_read_b128 v[248:251], v2 offset:22528
    v_mfma_f32_16x16x32_bf16 v[156:159], a[8:11], v[232:235], v[156:159]
    v_mfma_f32_16x16x32_bf16 v[184:187], a[0:3], v[236:239], v[184:187]
    ds_read_b128 v[232:235], v2 offset:23552
    v_mfma_f32_16x16x32_bf16 v[188:191], a[8:11], v[236:239], v[188:191]
    s_waitcnt lgkmcnt(2)
    v_mfma_f32_16x16x32_bf16 v[216:219], a[0:3], v[240:243], v[216:219]
    ds_read_b128 v[236:239], v2 offset:24576
    s_waitcnt vmcnt(14)
    s_mov_b32 m0, s59
    v_mfma_f32_16x16x32_bf16 v[220:223], a[8:11], v[240:243], v[220:223]
    s_addk_i32 s70, -8064
    buffer_load_dwordx4 v3, s[24:27], s70 offen nt lds
    v_mfma_f32_16x16x32_bf16 v[24:27], a[4:7], v[244:247], v[24:27]
    ds_read_b128 v[240:243], v2 offset:25600
    v_mfma_f32_16x16x32_bf16 v[28:31], a[12:15], v[244:247], v[28:31]
    buffer_load_dwordx4 v3, s[28:31], s70 offen offset:1024 nt lds
    s_waitcnt lgkmcnt(1)
    v_mfma_f32_16x16x32_bf16 v[56:59], a[4:7], v[248:251], v[56:59]
    ds_read_b128 v[244:247], v2 offset:26624
    v_mfma_f32_16x16x32_bf16 v[60:63], a[12:15], v[248:251], v[60:63]
    ds_read_b128 a[16:19], v1 offset:8192
    v_mfma_f32_16x16x32_bf16 v[88:91], a[4:7], v[232:235], v[88:91]
    ds_read_b128 v[248:251], v2 offset:27648
    v_mfma_f32_16x16x32_bf16 v[92:95], a[12:15], v[232:235], v[92:95]
    ds_read_b128 a[20:23], v253 offset:8192
    s_waitcnt vmcnt(14)
    s_mov_b32 m0, s52
    v_mfma_f32_16x16x32_bf16 v[120:123], a[4:7], v[236:239], v[120:123]
    ds_read_b128 v[232:235], v2 offset:28672
    s_addk_i32 s70, 8192
    v_mfma_f32_16x16x32_bf16 v[124:127], a[12:15], v[236:239], v[124:127]
    buffer_load_dwordx4 v3, s[24:27], s70 offen nt lds
    s_waitcnt lgkmcnt(1)
    v_mfma_f32_16x16x32_bf16 v[152:155], a[4:7], v[240:243], v[152:155]
    ds_read_b128 v[236:239], v2 offset:29696
    v_mfma_f32_16x16x32_bf16 v[156:159], a[12:15], v[240:243], v[156:159]
    buffer_load_dwordx4 v3, s[28:31], s70 offen offset:1024 nt lds
    v_mfma_f32_16x16x32_bf16 v[184:187], a[4:7], v[244:247], v[184:187]
    ds_read_b128 v[240:243], v2 offset:30720
    v_mfma_f32_16x16x32_bf16 v[188:191], a[12:15], v[244:247], v[188:191]
    ds_read_b128 a[24:27], v4 offset:16384
    v_mfma_f32_16x16x32_bf16 v[216:219], a[4:7], v[248:251], v[216:219]
    ds_read_b128 v[244:247], v2 offset:31744
    v_mfma_f32_16x16x32_bf16 v[220:223], a[12:15], v[248:251], v[220:223]
    ds_read_b128 a[28:31], v252 offset:16384
    s_waitcnt lgkmcnt(4)
    v_mfma_f32_16x16x32_bf16 v[24:27], a[16:19], v[232:235], v[24:27]
    ds_read_b128 v[248:251], v2 offset:32768
    s_waitcnt lgkmcnt(1)
    v_mfma_f32_16x16x32_bf16 v[28:31], a[24:27], v[232:235], v[28:31]
    v_mfma_f32_16x16x32_bf16 v[56:59], a[16:19], v[236:239], v[56:59]
    ds_read_b128 v[232:235], v2 offset:33792
    v_mfma_f32_16x16x32_bf16 v[60:63], a[24:27], v[236:239], v[60:63]
    v_mfma_f32_16x16x32_bf16 v[88:91], a[16:19], v[240:243], v[88:91]
    ds_read_b128 v[236:239], v2 offset:34816
    v_mfma_f32_16x16x32_bf16 v[92:95], a[24:27], v[240:243], v[92:95]
    v_mfma_f32_16x16x32_bf16 v[120:123], a[16:19], v[244:247], v[120:123]
    ds_read_b128 v[240:243], v2 offset:35840
    v_mfma_f32_16x16x32_bf16 v[124:127], a[24:27], v[244:247], v[124:127]
    s_waitcnt lgkmcnt(2)
    v_mfma_f32_16x16x32_bf16 v[152:155], a[16:19], v[248:251], v[152:155]
    ds_read_b128 v[244:247], v2 offset:36864
    v_mfma_f32_16x16x32_bf16 v[156:159], a[24:27], v[248:251], v[156:159]
    v_mfma_f32_16x16x32_bf16 v[184:187], a[16:19], v[232:235], v[184:187]
    ds_read_b128 v[248:251], v2 offset:37888
    v_mfma_f32_16x16x32_bf16 v[188:191], a[24:27], v[232:235], v[188:191]
    s_waitcnt lgkmcnt(2)
    v_mfma_f32_16x16x32_bf16 v[216:219], a[16:19], v[236:239], v[216:219]
    ds_read_b128 v[232:235], v2 offset:38912
    s_waitcnt vmcnt(14)
    s_mov_b32 m0, s60
    v_mfma_f32_16x16x32_bf16 v[220:223], a[24:27], v[236:239], v[220:223]
    s_addk_i32 s70, -8064
    buffer_load_dwordx4 v3, s[24:27], s70 offen nt lds
    v_mfma_f32_16x16x32_bf16 v[24:27], a[20:23], v[240:243], v[24:27]
    ds_read_b128 v[236:239], v2 offset:39936
    v_mfma_f32_16x16x32_bf16 v[28:31], a[28:31], v[240:243], v[28:31]
    buffer_load_dwordx4 v3, s[28:31], s70 offen offset:1024 nt lds
    s_waitcnt lgkmcnt(1)
    v_mfma_f32_16x16x32_bf16 v[56:59], a[20:23], v[244:247], v[56:59]
    ds_read_b128 v[240:243], v2 offset:40960
    v_mfma_f32_16x16x32_bf16 v[60:63], a[28:31], v[244:247], v[60:63]
    ds_read_b128 a[0:3], v1 offset:16384
    v_mfma_f32_16x16x32_bf16 v[88:91], a[20:23], v[248:251], v[88:91]
    ds_read_b128 v[244:247], v2 offset:41984
    v_mfma_f32_16x16x32_bf16 v[92:95], a[28:31], v[248:251], v[92:95]
    ds_read_b128 a[4:7], v253 offset:16384
    s_waitcnt vmcnt(14)
    s_mov_b32 m0, s54
    v_mfma_f32_16x16x32_bf16 v[120:123], a[20:23], v[232:235], v[120:123]
    ds_read_b128 v[248:251], v2 offset:43008
    s_addk_i32 s70, 8192
    v_mfma_f32_16x16x32_bf16 v[124:127], a[28:31], v[232:235], v[124:127]
    buffer_load_dwordx4 v3, s[24:27], s70 offen nt lds
    s_waitcnt lgkmcnt(1)
    v_mfma_f32_16x16x32_bf16 v[152:155], a[20:23], v[236:239], v[152:155]
    ds_read_b128 v[232:235], v2 offset:44032
    v_mfma_f32_16x16x32_bf16 v[156:159], a[28:31], v[236:239], v[156:159]
    buffer_load_dwordx4 v3, s[28:31], s70 offen offset:1024 nt lds
    v_mfma_f32_16x16x32_bf16 v[184:187], a[20:23], v[240:243], v[184:187]
    ds_read_b128 v[236:239], v2 offset:45056
    v_mfma_f32_16x16x32_bf16 v[188:191], a[28:31], v[240:243], v[188:191]
    ds_read_b128 a[8:11], v1 offset:24576
    v_mfma_f32_16x16x32_bf16 v[216:219], a[20:23], v[244:247], v[216:219]
    ds_read_b128 v[240:243], v2 offset:46080
    v_mfma_f32_16x16x32_bf16 v[220:223], a[28:31], v[244:247], v[220:223]
    ds_read_b128 a[12:15], v253 offset:24576
    s_waitcnt lgkmcnt(4)
    v_mfma_f32_16x16x32_bf16 v[24:27], a[0:3], v[248:251], v[24:27]
    ds_read_b128 v[244:247], v2 offset:47104
    s_waitcnt lgkmcnt(1)
    v_mfma_f32_16x16x32_bf16 v[28:31], a[8:11], v[248:251], v[28:31]
    v_mfma_f32_16x16x32_bf16 v[56:59], a[0:3], v[232:235], v[56:59]
    ds_read_b128 v[248:251], v2 offset:48128
    v_mfma_f32_16x16x32_bf16 v[60:63], a[8:11], v[232:235], v[60:63]
    v_mfma_f32_16x16x32_bf16 v[88:91], a[0:3], v[236:239], v[88:91]
    ds_read_b128 v[232:235], v2 offset:49152
    v_mfma_f32_16x16x32_bf16 v[92:95], a[8:11], v[236:239], v[92:95]
    v_mfma_f32_16x16x32_bf16 v[120:123], a[0:3], v[240:243], v[120:123]
    ds_read_b128 v[236:239], v2 offset:50176
    v_mfma_f32_16x16x32_bf16 v[124:127], a[8:11], v[240:243], v[124:127]
    s_waitcnt lgkmcnt(2)
    v_mfma_f32_16x16x32_bf16 v[152:155], a[0:3], v[244:247], v[152:155]
    ds_read_b128 v[240:243], v2 offset:51200
    v_mfma_f32_16x16x32_bf16 v[156:159], a[8:11], v[244:247], v[156:159]
    v_mfma_f32_16x16x32_bf16 v[184:187], a[0:3], v[248:251], v[184:187]
    ds_read_b128 v[244:247], v2 offset:52224
    v_mfma_f32_16x16x32_bf16 v[188:191], a[8:11], v[248:251], v[188:191]
    s_waitcnt lgkmcnt(2)
    v_mfma_f32_16x16x32_bf16 v[216:219], a[0:3], v[232:235], v[216:219]
    ds_read_b128 v[248:251], v2 offset:53248
    s_waitcnt vmcnt(14)
    s_mov_b32 m0, s57
    v_mfma_f32_16x16x32_bf16 v[220:223], a[8:11], v[232:235], v[220:223]
    s_mov_b32 s71, 0
    buffer_load_dwordx4 v5, s[32:35], s71 offen nt lds
    v_mfma_f32_16x16x32_bf16 v[24:27], a[4:7], v[236:239], v[24:27]
    ds_read_b128 v[232:235], v2 offset:54272
    v_mfma_f32_16x16x32_bf16 v[28:31], a[12:15], v[236:239], v[28:31]
    buffer_load_dwordx4 v5, s[36:39], s71 offen offset:1024 nt lds
    s_waitcnt lgkmcnt(1)
    v_mfma_f32_16x16x32_bf16 v[56:59], a[4:7], v[240:243], v[56:59]
    ds_read_b128 v[236:239], v2 offset:55296
    v_mfma_f32_16x16x32_bf16 v[60:63], a[12:15], v[240:243], v[60:63]
    ds_read_b128 a[16:19], v1 offset:32768
    v_mfma_f32_16x16x32_bf16 v[88:91], a[4:7], v[244:247], v[88:91]
    ds_read_b128 v[240:243], v2 offset:56320
    v_mfma_f32_16x16x32_bf16 v[92:95], a[12:15], v[244:247], v[92:95]
    ds_read_b128 a[20:23], v253 offset:32768
    s_waitcnt vmcnt(14)
    s_mov_b32 m0, s58
    v_mfma_f32_16x16x32_bf16 v[120:123], a[4:7], v[248:251], v[120:123]
    ds_read_b128 v[244:247], v2 offset:0
    s_addk_i32 s71, 8192
    v_mfma_f32_16x16x32_bf16 v[124:127], a[12:15], v[248:251], v[124:127]
    buffer_load_dwordx4 v5, s[32:35], s71 offen nt lds
    s_waitcnt lgkmcnt(1)
    v_mfma_f32_16x16x32_bf16 v[152:155], a[4:7], v[232:235], v[152:155]
    ds_read_b128 v[248:251], v2 offset:1024
    v_mfma_f32_16x16x32_bf16 v[156:159], a[12:15], v[232:235], v[156:159]
    buffer_load_dwordx4 v5, s[36:39], s71 offen offset:1024 nt lds
    v_mfma_f32_16x16x32_bf16 v[184:187], a[4:7], v[236:239], v[184:187]
    ds_read_b128 v[232:235], v2 offset:2048
    v_mfma_f32_16x16x32_bf16 v[188:191], a[12:15], v[236:239], v[188:191]
    ds_read_b128 a[24:27], v4 offset:24576
    v_mfma_f32_16x16x32_bf16 v[216:219], a[4:7], v[240:243], v[216:219]
    ds_read_b128 v[236:239], v2 offset:3072
    v_mfma_f32_16x16x32_bf16 v[220:223], a[12:15], v[240:243], v[220:223]
    ds_read_b128 a[28:31], v252 offset:24576
    s_waitcnt lgkmcnt(4)
    v_mfma_f32_16x16x32_bf16 v[32:35], a[16:19], v[244:247], 0
    ds_read_b128 v[240:243], v2 offset:4096
    s_waitcnt lgkmcnt(1)
    v_mfma_f32_16x16x32_bf16 v[36:39], a[24:27], v[244:247], 0
    v_mfma_f32_16x16x32_bf16 v[64:67], a[16:19], v[248:251], 0
    ds_read_b128 v[244:247], v2 offset:5120
    v_mfma_f32_16x16x32_bf16 v[68:71], a[24:27], v[248:251], 0
    v_mfma_f32_16x16x32_bf16 v[96:99], a[16:19], v[232:235], 0
    ds_read_b128 v[248:251], v2 offset:6144
    v_mfma_f32_16x16x32_bf16 v[100:103], a[24:27], v[232:235], 0
    v_mfma_f32_16x16x32_bf16 v[128:131], a[16:19], v[236:239], 0
    ds_read_b128 v[232:235], v2 offset:7168
    v_mfma_f32_16x16x32_bf16 v[132:135], a[24:27], v[236:239], 0
    s_waitcnt lgkmcnt(2)
    v_mfma_f32_16x16x32_bf16 v[160:163], a[16:19], v[240:243], 0
    ds_read_b128 v[236:239], v2 offset:8192
    v_mfma_f32_16x16x32_bf16 v[164:167], a[24:27], v[240:243], 0
    v_mfma_f32_16x16x32_bf16 v[192:195], a[16:19], v[244:247], 0
    ds_read_b128 v[240:243], v2 offset:9216
    v_mfma_f32_16x16x32_bf16 v[196:199], a[24:27], v[244:247], 0
    s_waitcnt lgkmcnt(2)
    v_mfma_f32_16x16x32_bf16 v[224:227], a[16:19], v[248:251], 0
    ds_read_b128 v[244:247], v2 offset:10240
    s_waitcnt vmcnt(14)
    s_mov_b32 m0, s55
    v_mfma_f32_16x16x32_bf16 v[228:231], a[24:27], v[248:251], 0
    s_addk_i32 s71, 8192
    buffer_load_dwordx4 v5, s[32:35], s71 offen nt lds
    v_mfma_f32_16x16x32_bf16 v[32:35], a[20:23], v[232:235], v[32:35]
    ds_read_b128 v[248:251], v2 offset:11264
    v_mfma_f32_16x16x32_bf16 v[36:39], a[28:31], v[232:235], v[36:39]
    buffer_load_dwordx4 v5, s[36:39], s71 offen offset:1024 nt lds
    s_waitcnt lgkmcnt(1)
    v_mfma_f32_16x16x32_bf16 v[64:67], a[20:23], v[236:239], v[64:67]
    ds_read_b128 v[232:235], v2 offset:12288
    v_mfma_f32_16x16x32_bf16 v[68:71], a[28:31], v[236:239], v[68:71]
    ds_read_b128 a[0:3], v4 offset:8192
    v_mfma_f32_16x16x32_bf16 v[96:99], a[20:23], v[240:243], v[96:99]
    ds_read_b128 v[236:239], v2 offset:13312
    v_mfma_f32_16x16x32_bf16 v[100:103], a[28:31], v[240:243], v[100:103]
    ds_read_b128 a[4:7], v252 offset:8192
    s_waitcnt vmcnt(14)
    v_mfma_f32_16x16x32_bf16 v[128:131], a[20:23], v[244:247], v[128:131]
    ds_read_b128 v[240:243], v2 offset:14336
    v_mfma_f32_16x16x32_bf16 v[132:135], a[28:31], v[244:247], v[132:135]
    ds_read_b128 a[8:11], v4 offset:32768
    s_waitcnt lgkmcnt(2)
    v_mfma_f32_16x16x32_bf16 v[160:163], a[20:23], v[248:251], v[160:163]
    ds_read_b128 v[244:247], v2 offset:15360
    v_mfma_f32_16x16x32_bf16 v[164:167], a[28:31], v[248:251], v[164:167]
    ds_read_b128 a[12:15], v252 offset:32768
    v_mfma_f32_16x16x32_bf16 v[192:195], a[20:23], v[232:235], v[192:195]
    ds_read_b128 v[248:251], v2 offset:16384
    v_mfma_f32_16x16x32_bf16 v[196:199], a[28:31], v[232:235], v[196:199]
    v_mfma_f32_16x16x32_bf16 v[224:227], a[20:23], v[236:239], v[224:227]
    ds_read_b128 v[232:235], v2 offset:17408
    v_mfma_f32_16x16x32_bf16 v[228:231], a[28:31], v[236:239], v[228:231]
    s_waitcnt lgkmcnt(3)
    v_mfma_f32_16x16x32_bf16 v[32:35], a[0:3], v[240:243], v[32:35]
    ds_read_b128 v[236:239], v2 offset:18432
    s_waitcnt lgkmcnt(3)
    v_mfma_f32_16x16x32_bf16 v[36:39], a[8:11], v[240:243], v[36:39]
    s_mov_b32 m0, s56
    s_addk_i32 s71, 8192
    buffer_load_dwordx4 v5, s[32:35], s71 offen nt lds
    v_mfma_f32_16x16x32_bf16 v[64:67], a[0:3], v[244:247], v[64:67]
    ds_read_b128 v[240:243], v2 offset:19456
    v_mfma_f32_16x16x32_bf16 v[68:71], a[8:11], v[244:247], v[68:71]
    buffer_load_dwordx4 v5, s[36:39], s71 offen offset:1024 nt lds
    s_waitcnt lgkmcnt(2)
    v_mfma_f32_16x16x32_bf16 v[96:99], a[0:3], v[248:251], v[96:99]
    ds_read_b128 v[244:247], v2 offset:20480
    v_mfma_f32_16x16x32_bf16 v[100:103], a[8:11], v[248:251], v[100:103]
    v_mfma_f32_16x16x32_bf16 v[128:131], a[0:3], v[232:235], v[128:131]
    ds_read_b128 v[248:251], v2 offset:21504
    v_mfma_f32_16x16x32_bf16 v[132:135], a[8:11], v[232:235], v[132:135]
    s_waitcnt lgkmcnt(2)
    v_mfma_f32_16x16x32_bf16 v[160:163], a[0:3], v[236:239], v[160:163]
    ds_read_b128 v[232:235], v2 offset:22528
    v_mfma_f32_16x16x32_bf16 v[164:167], a[8:11], v[236:239], v[164:167]
    v_mfma_f32_16x16x32_bf16 v[192:195], a[0:3], v[240:243], v[192:195]
    ds_read_b128 v[236:239], v2 offset:23552
    v_mfma_f32_16x16x32_bf16 v[196:199], a[8:11], v[240:243], v[196:199]
    s_waitcnt lgkmcnt(2)
    v_mfma_f32_16x16x32_bf16 v[224:227], a[0:3], v[244:247], v[224:227]
    ds_read_b128 v[240:243], v2 offset:24576
    s_waitcnt vmcnt(14)
    v_mfma_f32_16x16x32_bf16 v[228:231], a[8:11], v[244:247], v[228:231]
    ds_read_b128 a[16:19], v1 offset:0
    v_mfma_f32_16x16x32_bf16 v[32:35], a[4:7], v[248:251], v[32:35]
    ds_read_b128 v[244:247], v2 offset:25600
    v_mfma_f32_16x16x32_bf16 v[36:39], a[12:15], v[248:251], v[36:39]
    ds_read_b128 a[20:23], v253 offset:0
    s_waitcnt vmcnt(12)
    s_waitcnt lgkmcnt(0)
    v_mfma_f32_16x16x32_bf16 v[64:67], a[4:7], v[232:235], v[64:67]
    ds_read_b128 v[248:251], v2 offset:26624
    v_mfma_f32_16x16x32_bf16 v[68:71], a[12:15], v[232:235], v[68:71]
    ds_read_b128 a[24:27], v4 offset:0
    v_mfma_f32_16x16x32_bf16 v[96:99], a[4:7], v[236:239], v[96:99]
    ds_read_b128 v[232:235], v2 offset:27648
    v_mfma_f32_16x16x32_bf16 v[100:103], a[12:15], v[236:239], v[100:103]
    ds_read_b128 a[28:31], v252 offset:0
    v_mfma_f32_16x16x32_bf16 v[128:131], a[4:7], v[240:243], v[128:131]
    ds_read_b128 v[236:239], v2 offset:28672
    v_mfma_f32_16x16x32_bf16 v[132:135], a[12:15], v[240:243], v[132:135]
    v_mfma_f32_16x16x32_bf16 v[160:163], a[4:7], v[244:247], v[160:163]
    ds_read_b128 v[240:243], v2 offset:29696
    v_mfma_f32_16x16x32_bf16 v[164:167], a[12:15], v[244:247], v[164:167]
    s_waitcnt lgkmcnt(3)
    v_mfma_f32_16x16x32_bf16 v[192:195], a[4:7], v[248:251], v[192:195]
    ds_read_b128 v[244:247], v2 offset:30720
    v_mfma_f32_16x16x32_bf16 v[196:199], a[12:15], v[248:251], v[196:199]
    v_mfma_f32_16x16x32_bf16 v[224:227], a[4:7], v[232:235], v[224:227]
    ds_read_b128 v[248:251], v2 offset:31744
    v_mfma_f32_16x16x32_bf16 v[228:231], a[12:15], v[232:235], v[228:231]
    s_waitcnt lgkmcnt(2)
    v_mfma_f32_16x16x32_bf16 v[32:35], a[16:19], v[236:239], v[32:35]
    ds_read_b128 v[232:235], v2 offset:32768
    v_mfma_f32_16x16x32_bf16 v[36:39], a[24:27], v[236:239], v[36:39]
    v_mfma_f32_16x16x32_bf16 v[64:67], a[16:19], v[240:243], v[64:67]
    ds_read_b128 v[236:239], v2 offset:33792
    v_mfma_f32_16x16x32_bf16 v[68:71], a[24:27], v[240:243], v[68:71]
    s_waitcnt lgkmcnt(2)
    v_mfma_f32_16x16x32_bf16 v[96:99], a[16:19], v[244:247], v[96:99]
    ds_read_b128 v[240:243], v2 offset:34816
    v_mfma_f32_16x16x32_bf16 v[100:103], a[24:27], v[244:247], v[100:103]
    v_mfma_f32_16x16x32_bf16 v[128:131], a[16:19], v[248:251], v[128:131]
    ds_read_b128 v[244:247], v2 offset:35840
    v_mfma_f32_16x16x32_bf16 v[132:135], a[24:27], v[248:251], v[132:135]
    s_waitcnt lgkmcnt(2)
    v_mfma_f32_16x16x32_bf16 v[160:163], a[16:19], v[232:235], v[160:163]
    ds_read_b128 v[248:251], v2 offset:36864
    v_mfma_f32_16x16x32_bf16 v[164:167], a[24:27], v[232:235], v[164:167]
    v_mfma_f32_16x16x32_bf16 v[192:195], a[16:19], v[236:239], v[192:195]
    ds_read_b128 v[232:235], v2 offset:37888
    v_mfma_f32_16x16x32_bf16 v[196:199], a[24:27], v[236:239], v[196:199]
    s_waitcnt lgkmcnt(2)
    v_mfma_f32_16x16x32_bf16 v[224:227], a[16:19], v[240:243], v[224:227]
    ds_read_b128 v[236:239], v2 offset:38912
    s_waitcnt vmcnt(10)
    v_mfma_f32_16x16x32_bf16 v[228:231], a[24:27], v[240:243], v[228:231]
    ds_read_b128 a[0:3], v1 offset:8192
    v_mfma_f32_16x16x32_bf16 v[32:35], a[20:23], v[244:247], v[32:35]
    ds_read_b128 v[240:243], v2 offset:39936
    v_mfma_f32_16x16x32_bf16 v[36:39], a[28:31], v[244:247], v[36:39]
    ds_read_b128 a[4:7], v253 offset:8192
    s_waitcnt vmcnt(8)
    s_waitcnt lgkmcnt(0)
    v_mfma_f32_16x16x32_bf16 v[64:67], a[20:23], v[248:251], v[64:67]
    ds_read_b128 v[244:247], v2 offset:40960
    v_mfma_f32_16x16x32_bf16 v[68:71], a[28:31], v[248:251], v[68:71]
    ds_read_b128 a[8:11], v4 offset:16384
    v_mfma_f32_16x16x32_bf16 v[96:99], a[20:23], v[232:235], v[96:99]
    ds_read_b128 v[248:251], v2 offset:41984
    v_mfma_f32_16x16x32_bf16 v[100:103], a[28:31], v[232:235], v[100:103]
    ds_read_b128 a[12:15], v252 offset:16384
    v_mfma_f32_16x16x32_bf16 v[128:131], a[20:23], v[236:239], v[128:131]
    ds_read_b128 v[232:235], v2 offset:43008
    v_mfma_f32_16x16x32_bf16 v[132:135], a[28:31], v[236:239], v[132:135]
    v_mfma_f32_16x16x32_bf16 v[160:163], a[20:23], v[240:243], v[160:163]
    ds_read_b128 v[236:239], v2 offset:44032
    v_mfma_f32_16x16x32_bf16 v[164:167], a[28:31], v[240:243], v[164:167]
    s_waitcnt lgkmcnt(3)
    v_mfma_f32_16x16x32_bf16 v[192:195], a[20:23], v[244:247], v[192:195]
    ds_read_b128 v[240:243], v2 offset:45056
    v_mfma_f32_16x16x32_bf16 v[196:199], a[28:31], v[244:247], v[196:199]
    v_mfma_f32_16x16x32_bf16 v[224:227], a[20:23], v[248:251], v[224:227]
    ds_read_b128 v[244:247], v2 offset:46080
    s_waitcnt lgkmcnt(4)
    s_mov_b32 m0, s54
    v_mfma_f32_16x16x32_bf16 v[228:231], a[28:31], v[248:251], v[228:231]
    s_addk_i32 s71, 8192
    buffer_load_dwordx4 v5, s[32:35], s71 offen nt lds
    s_waitcnt lgkmcnt(2)
    v_mfma_f32_16x16x32_bf16 v[32:35], a[0:3], v[232:235], v[32:35]
    ds_read_b128 v[248:251], v2 offset:47104
    v_mfma_f32_16x16x32_bf16 v[36:39], a[8:11], v[232:235], v[36:39]
    buffer_load_dwordx4 v5, s[36:39], s71 offen offset:1024 nt lds
    v_mfma_f32_16x16x32_bf16 v[64:67], a[0:3], v[236:239], v[64:67]
    ds_read_b128 v[232:235], v2 offset:48128
    v_mfma_f32_16x16x32_bf16 v[68:71], a[8:11], v[236:239], v[68:71]
    s_waitcnt lgkmcnt(2)
    v_mfma_f32_16x16x32_bf16 v[96:99], a[0:3], v[240:243], v[96:99]
    ds_read_b128 v[236:239], v2 offset:49152
    v_mfma_f32_16x16x32_bf16 v[100:103], a[8:11], v[240:243], v[100:103]
    v_mfma_f32_16x16x32_bf16 v[128:131], a[0:3], v[244:247], v[128:131]
    ds_read_b128 v[240:243], v2 offset:50176
    v_mfma_f32_16x16x32_bf16 v[132:135], a[8:11], v[244:247], v[132:135]
    s_waitcnt lgkmcnt(2)
    v_mfma_f32_16x16x32_bf16 v[160:163], a[0:3], v[248:251], v[160:163]
    ds_read_b128 v[244:247], v2 offset:51200
    v_mfma_f32_16x16x32_bf16 v[164:167], a[8:11], v[248:251], v[164:167]
    v_mfma_f32_16x16x32_bf16 v[192:195], a[0:3], v[232:235], v[192:195]
    ds_read_b128 v[248:251], v2 offset:52224
    v_mfma_f32_16x16x32_bf16 v[196:199], a[8:11], v[232:235], v[196:199]
    s_waitcnt lgkmcnt(2)
    v_mfma_f32_16x16x32_bf16 v[224:227], a[0:3], v[236:239], v[224:227]
    ds_read_b128 v[232:235], v2 offset:53248
    v_mfma_f32_16x16x32_bf16 v[228:231], a[8:11], v[236:239], v[228:231]
    s_waitcnt vmcnt(8)
    ds_read_b64_tr_b16 a[16:17], v6 offset:40960
    v_mfma_f32_16x16x32_bf16 v[32:35], a[4:7], v[240:243], v[32:35]
    ds_read_b128 v[236:239], v2 offset:54272
    v_mfma_f32_16x16x32_bf16 v[36:39], a[12:15], v[240:243], v[36:39]
    ds_read_b64_tr_b16 a[20:21], v7 offset:40960
    s_waitcnt lgkmcnt(4)
    v_mfma_f32_16x16x32_bf16 v[64:67], a[4:7], v[244:247], v[64:67]
    ds_read_b128 v[240:243], v2 offset:55296
    v_mfma_f32_16x16x32_bf16 v[68:71], a[12:15], v[244:247], v[68:71]
    ds_read_b64_tr_b16 a[24:25], v6 offset:41472
    v_mfma_f32_16x16x32_bf16 v[96:99], a[4:7], v[248:251], v[96:99]
    ds_read_b128 v[244:247], v2 offset:56320
    v_mfma_f32_16x16x32_bf16 v[100:103], a[12:15], v[248:251], v[100:103]
    ds_read_b64_tr_b16 a[28:29], v7 offset:41472
    s_waitcnt lgkmcnt(5)
    v_mfma_f32_16x16x32_bf16 v[128:131], a[4:7], v[232:235], v[128:131]
    v_mfma_f32_16x16x32_bf16 v[132:135], a[12:15], v[232:235], v[132:135]
    v_mfma_f32_16x16x32_bf16 v[160:163], a[4:7], v[236:239], v[160:163]
    v_mfma_f32_16x16x32_bf16 v[164:167], a[12:15], v[236:239], v[164:167]
    s_waitcnt lgkmcnt(1)
    v_mfma_f32_16x16x32_bf16 v[192:195], a[4:7], v[240:243], v[192:195]
    v_mfma_f32_16x16x32_bf16 v[196:199], a[12:15], v[240:243], v[196:199]
    v_mfma_f32_16x16x32_bf16 v[224:227], a[4:7], v[244:247], v[224:227]
    s_waitcnt lgkmcnt(0)
    s_mov_b32 m0, s57
    s_addk_i32 s71, 8192
    v_mfma_f32_16x16x32_bf16 v[228:231], a[12:15], v[244:247], v[228:231]
    buffer_load_dwordx4 v5, s[32:35], s71 offen nt lds
    s_mov_b32 s24, s40
    s_mov_b32 s25, s41
    s_mov_b32 s28, s44
    s_mov_b32 s29, s45
    s_cmp_eq_u32 s66, 3
    s_cselect_b32 s26, 0, s42
    s_cselect_b32 s30, 0, s46
    v_max3_f32 v232, v8, v9, v10
    v_max3_f32 v232, v232, v11, v12
    v_max3_f32 v232, v232, v13, v14
    v_max3_f32 v232, v232, v15, v16
    v_max3_f32 v232, v232, v17, v18
    buffer_load_dwordx4 v5, s[36:39], s71 offen offset:1024 nt lds
    v_max3_f32 v232, v232, v19, v20
    v_max3_f32 v232, v232, v21, v22
    v_max3_f32 v232, v232, v23, v24
    v_max3_f32 v232, v232, v25, v26
    v_max3_f32 v232, v232, v27, v28
    v_max3_f32 v232, v232, v29, v30
    v_max3_f32 v232, v232, v31, v32
    v_max3_f32 v232, v232, v33, v34
    v_max3_f32 v232, v232, v35, v36
    v_max3_f32 v232, v232, v37, v38
    v_max_f32 v232, v232, v39
    v_max3_f32 v233, v40, v41, v42
    v_max3_f32 v233, v233, v43, v44
    v_max3_f32 v233, v233, v45, v46
    v_max3_f32 v233, v233, v47, v48
    v_max3_f32 v233, v233, v49, v50
    v_max3_f32 v233, v233, v51, v52
    v_max3_f32 v233, v233, v53, v54
    v_max3_f32 v233, v233, v55, v56
    v_max3_f32 v233, v233, v57, v58
    v_max3_f32 v233, v233, v59, v60
    v_max3_f32 v233, v233, v61, v62
    v_max3_f32 v233, v233, v63, v64
    v_max3_f32 v233, v233, v65, v66
    v_max3_f32 v233, v233, v67, v68
    v_max3_f32 v233, v233, v69, v70
    v_max_f32 v233, v233, v71
    v_max3_f32 v234, v72, v73, v74
    v_max3_f32 v234, v234, v75, v76
    v_max3_f32 v234, v234, v77, v78
    v_max3_f32 v234, v234, v79, v80
    v_max3_f32 v234, v234, v81, v82
    s_waitcnt vmcnt(8)
    ds_read_b64_tr_b16 a[18:19], v6 offset:49152
    v_max3_f32 v234, v234, v83, v84
    v_max3_f32 v234, v234, v85, v86
    v_max3_f32 v234, v234, v87, v88
    v_max3_f32 v234, v234, v89, v90
    ds_read_b64_tr_b16 a[22:23], v7 offset:49152
    v_max3_f32 v234, v234, v91, v92
    v_max3_f32 v234, v234, v93, v94
    v_max3_f32 v234, v234, v95, v96
    v_max3_f32 v234, v234, v97, v98
    ds_read_b64_tr_b16 a[26:27], v6 offset:49664
    v_max3_f32 v234, v234, v99, v100
    v_max3_f32 v234, v234, v101, v102
    v_max_f32 v234, v234, v103
    v_max3_f32 v235, v104, v105, v106
    v_max3_f32 v235, v235, v107, v108
    v_max3_f32 v235, v235, v109, v110
    v_max3_f32 v235, v235, v111, v112
    v_max3_f32 v235, v235, v113, v114
    ds_read_b64_tr_b16 a[30:31], v7 offset:49664
    v_max3_f32 v235, v235, v115, v116
    v_max3_f32 v235, v235, v117, v118
    v_max3_f32 v235, v235, v119, v120
    v_max3_f32 v235, v235, v121, v122
    v_max3_f32 v235, v235, v123, v124
    v_max3_f32 v235, v235, v125, v126
    v_max3_f32 v235, v235, v127, v128
    v_max3_f32 v235, v235, v129, v130
    v_max3_f32 v235, v235, v131, v132
    v_max3_f32 v235, v235, v133, v134
    v_max_f32 v235, v235, v135
    v_max3_f32 v236, v136, v137, v138
    v_max3_f32 v236, v236, v139, v140
    v_max3_f32 v236, v236, v141, v142
    v_max3_f32 v236, v236, v143, v144
    v_max3_f32 v236, v236, v145, v146
    v_max3_f32 v236, v236, v147, v148
    v_max3_f32 v236, v236, v149, v150
    v_max3_f32 v236, v236, v151, v152
    v_max3_f32 v236, v236, v153, v154
    v_max3_f32 v236, v236, v155, v156
    v_max3_f32 v236, v236, v157, v158
    v_max3_f32 v236, v236, v159, v160
    v_max3_f32 v236, v236, v161, v162
    v_max3_f32 v236, v236, v163, v164
    v_max3_f32 v236, v236, v165, v166
    v_max_f32 v236, v236, v167
    v_max3_f32 v237, v168, v169, v170
    v_max3_f32 v237, v237, v171, v172
    v_max3_f32 v237, v237, v173, v174
    v_max3_f32 v237, v237, v175, v176
    v_max3_f32 v237, v237, v177, v178
    s_waitcnt lgkmcnt(0)
    s_mov_b32 m0, s58
    s_addk_i32 s71, 8192
    v_max3_f32 v237, v237, v179, v180
    v_max3_f32 v237, v237, v181, v182
    v_max3_f32 v237, v237, v183, v184
    v_max3_f32 v237, v237, v185, v186
    buffer_load_dwordx4 v5, s[32:35], s71 offen nt lds
    v_max3_f32 v237, v237, v187, v188
    v_max3_f32 v237, v237, v189, v190
    v_max3_f32 v237, v237, v191, v192
    v_max3_f32 v237, v237, v193, v194
    buffer_load_dwordx4 v5, s[36:39], s71 offen offset:1024 nt lds
    v_max3_f32 v237, v237, v195, v196
    v_max3_f32 v237, v237, v197, v198
    v_max_f32 v237, v237, v199
    v_max3_f32 v238, v200, v201, v202
    v_max3_f32 v238, v238, v203, v204
    v_max3_f32 v238, v238, v205, v206
    v_max3_f32 v238, v238, v207, v208
    v_max3_f32 v238, v238, v209, v210
    v_max3_f32 v238, v238, v211, v212
    v_max3_f32 v238, v238, v213, v214
    v_max3_f32 v238, v238, v215, v216
    v_max3_f32 v238, v238, v217, v218
    v_max3_f32 v238, v238, v219, v220
    v_max3_f32 v238, v238, v221, v222
    v_max3_f32 v238, v238, v223, v224
    v_max3_f32 v238, v238, v225, v226
    v_max3_f32 v238, v238, v227, v228
    v_max3_f32 v238, v238, v229, v230
    v_max_f32 v238, v238, v231
    v_mov_b32 v240, v232
    v_mov_b32 v241, v233
    v_mov_b32 v242, v234
    v_mov_b32 v243, v235
    v_mov_b32 v244, v236
    v_mov_b32 v245, v237
    v_mov_b32 v246, v238
    v_permlane32_swap_b32 v232, v240
    v_permlane32_swap_b32 v233, v241
    v_permlane32_swap_b32 v234, v242
    v_permlane32_swap_b32 v235, v243
    v_permlane32_swap_b32 v236, v244
    v_permlane32_swap_b32 v237, v245
    v_permlane32_swap_b32 v238, v246
    v_max_f32 v232, v232, v240
    v_max_f32 v233, v233, v241
    v_max_f32 v234, v234, v242
    v_max_f32 v235, v235, v243
    v_max_f32 v236, v236, v244
    v_max_f32 v237, v237, v245
    v_max_f32 v238, v238, v246
    s_waitcnt vmcnt(8)
    ds_read_b64_tr_b16 a[0:1], v6 offset:24576
    v_mov_b32 v240, v232
    v_mov_b32 v241, v233
    v_mov_b32 v242, v234
    v_mov_b32 v243, v235
    v_mov_b32 v244, v236
    v_mov_b32 v245, v237
    v_mov_b32 v246, v238
    v_permlane16_swap_b32 v232, v240
    v_permlane16_swap_b32 v233, v241
    v_permlane16_swap_b32 v234, v242
    v_permlane16_swap_b32 v235, v243
    v_permlane16_swap_b32 v236, v244
    v_permlane16_swap_b32 v237, v245
    v_permlane16_swap_b32 v238, v246
    v_max_f32 v232, v232, v240
    v_max_f32 v233, v233, v241
    v_max_f32 v234, v234, v242
    v_max_f32 v235, v235, v243
    v_max_f32 v236, v236, v244
    v_max_f32 v237, v237, v245
    v_max_f32 v238, v238, v246
    v_and_b32 v2, 0xf0, v0
    v_add_u32 v2, 157696, v2
    s_lshl_b32 s3, s66, 2
    v_add_u32 v1, s3, v2
    s_mov_b64 exec, 0xffff
    ds_write_b32 v1, v232 offset:0
    ds_write_b32 v1, v233 offset:256
    ds_write_b32 v1, v234 offset:512
    ds_write_b32 v1, v235 offset:768
    ds_write_b32 v1, v236 offset:1024
    ds_write_b32 v1, v237 offset:1280
    ds_write_b32 v1, v238 offset:1536
    s_mov_b64 exec, -1
    s_waitcnt lgkmcnt(0)
    s_barrier
    ds_read_b128 v[240:243], v2 offset:0
    ds_read_b128 v[244:247], v2 offset:256
    ds_read_b128 v[248:251], v2 offset:512
    ds_read_b128 v[252:255], v2 offset:768
    s_waitcnt lgkmcnt(3)
    v_max3_f32 v232, v240, v241, v242
    v_max_f32 v232, v232, v243
    ds_read_b128 v[240:243], v2 offset:1024
    s_waitcnt lgkmcnt(3)
    v_max3_f32 v233, v244, v245, v246
    v_max_f32 v233, v233, v247
    ds_read_b128 v[244:247], v2 offset:1280
    s_waitcnt lgkmcnt(3)
    v_max3_f32 v234, v248, v249, v250
    v_max_f32 v234, v234, v251
    ds_read_b128 v[248:251], v2 offset:1536
    s_waitcnt lgkmcnt(3)
    v_max3_f32 v235, v252, v253, v254
    v_max_f32 v235, v235, v255
    s_waitcnt lgkmcnt(2)
    v_max3_f32 v236, v240, v241, v242
    v_max_f32 v236, v236, v243
    s_waitcnt lgkmcnt(1)
    v_max3_f32 v237, v244, v245, v246
    v_max_f32 v237, v237, v247
    s_waitcnt lgkmcnt(0)
    v_max3_f32 v238, v248, v249, v250
    v_max_f32 v238, v238, v251
    v_mul_f32 v232, s68, v232
    v_mul_f32 v233, s68, v233
    v_mul_f32 v234, s68, v234
    v_mul_f32 v235, s68, v235
    v_mul_f32 v236, s68, v236
    v_mul_f32 v237, s68, v237
    v_mul_f32 v238, s68, v238
    s_mul_i32 s3, s66, 28672
    v_add_u32 v1, s3, v0
    v_fma_f32 v8, v8, s68, -v232
    v_fma_f32 v9, v9, s68, -v232
    v_fma_f32 v10, v10, s68, -v232
    v_fma_f32 v11, v11, s68, -v232
    v_fma_f32 v12, v12, s68, -v232
    v_fma_f32 v13, v13, s68, -v232
    v_fma_f32 v14, v14, s68, -v232
    v_fma_f32 v15, v15, s68, -v232
    ds_read_b64_tr_b16 a[4:5], v7 offset:24576
    v_exp_f32 v8, v8
    v_exp_f32 v9, v9
    v_exp_f32 v10, v10
    v_exp_f32 v11, v11
    v_exp_f32 v12, v12
    v_exp_f32 v13, v13
    v_exp_f32 v14, v14
    v_exp_f32 v15, v15
    ds_read_b64_tr_b16 a[8:9], v6 offset:25088
    v_add_f32 v240, v8, v9
    v_add_f32 v240, v240, v10
    v_add_f32 v240, v240, v11
    v_add_f32 v240, v240, v12
    v_add_f32 v240, v240, v13
    v_add_f32 v240, v240, v14
    v_add_f32 v240, v240, v15
    v_cvt_pk_bf16_f32 v8, v8, v9
    v_cvt_pk_bf16_f32 v9, v10, v11
    v_cvt_pk_bf16_f32 v10, v12, v13
    v_cvt_pk_bf16_f32 v11, v14, v15
    ds_write_b128 v1, v[8:11] offset:0
    ds_read_b64_tr_b16 a[12:13], v7 offset:25088
    v_fma_f32 v16, v16, s68, -v232
    v_fma_f32 v17, v17, s68, -v232
    v_fma_f32 v18, v18, s68, -v232
    v_fma_f32 v19, v19, s68, -v232
    v_fma_f32 v20, v20, s68, -v232
    v_fma_f32 v21, v21, s68, -v232
    v_fma_f32 v22, v22, s68, -v232
    v_fma_f32 v23, v23, s68, -v232
    s_waitcnt vmcnt(6)
    ds_read_b64_tr_b16 a[2:3], v6 offset:32768
    v_exp_f32 v16, v16
    v_exp_f32 v17, v17
    v_exp_f32 v18, v18
    v_exp_f32 v19, v19
    v_exp_f32 v20, v20
    v_exp_f32 v21, v21
    v_exp_f32 v22, v22
    v_exp_f32 v23, v23
    ds_read_b64_tr_b16 a[6:7], v7 offset:32768
    s_waitcnt lgkmcnt(2)
    s_mov_b32 m0, s55
    v_add_f32 v240, v240, v16
    v_add_f32 v240, v240, v17
    v_add_f32 v240, v240, v18
    v_add_f32 v240, v240, v19
    v_add_f32 v240, v240, v20
    v_add_f32 v240, v240, v21
    v_add_f32 v240, v240, v22
    v_add_f32 v240, v240, v23
    v_cvt_pk_bf16_f32 v16, v16, v17
    v_cvt_pk_bf16_f32 v17, v18, v19
    v_cvt_pk_bf16_f32 v18, v20, v21
    v_cvt_pk_bf16_f32 v19, v22, v23
    ds_write_b128 v1, v[16:19] offset:7168
    s_addk_i32 s71, 8192
    buffer_load_dwordx4 v5, s[32:35], s71 offen nt lds
    v_fma_f32 v24, v24, s68, -v232
    v_fma_f32 v25, v25, s68, -v232
    v_fma_f32 v26, v26, s68, -v232
    v_fma_f32 v27, v27, s68, -v232
    v_fma_f32 v28, v28, s68, -v232
    v_fma_f32 v29, v29, s68, -v232
    v_fma_f32 v30, v30, s68, -v232
    v_fma_f32 v31, v31, s68, -v232
    buffer_load_dwordx4 v5, s[36:39], s71 offen offset:1024 nt lds
    v_exp_f32 v24, v24
    v_exp_f32 v25, v25
    v_exp_f32 v26, v26
    v_exp_f32 v27, v27
    v_exp_f32 v28, v28
    v_exp_f32 v29, v29
    v_exp_f32 v30, v30
    v_exp_f32 v31, v31
    ds_read_b64_tr_b16 a[10:11], v6 offset:33280
    v_add_f32 v240, v240, v24
    v_add_f32 v240, v240, v25
    v_add_f32 v240, v240, v26
    v_add_f32 v240, v240, v27
    v_add_f32 v240, v240, v28
    v_add_f32 v240, v240, v29
    v_add_f32 v240, v240, v30
    v_add_f32 v240, v240, v31
    v_cvt_pk_bf16_f32 v24, v24, v25
    v_cvt_pk_bf16_f32 v25, v26, v27
    v_cvt_pk_bf16_f32 v26, v28, v29
    v_cvt_pk_bf16_f32 v27, v30, v31
    ds_write_b128 v1, v[24:27] offset:14336
    ds_read_b64_tr_b16 a[14:15], v7 offset:33280
    v_fma_f32 v32, v32, s68, -v232
    v_fma_f32 v33, v33, s68, -v232
    v_fma_f32 v34, v34, s68, -v232
    v_fma_f32 v35, v35, s68, -v232
    v_fma_f32 v36, v36, s68, -v232
    v_fma_f32 v37, v37, s68, -v232
    v_fma_f32 v38, v38, s68, -v232
    v_fma_f32 v39, v39, s68, -v232
    v_exp_f32 v32, v32
    v_exp_f32 v33, v33
    v_exp_f32 v34, v34
    v_exp_f32 v35, v35
    v_exp_f32 v36, v36
    v_exp_f32 v37, v37
    v_exp_f32 v38, v38
    v_exp_f32 v39, v39
    v_add_f32 v240, v240, v32
    v_add_f32 v240, v240, v33
    v_add_f32 v240, v240, v34
    v_add_f32 v240, v240, v35
    v_add_f32 v240, v240, v36
    v_add_f32 v240, v240, v37
    v_add_f32 v240, v240, v38
    v_add_f32 v240, v240, v39
    v_cvt_pk_bf16_f32 v32, v32, v33
    v_cvt_pk_bf16_f32 v33, v34, v35
    v_cvt_pk_bf16_f32 v34, v36, v37
    v_cvt_pk_bf16_f32 v35, v38, v39
    ds_write_b128 v1, v[32:35] offset:21504
    s_waitcnt lgkmcnt(1)
    s_mov_b32 m0, s56
    s_addk_i32 s71, 8192
    v_fma_f32 v40, v40, s68, -v233
    v_fma_f32 v41, v41, s68, -v233
    v_fma_f32 v42, v42, s68, -v233
    v_fma_f32 v43, v43, s68, -v233
    v_fma_f32 v44, v44, s68, -v233
    v_fma_f32 v45, v45, s68, -v233
    v_fma_f32 v46, v46, s68, -v233
    v_fma_f32 v47, v47, s68, -v233
    buffer_load_dwordx4 v5, s[32:35], s71 offen nt lds
    v_exp_f32 v40, v40
    v_exp_f32 v41, v41
    v_exp_f32 v42, v42
    v_exp_f32 v43, v43
    v_exp_f32 v44, v44
    v_exp_f32 v45, v45
    v_exp_f32 v46, v46
    v_exp_f32 v47, v47
    buffer_load_dwordx4 v5, s[36:39], s71 offen offset:1024 nt lds
    v_add_f32 v241, v40, v41
    v_add_f32 v241, v241, v42
    v_add_f32 v241, v241, v43
    v_add_f32 v241, v241, v44
    v_add_f32 v241, v241, v45
    v_add_f32 v241, v241, v46
    v_add_f32 v241, v241, v47
    v_cvt_pk_bf16_f32 v40, v40, v41
    v_cvt_pk_bf16_f32 v41, v42, v43
    v_cvt_pk_bf16_f32 v42, v44, v45
    v_cvt_pk_bf16_f32 v43, v46, v47
    ds_write_b128 v1, v[40:43] offset:1024
    v_fma_f32 v48, v48, s68, -v233
    v_fma_f32 v49, v49, s68, -v233
    v_fma_f32 v50, v50, s68, -v233
    v_fma_f32 v51, v51, s68, -v233
    v_fma_f32 v52, v52, s68, -v233
    v_fma_f32 v53, v53, s68, -v233
    v_fma_f32 v54, v54, s68, -v233
    v_fma_f32 v55, v55, s68, -v233
    s_waitcnt vmcnt(8)
    ds_read_b64_tr_b16 a[32:33], v6 offset:16384
    v_exp_f32 v48, v48
    v_exp_f32 v49, v49
    v_exp_f32 v50, v50
    v_exp_f32 v51, v51
    v_exp_f32 v52, v52
    v_exp_f32 v53, v53
    v_exp_f32 v54, v54
    v_exp_f32 v55, v55
    ds_read_b64_tr_b16 a[36:37], v7 offset:16384
    v_add_f32 v241, v241, v48
    v_add_f32 v241, v241, v49
    v_add_f32 v241, v241, v50
    v_add_f32 v241, v241, v51
    v_add_f32 v241, v241, v52
    v_add_f32 v241, v241, v53
    v_add_f32 v241, v241, v54
    v_add_f32 v241, v241, v55
    v_cvt_pk_bf16_f32 v48, v48, v49
    v_cvt_pk_bf16_f32 v49, v50, v51
    v_cvt_pk_bf16_f32 v50, v52, v53
    v_cvt_pk_bf16_f32 v51, v54, v55
    ds_write_b128 v1, v[48:51] offset:8192
    ds_read_b64_tr_b16 a[40:41], v6 offset:16896
    v_fma_f32 v56, v56, s68, -v233
    v_fma_f32 v57, v57, s68, -v233
    v_fma_f32 v58, v58, s68, -v233
    v_fma_f32 v59, v59, s68, -v233
    v_fma_f32 v60, v60, s68, -v233
    v_fma_f32 v61, v61, s68, -v233
    v_fma_f32 v62, v62, s68, -v233
    v_fma_f32 v63, v63, s68, -v233
    ds_read_b64_tr_b16 a[44:45], v7 offset:16896
    v_exp_f32 v56, v56
    v_exp_f32 v57, v57
    v_exp_f32 v58, v58
    v_exp_f32 v59, v59
    v_exp_f32 v60, v60
    v_exp_f32 v61, v61
    v_exp_f32 v62, v62
    v_exp_f32 v63, v63
    v_add_f32 v241, v241, v56
    v_add_f32 v241, v241, v57
    v_add_f32 v241, v241, v58
    v_add_f32 v241, v241, v59
    v_add_f32 v241, v241, v60
    v_add_f32 v241, v241, v61
    v_add_f32 v241, v241, v62
    v_add_f32 v241, v241, v63
    v_cvt_pk_bf16_f32 v56, v56, v57
    v_cvt_pk_bf16_f32 v57, v58, v59
    v_cvt_pk_bf16_f32 v58, v60, v61
    v_cvt_pk_bf16_f32 v59, v62, v63
    ds_write_b128 v1, v[56:59] offset:15360
    s_waitcnt lgkmcnt(1)
    s_mov_b32 m0, s54
    s_addk_i32 s71, 8192
    v_fma_f32 v64, v64, s68, -v233
    v_fma_f32 v65, v65, s68, -v233
    v_fma_f32 v66, v66, s68, -v233
    v_fma_f32 v67, v67, s68, -v233
    v_fma_f32 v68, v68, s68, -v233
    v_fma_f32 v69, v69, s68, -v233
    v_fma_f32 v70, v70, s68, -v233
    v_fma_f32 v71, v71, s68, -v233
    buffer_load_dwordx4 v5, s[32:35], s71 offen nt lds
    v_exp_f32 v64, v64
    v_exp_f32 v65, v65
    v_exp_f32 v66, v66
    v_exp_f32 v67, v67
    v_exp_f32 v68, v68
    v_exp_f32 v69, v69
    v_exp_f32 v70, v70
    v_exp_f32 v71, v71
    buffer_load_dwordx4 v5, s[36:39], s71 offen offset:1024 nt lds
    v_add_f32 v241, v241, v64
    v_add_f32 v241, v241, v65
    v_add_f32 v241, v241, v66
    v_add_f32 v241, v241, v67
    v_add_f32 v241, v241, v68
    v_add_f32 v241, v241, v69
    v_add_f32 v241, v241, v70
    v_add_f32 v241, v241, v71
    v_cvt_pk_bf16_f32 v64, v64, v65
    v_cvt_pk_bf16_f32 v65, v66, v67
    v_cvt_pk_bf16_f32 v66, v68, v69
    v_cvt_pk_bf16_f32 v67, v70, v71
    ds_write_b128 v1, v[64:67] offset:22528
    v_fma_f32 v72, v72, s68, -v234
    v_fma_f32 v73, v73, s68, -v234
    v_fma_f32 v74, v74, s68, -v234
    v_fma_f32 v75, v75, s68, -v234
    v_fma_f32 v76, v76, s68, -v234
    v_fma_f32 v77, v77, s68, -v234
    v_fma_f32 v78, v78, s68, -v234
    v_fma_f32 v79, v79, s68, -v234
    s_waitcnt vmcnt(8)
    ds_read_b64_tr_b16 a[34:35], v6 offset:40960
    v_exp_f32 v72, v72
    v_exp_f32 v73, v73
    v_exp_f32 v74, v74
    v_exp_f32 v75, v75
    v_exp_f32 v76, v76
    v_exp_f32 v77, v77
    v_exp_f32 v78, v78
    v_exp_f32 v79, v79
    ds_read_b64_tr_b16 a[38:39], v7 offset:40960
    v_add_f32 v242, v72, v73
    v_add_f32 v242, v242, v74
    v_add_f32 v242, v242, v75
    v_add_f32 v242, v242, v76
    v_add_f32 v242, v242, v77
    v_add_f32 v242, v242, v78
    v_add_f32 v242, v242, v79
    v_cvt_pk_bf16_f32 v72, v72, v73
    v_cvt_pk_bf16_f32 v73, v74, v75
    v_cvt_pk_bf16_f32 v74, v76, v77
    v_cvt_pk_bf16_f32 v75, v78, v79
    ds_write_b128 v1, v[72:75] offset:2048
    ds_read_b64_tr_b16 a[42:43], v6 offset:41472
    v_fma_f32 v80, v80, s68, -v234
    v_fma_f32 v81, v81, s68, -v234
    v_fma_f32 v82, v82, s68, -v234
    v_fma_f32 v83, v83, s68, -v234
    v_fma_f32 v84, v84, s68, -v234
    v_fma_f32 v85, v85, s68, -v234
    v_fma_f32 v86, v86, s68, -v234
    v_fma_f32 v87, v87, s68, -v234
    ds_read_b64_tr_b16 a[46:47], v7 offset:41472
    v_exp_f32 v80, v80
    v_exp_f32 v81, v81
    v_exp_f32 v82, v82
    v_exp_f32 v83, v83
    v_exp_f32 v84, v84
    v_exp_f32 v85, v85
    v_exp_f32 v86, v86
    v_exp_f32 v87, v87
    v_add_f32 v242, v242, v80
    v_add_f32 v242, v242, v81
    v_add_f32 v242, v242, v82
    v_add_f32 v242, v242, v83
    v_add_f32 v242, v242, v84
    v_add_f32 v242, v242, v85
    v_add_f32 v242, v242, v86
    v_add_f32 v242, v242, v87
    v_cvt_pk_bf16_f32 v80, v80, v81
    v_cvt_pk_bf16_f32 v81, v82, v83
    v_cvt_pk_bf16_f32 v82, v84, v85
    v_cvt_pk_bf16_f32 v83, v86, v87
    ds_write_b128 v1, v[80:83] offset:9216
    s_waitcnt lgkmcnt(1)
    s_mov_b32 m0, s57
    s_addk_i32 s71, 8192
    v_fma_f32 v88, v88, s68, -v234
    v_fma_f32 v89, v89, s68, -v234
    v_fma_f32 v90, v90, s68, -v234
    v_fma_f32 v91, v91, s68, -v234
    v_fma_f32 v92, v92, s68, -v234
    v_fma_f32 v93, v93, s68, -v234
    v_fma_f32 v94, v94, s68, -v234
    v_fma_f32 v95, v95, s68, -v234
    buffer_load_dwordx4 v5, s[32:35], s71 offen nt lds
    v_exp_f32 v88, v88
    v_exp_f32 v89, v89
    v_exp_f32 v90, v90
    v_exp_f32 v91, v91
    v_exp_f32 v92, v92
    v_exp_f32 v93, v93
    v_exp_f32 v94, v94
    v_exp_f32 v95, v95
    buffer_load_dwordx4 v5, s[36:39], s71 offen offset:1024 nt lds
    v_add_f32 v242, v242, v88
    v_add_f32 v242, v242, v89
    v_add_f32 v242, v242, v90
    v_add_f32 v242, v242, v91
    v_add_f32 v242, v242, v92
    v_add_f32 v242, v242, v93
    v_add_f32 v242, v242, v94
    v_add_f32 v242, v242, v95
    v_cvt_pk_bf16_f32 v88, v88, v89
    v_cvt_pk_bf16_f32 v89, v90, v91
    v_cvt_pk_bf16_f32 v90, v92, v93
    v_cvt_pk_bf16_f32 v91, v94, v95
    ds_write_b128 v1, v[88:91] offset:16384
    s_waitcnt vmcnt(8)
    ds_read_b64_tr_b16 a[48:49], v6 offset:49152
    v_fma_f32 v96, v96, s68, -v234
    v_fma_f32 v97, v97, s68, -v234
    v_fma_f32 v98, v98, s68, -v234
    v_fma_f32 v99, v99, s68, -v234
    v_fma_f32 v100, v100, s68, -v234
    v_fma_f32 v101, v101, s68, -v234
    v_fma_f32 v102, v102, s68, -v234
    v_fma_f32 v103, v103, s68, -v234
    ds_read_b64_tr_b16 a[52:53], v7 offset:49152
    v_exp_f32 v96, v96
    v_exp_f32 v97, v97
    v_exp_f32 v98, v98
    v_exp_f32 v99, v99
    v_exp_f32 v100, v100
    v_exp_f32 v101, v101
    v_exp_f32 v102, v102
    v_exp_f32 v103, v103
    ds_read_b64_tr_b16 a[56:57], v6 offset:49664
    v_add_f32 v242, v242, v96
    v_add_f32 v242, v242, v97
    v_add_f32 v242, v242, v98
    v_add_f32 v242, v242, v99
    v_add_f32 v242, v242, v100
    v_add_f32 v242, v242, v101
    v_add_f32 v242, v242, v102
    v_add_f32 v242, v242, v103
    v_cvt_pk_bf16_f32 v96, v96, v97
    v_cvt_pk_bf16_f32 v97, v98, v99
    v_cvt_pk_bf16_f32 v98, v100, v101
    v_cvt_pk_bf16_f32 v99, v102, v103
    ds_write_b128 v1, v[96:99] offset:23552
    ds_read_b64_tr_b16 a[60:61], v7 offset:49664
    v_fma_f32 v104, v104, s68, -v235
    v_fma_f32 v105, v105, s68, -v235
    v_fma_f32 v106, v106, s68, -v235
    v_fma_f32 v107, v107, s68, -v235
    v_fma_f32 v108, v108, s68, -v235
    v_fma_f32 v109, v109, s68, -v235
    v_fma_f32 v110, v110, s68, -v235
    v_fma_f32 v111, v111, s68, -v235
    v_exp_f32 v104, v104
    v_exp_f32 v105, v105
    v_exp_f32 v106, v106
    v_exp_f32 v107, v107
    v_exp_f32 v108, v108
    v_exp_f32 v109, v109
    v_exp_f32 v110, v110
    v_exp_f32 v111, v111
    v_add_f32 v243, v104, v105
    v_add_f32 v243, v243, v106
    v_add_f32 v243, v243, v107
    v_add_f32 v243, v243, v108
    v_add_f32 v243, v243, v109
    v_add_f32 v243, v243, v110
    v_add_f32 v243, v243, v111
    v_cvt_pk_bf16_f32 v104, v104, v105
    v_cvt_pk_bf16_f32 v105, v106, v107
    v_cvt_pk_bf16_f32 v106, v108, v109
    v_cvt_pk_bf16_f32 v107, v110, v111
    ds_write_b128 v1, v[104:107] offset:3072
    s_waitcnt lgkmcnt(1)
    s_mov_b32 m0, s58
    s_addk_i32 s71, 8192
    v_fma_f32 v112, v112, s68, -v235
    v_fma_f32 v113, v113, s68, -v235
    v_fma_f32 v114, v114, s68, -v235
    v_fma_f32 v115, v115, s68, -v235
    v_fma_f32 v116, v116, s68, -v235
    v_fma_f32 v117, v117, s68, -v235
    v_fma_f32 v118, v118, s68, -v235
    v_fma_f32 v119, v119, s68, -v235
    buffer_load_dwordx4 v5, s[32:35], s71 offen nt lds
    v_exp_f32 v112, v112
    v_exp_f32 v113, v113
    v_exp_f32 v114, v114
    v_exp_f32 v115, v115
    v_exp_f32 v116, v116
    v_exp_f32 v117, v117
    v_exp_f32 v118, v118
    v_exp_f32 v119, v119
    buffer_load_dwordx4 v5, s[36:39], s71 offen offset:1024 nt lds
    v_add_f32 v243, v243, v112
    v_add_f32 v243, v243, v113
    v_add_f32 v243, v243, v114
    v_add_f32 v243, v243, v115
    v_add_f32 v243, v243, v116
    v_add_f32 v243, v243, v117
    v_add_f32 v243, v243, v118
    v_add_f32 v243, v243, v119
    v_cvt_pk_bf16_f32 v112, v112, v113
    v_cvt_pk_bf16_f32 v113, v114, v115
    v_cvt_pk_bf16_f32 v114, v116, v117
    v_cvt_pk_bf16_f32 v115, v118, v119
    ds_write_b128 v1, v[112:115] offset:10240
    v_fma_f32 v120, v120, s68, -v235
    v_fma_f32 v121, v121, s68, -v235
    v_fma_f32 v122, v122, s68, -v235
    v_fma_f32 v123, v123, s68, -v235
    v_fma_f32 v124, v124, s68, -v235
    v_fma_f32 v125, v125, s68, -v235
    v_fma_f32 v126, v126, s68, -v235
    v_fma_f32 v127, v127, s68, -v235
    v_exp_f32 v120, v120
    v_exp_f32 v121, v121
    v_exp_f32 v122, v122
    v_exp_f32 v123, v123
    v_exp_f32 v124, v124
    v_exp_f32 v125, v125
    v_exp_f32 v126, v126
    v_exp_f32 v127, v127
    v_add_f32 v243, v243, v120
    v_add_f32 v243, v243, v121
    v_add_f32 v243, v243, v122
    v_add_f32 v243, v243, v123
    v_add_f32 v243, v243, v124
    v_add_f32 v243, v243, v125
    v_add_f32 v243, v243, v126
    v_add_f32 v243, v243, v127
    v_cvt_pk_bf16_f32 v120, v120, v121
    v_cvt_pk_bf16_f32 v121, v122, v123
    v_cvt_pk_bf16_f32 v122, v124, v125
    v_cvt_pk_bf16_f32 v123, v126, v127
    ds_write_b128 v1, v[120:123] offset:17408
    v_fma_f32 v128, v128, s68, -v235
    v_fma_f32 v129, v129, s68, -v235
    v_fma_f32 v130, v130, s68, -v235
    v_fma_f32 v131, v131, s68, -v235
    v_fma_f32 v132, v132, s68, -v235
    v_fma_f32 v133, v133, s68, -v235
    v_fma_f32 v134, v134, s68, -v235
    v_fma_f32 v135, v135, s68, -v235
    v_exp_f32 v128, v128
    v_exp_f32 v129, v129
    v_exp_f32 v130, v130
    v_exp_f32 v131, v131
    v_exp_f32 v132, v132
    v_exp_f32 v133, v133
    v_exp_f32 v134, v134
    v_exp_f32 v135, v135
    s_waitcnt vmcnt(8)
    ds_read_b64_tr_b16 a[50:51], v6 offset:24576
    v_add_f32 v243, v243, v128
    v_add_f32 v243, v243, v129
    v_add_f32 v243, v243, v130
    v_add_f32 v243, v243, v131
    v_add_f32 v243, v243, v132
    v_add_f32 v243, v243, v133
    v_add_f32 v243, v243, v134
    v_add_f32 v243, v243, v135
    v_cvt_pk_bf16_f32 v128, v128, v129
    v_cvt_pk_bf16_f32 v129, v130, v131
    v_cvt_pk_bf16_f32 v130, v132, v133
    v_cvt_pk_bf16_f32 v131, v134, v135
    ds_write_b128 v1, v[128:131] offset:24576
    ds_read_b64_tr_b16 a[54:55], v7 offset:24576
    v_fma_f32 v136, v136, s68, -v236
    v_fma_f32 v137, v137, s68, -v236
    v_fma_f32 v138, v138, s68, -v236
    v_fma_f32 v139, v139, s68, -v236
    v_fma_f32 v140, v140, s68, -v236
    v_fma_f32 v141, v141, s68, -v236
    v_fma_f32 v142, v142, s68, -v236
    v_fma_f32 v143, v143, s68, -v236
    ds_read_b64_tr_b16 a[58:59], v6 offset:25088
    v_exp_f32 v136, v136
    v_exp_f32 v137, v137
    v_exp_f32 v138, v138
    v_exp_f32 v139, v139
    v_exp_f32 v140, v140
    v_exp_f32 v141, v141
    v_exp_f32 v142, v142
    v_exp_f32 v143, v143
    ds_read_b64_tr_b16 a[62:63], v7 offset:25088
    v_add_f32 v244, v136, v137
    v_add_f32 v244, v244, v138
    v_add_f32 v244, v244, v139
    v_add_f32 v244, v244, v140
    v_add_f32 v244, v244, v141
    v_add_f32 v244, v244, v142
    v_add_f32 v244, v244, v143
    v_cvt_pk_bf16_f32 v136, v136, v137
    v_cvt_pk_bf16_f32 v137, v138, v139
    v_cvt_pk_bf16_f32 v138, v140, v141
    v_cvt_pk_bf16_f32 v139, v142, v143
    ds_write_b128 v1, v[136:139] offset:4096
    v_fma_f32 v144, v144, s68, -v236
    v_fma_f32 v145, v145, s68, -v236
    v_fma_f32 v146, v146, s68, -v236
    v_fma_f32 v147, v147, s68, -v236
    v_fma_f32 v148, v148, s68, -v236
    v_fma_f32 v149, v149, s68, -v236
    v_fma_f32 v150, v150, s68, -v236
    v_fma_f32 v151, v151, s68, -v236
    v_exp_f32 v144, v144
    v_exp_f32 v145, v145
    v_exp_f32 v146, v146
    v_exp_f32 v147, v147
    v_exp_f32 v148, v148
    v_exp_f32 v149, v149
    v_exp_f32 v150, v150
    v_exp_f32 v151, v151
    s_waitcnt lgkmcnt(1)
    s_mov_b32 m0, s55
    s_addk_i32 s71, 8192
    v_add_f32 v244, v244, v144
    v_add_f32 v244, v244, v145
    v_add_f32 v244, v244, v146
    v_add_f32 v244, v244, v147
    v_add_f32 v244, v244, v148
    v_add_f32 v244, v244, v149
    v_add_f32 v244, v244, v150
    v_add_f32 v244, v244, v151
    v_cvt_pk_bf16_f32 v144, v144, v145
    v_cvt_pk_bf16_f32 v145, v146, v147
    v_cvt_pk_bf16_f32 v146, v148, v149
    v_cvt_pk_bf16_f32 v147, v150, v151
    ds_write_b128 v1, v[144:147] offset:11264
    buffer_load_dwordx4 v5, s[32:35], s71 offen nt lds
    v_fma_f32 v152, v152, s68, -v236
    v_fma_f32 v153, v153, s68, -v236
    v_fma_f32 v154, v154, s68, -v236
    v_fma_f32 v155, v155, s68, -v236
    v_fma_f32 v156, v156, s68, -v236
    v_fma_f32 v157, v157, s68, -v236
    v_fma_f32 v158, v158, s68, -v236
    v_fma_f32 v159, v159, s68, -v236
    buffer_load_dwordx4 v5, s[36:39], s71 offen offset:1024 nt lds
    s_waitcnt vmcnt(8)
    v_exp_f32 v152, v152
    v_exp_f32 v153, v153
    v_exp_f32 v154, v154
    v_exp_f32 v155, v155
    v_exp_f32 v156, v156
    v_exp_f32 v157, v157
    v_exp_f32 v158, v158
    v_exp_f32 v159, v159
    ds_read_b64_tr_b16 a[64:65], v6 offset:32768
    v_add_f32 v244, v244, v152
    v_add_f32 v244, v244, v153
    v_add_f32 v244, v244, v154
    v_add_f32 v244, v244, v155
    v_add_f32 v244, v244, v156
    v_add_f32 v244, v244, v157
    v_add_f32 v244, v244, v158
    v_add_f32 v244, v244, v159
    v_cvt_pk_bf16_f32 v152, v152, v153
    v_cvt_pk_bf16_f32 v153, v154, v155
    v_cvt_pk_bf16_f32 v154, v156, v157
    v_cvt_pk_bf16_f32 v155, v158, v159
    ds_write_b128 v1, v[152:155] offset:18432
    ds_read_b64_tr_b16 a[68:69], v7 offset:32768
    v_fma_f32 v160, v160, s68, -v236
    v_fma_f32 v161, v161, s68, -v236
    v_fma_f32 v162, v162, s68, -v236
    v_fma_f32 v163, v163, s68, -v236
    v_fma_f32 v164, v164, s68, -v236
    v_fma_f32 v165, v165, s68, -v236
    v_fma_f32 v166, v166, s68, -v236
    v_fma_f32 v167, v167, s68, -v236
    ds_read_b64_tr_b16 a[72:73], v6 offset:33280
    v_exp_f32 v160, v160
    v_exp_f32 v161, v161
    v_exp_f32 v162, v162
    v_exp_f32 v163, v163
    v_exp_f32 v164, v164
    v_exp_f32 v165, v165
    v_exp_f32 v166, v166
    v_exp_f32 v167, v167
    ds_read_b64_tr_b16 a[76:77], v7 offset:33280
    v_add_f32 v244, v244, v160
    v_add_f32 v244, v244, v161
    v_add_f32 v244, v244, v162
    v_add_f32 v244, v244, v163
    v_add_f32 v244, v244, v164
    v_add_f32 v244, v244, v165
    v_add_f32 v244, v244, v166
    v_add_f32 v244, v244, v167
    v_cvt_pk_bf16_f32 v160, v160, v161
    v_cvt_pk_bf16_f32 v161, v162, v163
    v_cvt_pk_bf16_f32 v162, v164, v165
    v_cvt_pk_bf16_f32 v163, v166, v167
    ds_write_b128 v1, v[160:163] offset:25600
    v_fma_f32 v168, v168, s68, -v237
    v_fma_f32 v169, v169, s68, -v237
    v_fma_f32 v170, v170, s68, -v237
    v_fma_f32 v171, v171, s68, -v237
    v_fma_f32 v172, v172, s68, -v237
    v_fma_f32 v173, v173, s68, -v237
    v_fma_f32 v174, v174, s68, -v237
    v_fma_f32 v175, v175, s68, -v237
    v_exp_f32 v168, v168
    v_exp_f32 v169, v169
    v_exp_f32 v170, v170
    v_exp_f32 v171, v171
    v_exp_f32 v172, v172
    v_exp_f32 v173, v173
    v_exp_f32 v174, v174
    v_exp_f32 v175, v175
    s_waitcnt lgkmcnt(1)
    s_mov_b32 m0, s56
    s_addk_i32 s71, 8192
    v_add_f32 v245, v168, v169
    v_add_f32 v245, v245, v170
    v_add_f32 v245, v245, v171
    v_add_f32 v245, v245, v172
    v_add_f32 v245, v245, v173
    v_add_f32 v245, v245, v174
    v_add_f32 v245, v245, v175
    v_cvt_pk_bf16_f32 v168, v168, v169
    v_cvt_pk_bf16_f32 v169, v170, v171
    v_cvt_pk_bf16_f32 v170, v172, v173
    v_cvt_pk_bf16_f32 v171, v174, v175
    ds_write_b128 v1, v[168:171] offset:5120
    buffer_load_dwordx4 v5, s[32:35], s71 offen nt lds
    s_waitcnt vmcnt(7)
    v_fma_f32 v176, v176, s68, -v237
    v_fma_f32 v177, v177, s68, -v237
    v_fma_f32 v178, v178, s68, -v237
    v_fma_f32 v179, v179, s68, -v237
    v_fma_f32 v180, v180, s68, -v237
    v_fma_f32 v181, v181, s68, -v237
    v_fma_f32 v182, v182, s68, -v237
    v_fma_f32 v183, v183, s68, -v237
    buffer_load_dwordx4 v5, s[36:39], s71 offen offset:1024 nt lds
    v_exp_f32 v176, v176
    v_exp_f32 v177, v177
    v_exp_f32 v178, v178
    v_exp_f32 v179, v179
    v_exp_f32 v180, v180
    v_exp_f32 v181, v181
    v_exp_f32 v182, v182
    v_exp_f32 v183, v183
    ds_read_b64_tr_b16 a[66:67], v6 offset:16384
    v_add_f32 v245, v245, v176
    v_add_f32 v245, v245, v177
    v_add_f32 v245, v245, v178
    v_add_f32 v245, v245, v179
    v_add_f32 v245, v245, v180
    v_add_f32 v245, v245, v181
    v_add_f32 v245, v245, v182
    v_add_f32 v245, v245, v183
    v_cvt_pk_bf16_f32 v176, v176, v177
    v_cvt_pk_bf16_f32 v177, v178, v179
    v_cvt_pk_bf16_f32 v178, v180, v181
    v_cvt_pk_bf16_f32 v179, v182, v183
    ds_write_b128 v1, v[176:179] offset:12288
    ds_read_b64_tr_b16 a[70:71], v7 offset:16384
    v_fma_f32 v184, v184, s68, -v237
    v_fma_f32 v185, v185, s68, -v237
    v_fma_f32 v186, v186, s68, -v237
    v_fma_f32 v187, v187, s68, -v237
    v_fma_f32 v188, v188, s68, -v237
    v_fma_f32 v189, v189, s68, -v237
    v_fma_f32 v190, v190, s68, -v237
    v_fma_f32 v191, v191, s68, -v237
    ds_read_b64_tr_b16 a[74:75], v6 offset:16896
    v_exp_f32 v184, v184
    v_exp_f32 v185, v185
    v_exp_f32 v186, v186
    v_exp_f32 v187, v187
    v_exp_f32 v188, v188
    v_exp_f32 v189, v189
    v_exp_f32 v190, v190
    v_exp_f32 v191, v191
    ds_read_b64_tr_b16 a[78:79], v7 offset:16896
    v_add_f32 v245, v245, v184
    v_add_f32 v245, v245, v185
    v_add_f32 v245, v245, v186
    v_add_f32 v245, v245, v187
    v_add_f32 v245, v245, v188
    v_add_f32 v245, v245, v189
    v_add_f32 v245, v245, v190
    v_add_f32 v245, v245, v191
    v_cvt_pk_bf16_f32 v184, v184, v185
    v_cvt_pk_bf16_f32 v185, v186, v187
    v_cvt_pk_bf16_f32 v186, v188, v189
    v_cvt_pk_bf16_f32 v187, v190, v191
    ds_write_b128 v1, v[184:187] offset:19456
    v_fma_f32 v192, v192, s68, -v237
    v_fma_f32 v193, v193, s68, -v237
    v_fma_f32 v194, v194, s68, -v237
    v_fma_f32 v195, v195, s68, -v237
    v_fma_f32 v196, v196, s68, -v237
    v_fma_f32 v197, v197, s68, -v237
    v_fma_f32 v198, v198, s68, -v237
    v_fma_f32 v199, v199, s68, -v237
    v_exp_f32 v192, v192
    v_exp_f32 v193, v193
    v_exp_f32 v194, v194
    v_exp_f32 v195, v195
    v_exp_f32 v196, v196
    v_exp_f32 v197, v197
    v_exp_f32 v198, v198
    v_exp_f32 v199, v199
    s_waitcnt lgkmcnt(1)
    s_mov_b32 m0, s54
    s_addk_i32 s71, 8192
    v_add_f32 v245, v245, v192
    v_add_f32 v245, v245, v193
    v_add_f32 v245, v245, v194
    v_add_f32 v245, v245, v195
    v_add_f32 v245, v245, v196
    v_add_f32 v245, v245, v197
    v_add_f32 v245, v245, v198
    v_add_f32 v245, v245, v199
    v_cvt_pk_bf16_f32 v192, v192, v193
    v_cvt_pk_bf16_f32 v193, v194, v195
    v_cvt_pk_bf16_f32 v194, v196, v197
    v_cvt_pk_bf16_f32 v195, v198, v199
    ds_write_b128 v1, v[192:195] offset:26624
    buffer_load_dwordx4 v5, s[32:35], s71 offen nt lds
    s_waitcnt vmcnt(7)
    v_fma_f32 v200, v200, s68, -v238
    v_fma_f32 v201, v201, s68, -v238
    v_fma_f32 v202, v202, s68, -v238
    v_fma_f32 v203, v203, s68, -v238
    v_fma_f32 v204, v204, s68, -v238
    v_fma_f32 v205, v205, s68, -v238
    v_fma_f32 v206, v206, s68, -v238
    v_fma_f32 v207, v207, s68, -v238
    buffer_load_dwordx4 v5, s[36:39], s71 offen offset:1024 nt lds
    v_exp_f32 v200, v200
    v_exp_f32 v201, v201
    v_exp_f32 v202, v202
    v_exp_f32 v203, v203
    v_exp_f32 v204, v204
    v_exp_f32 v205, v205
    v_exp_f32 v206, v206
    v_exp_f32 v207, v207
    ds_read_b64_tr_b16 a[80:81], v6 offset:40960
    v_add_f32 v246, v200, v201
    v_add_f32 v246, v246, v202
    v_add_f32 v246, v246, v203
    v_add_f32 v246, v246, v204
    v_add_f32 v246, v246, v205
    v_add_f32 v246, v246, v206
    v_add_f32 v246, v246, v207
    v_cvt_pk_bf16_f32 v200, v200, v201
    v_cvt_pk_bf16_f32 v201, v202, v203
    v_cvt_pk_bf16_f32 v202, v204, v205
    v_cvt_pk_bf16_f32 v203, v206, v207
    ds_write_b128 v1, v[200:203] offset:6144
    ds_read_b64_tr_b16 a[84:85], v7 offset:40960
    v_fma_f32 v208, v208, s68, -v238
    v_fma_f32 v209, v209, s68, -v238
    v_fma_f32 v210, v210, s68, -v238
    v_fma_f32 v211, v211, s68, -v238
    v_fma_f32 v212, v212, s68, -v238
    v_fma_f32 v213, v213, s68, -v238
    v_fma_f32 v214, v214, s68, -v238
    v_fma_f32 v215, v215, s68, -v238
    ds_read_b64_tr_b16 a[88:89], v6 offset:41472
    v_exp_f32 v208, v208
    v_exp_f32 v209, v209
    v_exp_f32 v210, v210
    v_exp_f32 v211, v211
    v_exp_f32 v212, v212
    v_exp_f32 v213, v213
    v_exp_f32 v214, v214
    v_exp_f32 v215, v215
    ds_read_b64_tr_b16 a[92:93], v7 offset:41472
    v_add_f32 v246, v246, v208
    v_add_f32 v246, v246, v209
    v_add_f32 v246, v246, v210
    v_add_f32 v246, v246, v211
    v_add_f32 v246, v246, v212
    v_add_f32 v246, v246, v213
    v_add_f32 v246, v246, v214
    v_add_f32 v246, v246, v215
    v_cvt_pk_bf16_f32 v208, v208, v209
    v_cvt_pk_bf16_f32 v209, v210, v211
    v_cvt_pk_bf16_f32 v210, v212, v213
    v_cvt_pk_bf16_f32 v211, v214, v215
    ds_write_b128 v1, v[208:211] offset:13312
    v_fma_f32 v216, v216, s68, -v238
    v_fma_f32 v217, v217, s68, -v238
    v_fma_f32 v218, v218, s68, -v238
    v_fma_f32 v219, v219, s68, -v238
    v_fma_f32 v220, v220, s68, -v238
    v_fma_f32 v221, v221, s68, -v238
    v_fma_f32 v222, v222, s68, -v238
    v_fma_f32 v223, v223, s68, -v238
    v_exp_f32 v216, v216
    v_exp_f32 v217, v217
    v_exp_f32 v218, v218
    v_exp_f32 v219, v219
    v_exp_f32 v220, v220
    v_exp_f32 v221, v221
    v_exp_f32 v222, v222
    v_exp_f32 v223, v223
    s_waitcnt lgkmcnt(1)
    s_mov_b32 m0, s57
    s_addk_i32 s71, 8192
    v_add_f32 v246, v246, v216
    v_add_f32 v246, v246, v217
    v_add_f32 v246, v246, v218
    v_add_f32 v246, v246, v219
    v_add_f32 v246, v246, v220
    v_add_f32 v246, v246, v221
    v_add_f32 v246, v246, v222
    v_add_f32 v246, v246, v223
    v_cvt_pk_bf16_f32 v216, v216, v217
    v_cvt_pk_bf16_f32 v217, v218, v219
    v_cvt_pk_bf16_f32 v218, v220, v221
    v_cvt_pk_bf16_f32 v219, v222, v223
    ds_write_b128 v1, v[216:219] offset:20480
    buffer_load_dwordx4 v5, s[32:35], s71 offen nt lds
    s_waitcnt vmcnt(7)
    v_fma_f32 v224, v224, s68, -v238
    v_fma_f32 v225, v225, s68, -v238
    v_fma_f32 v226, v226, s68, -v238
    v_fma_f32 v227, v227, s68, -v238
    v_fma_f32 v228, v228, s68, -v238
    v_fma_f32 v229, v229, s68, -v238
    v_fma_f32 v230, v230, s68, -v238
    v_fma_f32 v231, v231, s68, -v238
    buffer_load_dwordx4 v5, s[36:39], s71 offen offset:1024 nt lds
    v_exp_f32 v224, v224
    v_exp_f32 v225, v225
    v_exp_f32 v226, v226
    v_exp_f32 v227, v227
    v_exp_f32 v228, v228
    v_exp_f32 v229, v229
    v_exp_f32 v230, v230
    v_exp_f32 v231, v231
    ds_read_b64_tr_b16 a[82:83], v6 offset:49152
    v_add_f32 v246, v246, v224
    v_add_f32 v246, v246, v225
    v_add_f32 v246, v246, v226
    v_add_f32 v246, v246, v227
    v_add_f32 v246, v246, v228
    v_add_f32 v246, v246, v229
    v_add_f32 v246, v246, v230
    v_add_f32 v246, v246, v231
    v_cvt_pk_bf16_f32 v224, v224, v225
    v_cvt_pk_bf16_f32 v225, v226, v227
    v_cvt_pk_bf16_f32 v226, v228, v229
    v_cvt_pk_bf16_f32 v227, v230, v231
    ds_write_b128 v1, v[224:227] offset:27648
    ds_read_b64_tr_b16 a[86:87], v7 offset:49152
    v_mov_b32 v248, v240
    v_mov_b32 v249, v241
    v_mov_b32 v250, v242
    v_mov_b32 v251, v243
    v_mov_b32 v252, v244
    v_mov_b32 v253, v245
    v_mov_b32 v254, v246
    v_permlane32_swap_b32 v240, v248
    v_permlane32_swap_b32 v241, v249
    v_permlane32_swap_b32 v242, v250
    v_permlane32_swap_b32 v243, v251
    v_permlane32_swap_b32 v244, v252
    v_permlane32_swap_b32 v245, v253
    v_permlane32_swap_b32 v246, v254
    v_add_f32 v240, v240, v248
    v_add_f32 v241, v241, v249
    v_add_f32 v242, v242, v250
    v_add_f32 v243, v243, v251
    v_add_f32 v244, v244, v252
    v_add_f32 v245, v245, v253
    v_add_f32 v246, v246, v254
    ds_read_b64_tr_b16 a[90:91], v6 offset:49664
    v_mov_b32 v248, v240
    v_mov_b32 v249, v241
    v_mov_b32 v250, v242
    v_mov_b32 v251, v243
    v_mov_b32 v252, v244
    v_mov_b32 v253, v245
    v_mov_b32 v254, v246
    v_permlane16_swap_b32 v240, v248
    v_permlane16_swap_b32 v241, v249
    v_permlane16_swap_b32 v242, v250
    v_permlane16_swap_b32 v243, v251
    v_permlane16_swap_b32 v244, v252
    v_permlane16_swap_b32 v245, v253
    v_permlane16_swap_b32 v246, v254
    v_add_f32 v240, v240, v248
    v_add_f32 v241, v241, v249
    v_add_f32 v242, v242, v250
    v_add_f32 v243, v243, v251
    v_add_f32 v244, v244, v252
    v_add_f32 v245, v245, v253
    v_add_f32 v246, v246, v254
    v_add_u32 v2, 2048, v2
    s_lshl_b32 s3, s66, 2
    v_add_u32 v1, s3, v2
    s_mov_b64 exec, 0xffff
    ds_write_b32 v1, v240 offset:0
    ds_write_b32 v1, v241 offset:256
    ds_write_b32 v1, v242 offset:512
    ds_write_b32 v1, v243 offset:768
    ds_write_b32 v1, v244 offset:1024
    ds_write_b32 v1, v245 offset:1280
    ds_write_b32 v1, v246 offset:1536
    s_mov_b64 exec, -1
    v_add_u32 v1, 0x10000, v0
    v_lshrrev_b32 v10, 4, v0
    v_lshrrev_b32 v14, 2, v10
    v_and_b32 v14, 7, v14
    v_and_b32 v15, 3, v10
    v_lshrrev_b32 v16, 5, v10
    v_bfe_u32 v13, v10, 4, 1
    v_xor_b32 v17, v15, v13
    v_lshlrev_b32 v17, 4, v17
    v_lshl_add_u32 v18, v16, 6, v17
    s_movk_i32 s3, 896
    v_mad_u32_u24 v18, v14, s3, v18
    s_lshl_b32 s3, s66, 8
    v_add_u32 v148, s3, v18
    v_lshlrev_b32 v18, 6, v14
    v_lshl_add_u32 v18, v16, 10, v18
    v_add_u32 v18, v18, v17
    v_and_b32 v19, 1, v15
    v_lshl_add_u32 v18, v19, 3, v18
    v_add_u32 v149, s52, v18
    v_xor_b32 v150, 8, v149
    v_subrev_u32 v151, 100352, v6
    v_subrev_u32 v152, 100352, v7
    v_subrev_u32 v153, 100352, v149
    v_subrev_u32 v154, 100352, v150
    s_waitcnt lgkmcnt(0)
    s_barrier
    ds_read_b128 v[120:123], v0 offset:0
    ds_read_b128 v[124:127], v0 offset:1024
    ds_read_b128 v[128:131], v0 offset:2048
    ds_read_b128 v[132:135], v0 offset:3072
    ds_read_b128 v[136:139], v0 offset:4096
    ds_read_b128 v[140:143], v0 offset:5120
    ds_read_b128 v[144:147], v0 offset:6144
    s_waitcnt lgkmcnt(6)
    v_mfma_f32_16x16x32_bf16 v[8:11], a[16:19], v[120:123], 0
    ds_read_b64_tr_b16 a[94:95], v7 offset:49664
    v_mfma_f32_16x16x32_bf16 v[12:15], a[20:23], v[120:123], 0
    v_mfma_f32_16x16x32_bf16 v[16:19], a[24:27], v[120:123], 0
    v_mfma_f32_16x16x32_bf16 v[20:23], a[28:31], v[120:123], 0
    ds_read_b128 v[120:123], v0 offset:7168
    s_waitcnt lgkmcnt(7)
    v_mfma_f32_16x16x32_bf16 v[24:27], a[16:19], v[124:127], 0
    v_mfma_f32_16x16x32_bf16 v[28:31], a[20:23], v[124:127], 0
    v_mfma_f32_16x16x32_bf16 v[32:35], a[24:27], v[124:127], 0
    v_mfma_f32_16x16x32_bf16 v[36:39], a[28:31], v[124:127], 0
    ds_read_b128 v[124:127], v0 offset:8192
    s_waitcnt lgkmcnt(2)
    s_mov_b32 m0, s58
    v_mfma_f32_16x16x32_bf16 v[40:43], a[16:19], v[128:131], 0
    s_addk_i32 s71, 8192
    buffer_load_dwordx4 v5, s[32:35], s71 offen nt lds
    v_mfma_f32_16x16x32_bf16 v[44:47], a[20:23], v[128:131], 0
    buffer_load_dwordx4 v5, s[36:39], s71 offen offset:1024 nt lds
    v_mfma_f32_16x16x32_bf16 v[48:51], a[24:27], v[128:131], 0
    v_mfma_f32_16x16x32_bf16 v[52:55], a[28:31], v[128:131], 0
    ds_read_b128 v[128:131], v0 offset:9216
    v_mfma_f32_16x16x32_bf16 v[56:59], a[16:19], v[132:135], 0
    s_waitcnt vmcnt(8)
    ds_read_b64_tr_b16 a[96:97], v6 offset:24576
    v_mfma_f32_16x16x32_bf16 v[60:63], a[20:23], v[132:135], 0
    ds_read_b64_tr_b16 a[100:101], v7 offset:24576
    v_mfma_f32_16x16x32_bf16 v[64:67], a[24:27], v[132:135], 0
    ds_read_b64_tr_b16 a[104:105], v6 offset:25088
    v_mfma_f32_16x16x32_bf16 v[68:71], a[28:31], v[132:135], 0
    ds_read_b128 v[132:135], v0 offset:10240
    v_mfma_f32_16x16x32_bf16 v[72:75], a[16:19], v[136:139], 0
    ds_read_b64_tr_b16 a[108:109], v7 offset:25088
    v_mfma_f32_16x16x32_bf16 v[76:79], a[20:23], v[136:139], 0
    v_mfma_f32_16x16x32_bf16 v[80:83], a[24:27], v[136:139], 0
    v_mfma_f32_16x16x32_bf16 v[84:87], a[28:31], v[136:139], 0
    ds_read_b128 v[136:139], v0 offset:11264
    v_mfma_f32_16x16x32_bf16 v[88:91], a[16:19], v[140:143], 0
    v_mfma_f32_16x16x32_bf16 v[92:95], a[20:23], v[140:143], 0
    v_mfma_f32_16x16x32_bf16 v[96:99], a[24:27], v[140:143], 0
    v_mfma_f32_16x16x32_bf16 v[100:103], a[28:31], v[140:143], 0
    ds_read_b128 v[140:143], v0 offset:12288
    s_waitcnt lgkmcnt(2)
    s_mov_b32 m0, s55
    v_mfma_f32_16x16x32_bf16 v[104:107], a[16:19], v[144:147], 0
    s_addk_i32 s71, 8192
    buffer_load_dwordx4 v5, s[32:35], s71 offen nt lds
    v_mfma_f32_16x16x32_bf16 v[108:111], a[20:23], v[144:147], 0
    buffer_load_dwordx4 v5, s[36:39], s71 offen offset:1024 nt lds
    v_mfma_f32_16x16x32_bf16 v[112:115], a[24:27], v[144:147], 0
    v_mfma_f32_16x16x32_bf16 v[116:119], a[28:31], v[144:147], 0
    ds_read_b128 v[144:147], v0 offset:13312
    v_mfma_f32_16x16x32_bf16 v[8:11], a[0:3], v[120:123], v[8:11]
    v_mfma_f32_16x16x32_bf16 v[12:15], a[4:7], v[120:123], v[12:15]
    v_mfma_f32_16x16x32_bf16 v[16:19], a[8:11], v[120:123], v[16:19]
    v_mfma_f32_16x16x32_bf16 v[20:23], a[12:15], v[120:123], v[20:23]
    ds_read_b128 v[120:123], v0 offset:14336
    v_mfma_f32_16x16x32_bf16 v[24:27], a[0:3], v[124:127], v[24:27]
    v_mfma_f32_16x16x32_bf16 v[28:31], a[4:7], v[124:127], v[28:31]
    v_mfma_f32_16x16x32_bf16 v[32:35], a[8:11], v[124:127], v[32:35]
    v_mfma_f32_16x16x32_bf16 v[36:39], a[12:15], v[124:127], v[36:39]
    ds_read_b128 v[124:127], v0 offset:15360
    v_mfma_f32_16x16x32_bf16 v[40:43], a[0:3], v[128:131], v[40:43]
    v_mfma_f32_16x16x32_bf16 v[44:47], a[4:7], v[128:131], v[44:47]
    v_mfma_f32_16x16x32_bf16 v[48:51], a[8:11], v[128:131], v[48:51]
    v_mfma_f32_16x16x32_bf16 v[52:55], a[12:15], v[128:131], v[52:55]
    ds_read_b128 v[128:131], v0 offset:16384
    v_mfma_f32_16x16x32_bf16 v[56:59], a[0:3], v[132:135], v[56:59]
    v_mfma_f32_16x16x32_bf16 v[60:63], a[4:7], v[132:135], v[60:63]
    s_waitcnt vmcnt(8)
    ds_read_b64_tr_b16 a[98:99], v6 offset:32768
    v_mfma_f32_16x16x32_bf16 v[64:67], a[8:11], v[132:135], v[64:67]
    ds_read_b64_tr_b16 a[102:103], v7 offset:32768
    v_mfma_f32_16x16x32_bf16 v[68:71], a[12:15], v[132:135], v[68:71]
    ds_read_b128 v[132:135], v0 offset:17408
    s_waitcnt lgkmcnt(5)
    v_mfma_f32_16x16x32_bf16 v[72:75], a[0:3], v[136:139], v[72:75]
    ds_read_b64_tr_b16 a[106:107], v6 offset:33280
    v_mfma_f32_16x16x32_bf16 v[76:79], a[4:7], v[136:139], v[76:79]
    ds_read_b64_tr_b16 a[110:111], v7 offset:33280
    v_mfma_f32_16x16x32_bf16 v[80:83], a[8:11], v[136:139], v[80:83]
    v_mfma_f32_16x16x32_bf16 v[84:87], a[12:15], v[136:139], v[84:87]
    ds_read_b128 v[136:139], v0 offset:18432
    v_mfma_f32_16x16x32_bf16 v[88:91], a[0:3], v[140:143], v[88:91]
    v_mfma_f32_16x16x32_bf16 v[92:95], a[4:7], v[140:143], v[92:95]
    v_mfma_f32_16x16x32_bf16 v[96:99], a[8:11], v[140:143], v[96:99]
    v_mfma_f32_16x16x32_bf16 v[100:103], a[12:15], v[140:143], v[100:103]
    ds_read_b128 v[140:143], v0 offset:19456
    v_mfma_f32_16x16x32_bf16 v[104:107], a[0:3], v[144:147], v[104:107]
    s_waitcnt lgkmcnt(2)
    s_mov_b32 m0, s56
    s_addk_i32 s71, 8192
    v_mfma_f32_16x16x32_bf16 v[108:111], a[4:7], v[144:147], v[108:111]
    buffer_load_dwordx4 v5, s[32:35], s71 offen nt lds
    v_mfma_f32_16x16x32_bf16 v[112:115], a[8:11], v[144:147], v[112:115]
    buffer_load_dwordx4 v5, s[36:39], s71 offen offset:1024 nt lds
    v_mfma_f32_16x16x32_bf16 v[116:119], a[12:15], v[144:147], v[116:119]
    ds_read_b128 v[144:147], v0 offset:20480
    v_mfma_f32_16x16x32_bf16 v[8:11], a[32:35], v[120:123], v[8:11]
    v_mfma_f32_16x16x32_bf16 v[12:15], a[36:39], v[120:123], v[12:15]
    v_mfma_f32_16x16x32_bf16 v[16:19], a[40:43], v[120:123], v[16:19]
    v_mfma_f32_16x16x32_bf16 v[20:23], a[44:47], v[120:123], v[20:23]
    ds_read_b128 v[120:123], v0 offset:21504
    v_mfma_f32_16x16x32_bf16 v[24:27], a[32:35], v[124:127], v[24:27]
    v_mfma_f32_16x16x32_bf16 v[28:31], a[36:39], v[124:127], v[28:31]
    v_mfma_f32_16x16x32_bf16 v[32:35], a[40:43], v[124:127], v[32:35]
    v_mfma_f32_16x16x32_bf16 v[36:39], a[44:47], v[124:127], v[36:39]
    ds_read_b128 v[124:127], v0 offset:22528
    v_mfma_f32_16x16x32_bf16 v[40:43], a[32:35], v[128:131], v[40:43]
    v_mfma_f32_16x16x32_bf16 v[44:47], a[36:39], v[128:131], v[44:47]
    v_mfma_f32_16x16x32_bf16 v[48:51], a[40:43], v[128:131], v[48:51]
    v_mfma_f32_16x16x32_bf16 v[52:55], a[44:47], v[128:131], v[52:55]
    ds_read_b128 v[128:131], v0 offset:23552
    v_mfma_f32_16x16x32_bf16 v[56:59], a[32:35], v[132:135], v[56:59]
    v_mfma_f32_16x16x32_bf16 v[60:63], a[36:39], v[132:135], v[60:63]
    v_mfma_f32_16x16x32_bf16 v[64:67], a[40:43], v[132:135], v[64:67]
    s_waitcnt vmcnt(8)
    ds_read_b64_tr_b16 a[0:1], v6 offset:16384
    v_mfma_f32_16x16x32_bf16 v[68:71], a[44:47], v[132:135], v[68:71]
    ds_read_b128 v[132:135], v0 offset:24576
    s_waitcnt lgkmcnt(4)
    v_mfma_f32_16x16x32_bf16 v[72:75], a[32:35], v[136:139], v[72:75]
    ds_read_b64_tr_b16 a[4:5], v7 offset:16384
    v_mfma_f32_16x16x32_bf16 v[76:79], a[36:39], v[136:139], v[76:79]
    ds_read_b64_tr_b16 a[8:9], v6 offset:16896
    v_mfma_f32_16x16x32_bf16 v[80:83], a[40:43], v[136:139], v[80:83]
    ds_read_b64_tr_b16 a[12:13], v7 offset:16896
    v_mfma_f32_16x16x32_bf16 v[84:87], a[44:47], v[136:139], v[84:87]
    ds_read_b128 v[136:139], v0 offset:25600
    v_mfma_f32_16x16x32_bf16 v[88:91], a[32:35], v[140:143], v[88:91]
    v_mfma_f32_16x16x32_bf16 v[92:95], a[36:39], v[140:143], v[92:95]
    v_mfma_f32_16x16x32_bf16 v[96:99], a[40:43], v[140:143], v[96:99]
    v_mfma_f32_16x16x32_bf16 v[100:103], a[44:47], v[140:143], v[100:103]
    ds_read_b128 v[140:143], v0 offset:26624
    v_mfma_f32_16x16x32_bf16 v[104:107], a[32:35], v[144:147], v[104:107]
    v_mfma_f32_16x16x32_bf16 v[108:111], a[36:39], v[144:147], v[108:111]
    s_waitcnt lgkmcnt(2)
    s_mov_b32 m0, s54
    s_addk_i32 s71, 8192
    v_mfma_f32_16x16x32_bf16 v[112:115], a[40:43], v[144:147], v[112:115]
    buffer_load_dwordx4 v5, s[32:35], s71 offen nt lds
    v_mfma_f32_16x16x32_bf16 v[116:119], a[44:47], v[144:147], v[116:119]
    ds_read_b128 v[144:147], v0 offset:27648
    v_mfma_f32_16x16x32_bf16 v[8:11], a[48:51], v[120:123], v[8:11]
    s_barrier
    buffer_load_dwordx4 v5, s[36:39], s71 offen offset:1024 nt lds
    s_mov_b32 m0, s59
    v_mfma_f32_16x16x32_bf16 v[12:15], a[52:55], v[120:123], v[12:15]
    s_addk_i32 s71, 8192
    buffer_load_dwordx4 v5, s[32:35], s71 offen nt lds
    v_mfma_f32_16x16x32_bf16 v[16:19], a[56:59], v[120:123], v[16:19]
    buffer_load_dwordx4 v5, s[36:39], s71 offen offset:1024 nt lds
    s_mov_b32 m0, s60
    s_addk_i32 s71, 8192
    v_mfma_f32_16x16x32_bf16 v[20:23], a[60:63], v[120:123], v[20:23]
    ds_read_b128 v[120:123], v0 offset:28672
    v_mfma_f32_16x16x32_bf16 v[24:27], a[48:51], v[124:127], v[24:27]
    buffer_load_dwordx4 v5, s[32:35], s71 offen nt lds
    v_mfma_f32_16x16x32_bf16 v[28:31], a[52:55], v[124:127], v[28:31]
    buffer_load_dwordx4 v5, s[36:39], s71 offen offset:1024 nt lds
    v_mfma_f32_16x16x32_bf16 v[32:35], a[56:59], v[124:127], v[32:35]
    v_mfma_f32_16x16x32_bf16 v[36:39], a[60:63], v[124:127], v[36:39]
    ds_read_b128 v[124:127], v0 offset:29696
    v_mfma_f32_16x16x32_bf16 v[40:43], a[48:51], v[128:131], v[40:43]
    v_mfma_f32_16x16x32_bf16 v[44:47], a[52:55], v[128:131], v[44:47]
    v_mfma_f32_16x16x32_bf16 v[48:51], a[56:59], v[128:131], v[48:51]
    v_mfma_f32_16x16x32_bf16 v[52:55], a[60:63], v[128:131], v[52:55]
    ds_read_b128 v[128:131], v0 offset:30720
    v_mfma_f32_16x16x32_bf16 v[56:59], a[48:51], v[132:135], v[56:59]
    v_mfma_f32_16x16x32_bf16 v[60:63], a[52:55], v[132:135], v[60:63]
    v_mfma_f32_16x16x32_bf16 v[64:67], a[56:59], v[132:135], v[64:67]
    s_waitcnt vmcnt(12)
    ds_read_b64_tr_b16 a[2:3], v6 offset:40960
    v_mfma_f32_16x16x32_bf16 v[68:71], a[60:63], v[132:135], v[68:71]
    ds_read_b128 v[132:135], v0 offset:31744
    s_waitcnt lgkmcnt(4)
    v_mfma_f32_16x16x32_bf16 v[72:75], a[48:51], v[136:139], v[72:75]
    ds_read_b64_tr_b16 a[6:7], v7 offset:40960
    v_mfma_f32_16x16x32_bf16 v[76:79], a[52:55], v[136:139], v[76:79]
    ds_read_b64_tr_b16 a[10:11], v6 offset:41472
    v_mfma_f32_16x16x32_bf16 v[80:83], a[56:59], v[136:139], v[80:83]
    ds_read_b64_tr_b16 a[14:15], v7 offset:41472
    v_mfma_f32_16x16x32_bf16 v[84:87], a[60:63], v[136:139], v[84:87]
    ds_read_b128 v[136:139], v0 offset:32768
    v_mfma_f32_16x16x32_bf16 v[88:91], a[48:51], v[140:143], v[88:91]
    v_mfma_f32_16x16x32_bf16 v[92:95], a[52:55], v[140:143], v[92:95]
    v_mfma_f32_16x16x32_bf16 v[96:99], a[56:59], v[140:143], v[96:99]
    v_mfma_f32_16x16x32_bf16 v[100:103], a[60:63], v[140:143], v[100:103]
    ds_read_b128 v[140:143], v0 offset:33792
    v_mfma_f32_16x16x32_bf16 v[104:107], a[48:51], v[144:147], v[104:107]
    v_mfma_f32_16x16x32_bf16 v[108:111], a[52:55], v[144:147], v[108:111]
    s_waitcnt lgkmcnt(2)
    s_mov_b32 m0, s57
    s_addk_i32 s71, 8192
    v_mfma_f32_16x16x32_bf16 v[112:115], a[56:59], v[144:147], v[112:115]
    buffer_load_dwordx4 v5, s[32:35], s71 offen nt lds
    v_mfma_f32_16x16x32_bf16 v[116:119], a[60:63], v[144:147], v[116:119]
    ds_read_b128 v[144:147], v0 offset:34816
    v_mfma_f32_16x16x32_bf16 v[8:11], a[64:67], v[120:123], v[8:11]
    buffer_load_dwordx4 v5, s[36:39], s71 offen offset:1024 nt lds
    v_mfma_f32_16x16x32_bf16 v[12:15], a[68:71], v[120:123], v[12:15]
    v_mfma_f32_16x16x32_bf16 v[16:19], a[72:75], v[120:123], v[16:19]
    v_mfma_f32_16x16x32_bf16 v[20:23], a[76:79], v[120:123], v[20:23]
    ds_read_b128 v[120:123], v0 offset:35840
    v_mfma_f32_16x16x32_bf16 v[24:27], a[64:67], v[124:127], v[24:27]
    v_mfma_f32_16x16x32_bf16 v[28:31], a[68:71], v[124:127], v[28:31]
    v_mfma_f32_16x16x32_bf16 v[32:35], a[72:75], v[124:127], v[32:35]
    v_mfma_f32_16x16x32_bf16 v[36:39], a[76:79], v[124:127], v[36:39]
    ds_read_b128 v[124:127], v0 offset:36864
    v_mfma_f32_16x16x32_bf16 v[40:43], a[64:67], v[128:131], v[40:43]
    v_mfma_f32_16x16x32_bf16 v[44:47], a[68:71], v[128:131], v[44:47]
    v_mfma_f32_16x16x32_bf16 v[48:51], a[72:75], v[128:131], v[48:51]
    v_mfma_f32_16x16x32_bf16 v[52:55], a[76:79], v[128:131], v[52:55]
    ds_read_b128 v[128:131], v0 offset:37888
    v_mfma_f32_16x16x32_bf16 v[56:59], a[64:67], v[132:135], v[56:59]
    v_mfma_f32_16x16x32_bf16 v[60:63], a[68:71], v[132:135], v[60:63]
    v_mfma_f32_16x16x32_bf16 v[64:67], a[72:75], v[132:135], v[64:67]
    v_mfma_f32_16x16x32_bf16 v[68:71], a[76:79], v[132:135], v[68:71]
    ds_read_b128 v[132:135], v0 offset:38912
    s_waitcnt lgkmcnt(3)
    v_mfma_f32_16x16x32_bf16 v[72:75], a[64:67], v[136:139], v[72:75]
    v_mfma_f32_16x16x32_bf16 v[76:79], a[68:71], v[136:139], v[76:79]
    v_mfma_f32_16x16x32_bf16 v[80:83], a[72:75], v[136:139], v[80:83]
    v_mfma_f32_16x16x32_bf16 v[84:87], a[76:79], v[136:139], v[84:87]
    ds_read_b128 v[136:139], v0 offset:39936
    v_mfma_f32_16x16x32_bf16 v[88:91], a[64:67], v[140:143], v[88:91]
    v_mfma_f32_16x16x32_bf16 v[92:95], a[68:71], v[140:143], v[92:95]
    v_mfma_f32_16x16x32_bf16 v[96:99], a[72:75], v[140:143], v[96:99]
    v_mfma_f32_16x16x32_bf16 v[100:103], a[76:79], v[140:143], v[100:103]
    ds_read_b128 v[140:143], v0 offset:40960
    s_waitcnt vmcnt(12)
    v_mfma_f32_16x16x32_bf16 v[104:107], a[64:67], v[144:147], v[104:107]
    ds_read_b64_tr_b16 a[16:17], v6 offset:49152
    v_mfma_f32_16x16x32_bf16 v[108:111], a[68:71], v[144:147], v[108:111]
    ds_read_b64_tr_b16 a[20:21], v7 offset:49152
    v_mfma_f32_16x16x32_bf16 v[112:115], a[72:75], v[144:147], v[112:115]
    ds_read_b64_tr_b16 a[24:25], v6 offset:49664
    v_mfma_f32_16x16x32_bf16 v[116:119], a[76:79], v[144:147], v[116:119]
    ds_read_b128 v[144:147], v0 offset:41984
    v_mfma_f32_16x16x32_bf16 v[8:11], a[80:83], v[120:123], v[8:11]
    s_barrier
    ds_read_b64_tr_b16 a[28:29], v7 offset:49664
    s_mov_b32 m0, s61
    v_mfma_f32_16x16x32_bf16 v[12:15], a[84:87], v[120:123], v[12:15]
    s_addk_i32 s71, 8192
    buffer_load_dwordx4 v5, s[32:35], s71 offen nt lds
    v_mfma_f32_16x16x32_bf16 v[16:19], a[88:91], v[120:123], v[16:19]
    buffer_load_dwordx4 v5, s[36:39], s71 offen offset:1024 nt lds
    s_mov_b32 m0, s62
    s_addk_i32 s71, 8192
    v_mfma_f32_16x16x32_bf16 v[20:23], a[92:95], v[120:123], v[20:23]
    ds_read_b128 v[120:123], v0 offset:43008
    s_waitcnt lgkmcnt(7)
    v_mfma_f32_16x16x32_bf16 v[24:27], a[80:83], v[124:127], v[24:27]
    buffer_load_dwordx4 v5, s[32:35], s71 offen nt lds
    v_mfma_f32_16x16x32_bf16 v[28:31], a[84:87], v[124:127], v[28:31]
    buffer_load_dwordx4 v5, s[36:39], s71 offen offset:1024 nt lds
    v_mfma_f32_16x16x32_bf16 v[32:35], a[88:91], v[124:127], v[32:35]
    v_mfma_f32_16x16x32_bf16 v[36:39], a[92:95], v[124:127], v[36:39]
    ds_read_b128 v[124:127], v0 offset:44032
    s_waitcnt lgkmcnt(2)
    s_mov_b32 m0, s58
    v_mfma_f32_16x16x32_bf16 v[40:43], a[80:83], v[128:131], v[40:43]
    s_addk_i32 s71, 8192
    buffer_load_dwordx4 v5, s[32:35], s71 offen nt lds
    v_mfma_f32_16x16x32_bf16 v[44:47], a[84:87], v[128:131], v[44:47]
    buffer_load_dwordx4 v5, s[36:39], s71 offen offset:1024 nt lds
    v_mfma_f32_16x16x32_bf16 v[48:51], a[88:91], v[128:131], v[48:51]
    v_mfma_f32_16x16x32_bf16 v[52:55], a[92:95], v[128:131], v[52:55]
    ds_read_b128 v[128:131], v0 offset:45056
    v_mfma_f32_16x16x32_bf16 v[56:59], a[80:83], v[132:135], v[56:59]
    v_mfma_f32_16x16x32_bf16 v[60:63], a[84:87], v[132:135], v[60:63]
    v_mfma_f32_16x16x32_bf16 v[64:67], a[88:91], v[132:135], v[64:67]
    v_mfma_f32_16x16x32_bf16 v[68:71], a[92:95], v[132:135], v[68:71]
    ds_read_b128 v[132:135], v0 offset:46080
    v_mfma_f32_16x16x32_bf16 v[72:75], a[80:83], v[136:139], v[72:75]
    v_mfma_f32_16x16x32_bf16 v[76:79], a[84:87], v[136:139], v[76:79]
    v_mfma_f32_16x16x32_bf16 v[80:83], a[88:91], v[136:139], v[80:83]
    v_mfma_f32_16x16x32_bf16 v[84:87], a[92:95], v[136:139], v[84:87]
    ds_read_b128 v[136:139], v0 offset:47104
    s_waitcnt vmcnt(16)
    v_mfma_f32_16x16x32_bf16 v[88:91], a[80:83], v[140:143], v[88:91]
    ds_read_b64_tr_b16 a[18:19], v6 offset:24576
    v_mfma_f32_16x16x32_bf16 v[92:95], a[84:87], v[140:143], v[92:95]
    ds_read_b64_tr_b16 a[22:23], v7 offset:24576
    v_mfma_f32_16x16x32_bf16 v[96:99], a[88:91], v[140:143], v[96:99]
    ds_read_b64_tr_b16 a[26:27], v6 offset:25088
    v_mfma_f32_16x16x32_bf16 v[100:103], a[92:95], v[140:143], v[100:103]
    ds_read_b128 v[140:143], v0 offset:48128
    v_mfma_f32_16x16x32_bf16 v[104:107], a[80:83], v[144:147], v[104:107]
    ds_read_b64_tr_b16 a[30:31], v7 offset:25088
    v_mfma_f32_16x16x32_bf16 v[108:111], a[84:87], v[144:147], v[108:111]
    v_mfma_f32_16x16x32_bf16 v[112:115], a[88:91], v[144:147], v[112:115]
    v_mfma_f32_16x16x32_bf16 v[116:119], a[92:95], v[144:147], v[116:119]
    ds_read_b128 v[144:147], v0 offset:49152
    s_waitcnt lgkmcnt(7)
    v_mfma_f32_16x16x32_bf16 v[8:11], a[96:99], v[120:123], v[8:11]
    v_mfma_f32_16x16x32_bf16 v[12:15], a[100:103], v[120:123], v[12:15]
    v_mfma_f32_16x16x32_bf16 v[16:19], a[104:107], v[120:123], v[16:19]
    v_mfma_f32_16x16x32_bf16 v[20:23], a[108:111], v[120:123], v[20:23]
    ds_read_b128 v[120:123], v0 offset:50176
    s_waitcnt lgkmcnt(2)
    s_mov_b32 m0, s55
    v_mfma_f32_16x16x32_bf16 v[24:27], a[96:99], v[124:127], v[24:27]
    s_addk_i32 s71, 8192
    buffer_load_dwordx4 v5, s[32:35], s71 offen nt lds
    v_mfma_f32_16x16x32_bf16 v[28:31], a[100:103], v[124:127], v[28:31]
    buffer_load_dwordx4 v5, s[36:39], s71 offen offset:1024 nt lds
    v_mfma_f32_16x16x32_bf16 v[32:35], a[104:107], v[124:127], v[32:35]
    v_mfma_f32_16x16x32_bf16 v[36:39], a[108:111], v[124:127], v[36:39]
    ds_read_b128 v[124:127], v0 offset:51200
    v_mfma_f32_16x16x32_bf16 v[40:43], a[96:99], v[128:131], v[40:43]
    v_mfma_f32_16x16x32_bf16 v[44:47], a[100:103], v[128:131], v[44:47]
    v_mfma_f32_16x16x32_bf16 v[48:51], a[104:107], v[128:131], v[48:51]
    v_mfma_f32_16x16x32_bf16 v[52:55], a[108:111], v[128:131], v[52:55]
    ds_read_b128 v[128:131], v0 offset:52224
    v_mfma_f32_16x16x32_bf16 v[56:59], a[96:99], v[132:135], v[56:59]
    v_mfma_f32_16x16x32_bf16 v[60:63], a[100:103], v[132:135], v[60:63]
    v_mfma_f32_16x16x32_bf16 v[64:67], a[104:107], v[132:135], v[64:67]
    v_mfma_f32_16x16x32_bf16 v[68:71], a[108:111], v[132:135], v[68:71]
    ds_read_b128 v[132:135], v0 offset:53248
    v_mfma_f32_16x16x32_bf16 v[72:75], a[96:99], v[136:139], v[72:75]
    v_mfma_f32_16x16x32_bf16 v[76:79], a[100:103], v[136:139], v[76:79]
    s_waitcnt vmcnt(16)
    ds_read_b64_tr_b16 a[32:33], v6 offset:32768
    v_mfma_f32_16x16x32_bf16 v[80:83], a[104:107], v[136:139], v[80:83]
    ds_read_b64_tr_b16 a[36:37], v7 offset:32768
    v_mfma_f32_16x16x32_bf16 v[84:87], a[108:111], v[136:139], v[84:87]
    ds_read_b128 v[136:139], v0 offset:54272
    v_mfma_f32_16x16x32_bf16 v[88:91], a[96:99], v[140:143], v[88:91]
    ds_read_b64_tr_b16 a[40:41], v6 offset:33280
    v_mfma_f32_16x16x32_bf16 v[92:95], a[100:103], v[140:143], v[92:95]
    ds_read_b64_tr_b16 a[44:45], v7 offset:33280
    v_mfma_f32_16x16x32_bf16 v[96:99], a[104:107], v[140:143], v[96:99]
    v_mfma_f32_16x16x32_bf16 v[100:103], a[108:111], v[140:143], v[100:103]
    ds_read_b128 v[140:143], v0 offset:55296
    s_waitcnt lgkmcnt(7)
    v_mfma_f32_16x16x32_bf16 v[104:107], a[96:99], v[144:147], v[104:107]
    v_mfma_f32_16x16x32_bf16 v[108:111], a[100:103], v[144:147], v[108:111]
    v_mfma_f32_16x16x32_bf16 v[112:115], a[104:107], v[144:147], v[112:115]
    v_mfma_f32_16x16x32_bf16 v[116:119], a[108:111], v[144:147], v[116:119]
    ds_read_b128 v[144:147], v0 offset:56320
    v_mfma_f32_16x16x32_bf16 v[8:11], a[0:3], v[120:123], v[8:11]
    s_barrier
    s_mov_b32 m0, s63
    s_addk_i32 s71, 8192
    v_mfma_f32_16x16x32_bf16 v[12:15], a[4:7], v[120:123], v[12:15]
    buffer_load_dwordx4 v5, s[32:35], s71 offen nt lds
    v_mfma_f32_16x16x32_bf16 v[16:19], a[8:11], v[120:123], v[16:19]
    buffer_load_dwordx4 v5, s[36:39], s71 offen offset:1024 nt lds
    s_mov_b32 m0, s64
    s_addk_i32 s71, 8192
    v_mfma_f32_16x16x32_bf16 v[20:23], a[12:15], v[120:123], v[20:23]
    ds_read_b128 v[120:123], v0 offset:57344
    v_mfma_f32_16x16x32_bf16 v[24:27], a[0:3], v[124:127], v[24:27]
    buffer_load_dwordx4 v5, s[32:35], s71 offen nt lds
    v_mfma_f32_16x16x32_bf16 v[28:31], a[4:7], v[124:127], v[28:31]
    buffer_load_dwordx4 v5, s[36:39], s71 offen offset:1024 nt lds
    s_waitcnt lgkmcnt(2)
    s_mov_b32 m0, s56
    v_mfma_f32_16x16x32_bf16 v[32:35], a[8:11], v[124:127], v[32:35]
    s_addk_i32 s71, 8192
    buffer_load_dwordx4 v5, s[32:35], s71 offen nt lds
    v_mfma_f32_16x16x32_bf16 v[36:39], a[12:15], v[124:127], v[36:39]
    ds_read_b128 v[124:127], v0 offset:58368
    v_mfma_f32_16x16x32_bf16 v[40:43], a[0:3], v[128:131], v[40:43]
    buffer_load_dwordx4 v5, s[36:39], s71 offen offset:1024 nt lds
    v_mfma_f32_16x16x32_bf16 v[44:47], a[4:7], v[128:131], v[44:47]
    v_mfma_f32_16x16x32_bf16 v[48:51], a[8:11], v[128:131], v[48:51]
    v_mfma_f32_16x16x32_bf16 v[52:55], a[12:15], v[128:131], v[52:55]
    ds_read_b128 v[128:131], v0 offset:59392
    v_mfma_f32_16x16x32_bf16 v[56:59], a[0:3], v[132:135], v[56:59]
    v_mfma_f32_16x16x32_bf16 v[60:63], a[4:7], v[132:135], v[60:63]
    v_mfma_f32_16x16x32_bf16 v[64:67], a[8:11], v[132:135], v[64:67]
    s_waitcnt vmcnt(20)
    ds_read_b64_tr_b16 a[34:35], v6 offset:16384
    v_mfma_f32_16x16x32_bf16 v[68:71], a[12:15], v[132:135], v[68:71]
    ds_read_b128 v[132:135], v0 offset:60416
    v_mfma_f32_16x16x32_bf16 v[72:75], a[0:3], v[136:139], v[72:75]
    ds_read_b64_tr_b16 a[38:39], v7 offset:16384
    v_mfma_f32_16x16x32_bf16 v[76:79], a[4:7], v[136:139], v[76:79]
    ds_read_b64_tr_b16 a[42:43], v6 offset:16896
    v_mfma_f32_16x16x32_bf16 v[80:83], a[8:11], v[136:139], v[80:83]
    ds_read_b64_tr_b16 a[46:47], v7 offset:16896
    v_mfma_f32_16x16x32_bf16 v[84:87], a[12:15], v[136:139], v[84:87]
    ds_read_b128 v[136:139], v0 offset:61440
    v_mfma_f32_16x16x32_bf16 v[88:91], a[0:3], v[140:143], v[88:91]
    v_mfma_f32_16x16x32_bf16 v[92:95], a[4:7], v[140:143], v[92:95]
    v_mfma_f32_16x16x32_bf16 v[96:99], a[8:11], v[140:143], v[96:99]
    v_mfma_f32_16x16x32_bf16 v[100:103], a[12:15], v[140:143], v[100:103]
    ds_read_b128 v[140:143], v0 offset:62464
    s_waitcnt lgkmcnt(7)
    v_mfma_f32_16x16x32_bf16 v[104:107], a[0:3], v[144:147], v[104:107]
    v_mfma_f32_16x16x32_bf16 v[108:111], a[4:7], v[144:147], v[108:111]
    s_waitcnt lgkmcnt(2)
    s_mov_b32 m0, s54
    s_addk_i32 s71, 8192
    v_mfma_f32_16x16x32_bf16 v[112:115], a[8:11], v[144:147], v[112:115]
    buffer_load_dwordx4 v5, s[32:35], s71 offen nt lds
    v_mfma_f32_16x16x32_bf16 v[116:119], a[12:15], v[144:147], v[116:119]
    ds_read_b128 v[144:147], v0 offset:63488
    v_mfma_f32_16x16x32_bf16 v[8:11], a[16:19], v[120:123], v[8:11]
    s_barrier
    buffer_load_dwordx4 v5, s[36:39], s71 offen offset:1024 nt lds
    s_mov_b32 m0, s65
    v_mfma_f32_16x16x32_bf16 v[12:15], a[20:23], v[120:123], v[12:15]
    s_addk_i32 s71, 8192
    buffer_load_dwordx4 v5, s[32:35], s71 offen nt lds
    v_mfma_f32_16x16x32_bf16 v[16:19], a[24:27], v[120:123], v[16:19]
    buffer_load_dwordx4 v5, s[36:39], s71 offen offset:1024 nt lds
    v_mfma_f32_16x16x32_bf16 v[20:23], a[28:31], v[120:123], v[20:23]
    ds_read_b128 v[120:123], v0 offset:64512
    v_mfma_f32_16x16x32_bf16 v[24:27], a[16:19], v[124:127], v[24:27]
    v_mfma_f32_16x16x32_bf16 v[28:31], a[20:23], v[124:127], v[28:31]
    v_mfma_f32_16x16x32_bf16 v[32:35], a[24:27], v[124:127], v[32:35]
    v_mfma_f32_16x16x32_bf16 v[36:39], a[28:31], v[124:127], v[36:39]
    ds_read_b128 v[124:127], v1 offset:0
    v_mfma_f32_16x16x32_bf16 v[40:43], a[16:19], v[128:131], v[40:43]
    v_mfma_f32_16x16x32_bf16 v[44:47], a[20:23], v[128:131], v[44:47]
    v_mfma_f32_16x16x32_bf16 v[48:51], a[24:27], v[128:131], v[48:51]
    v_mfma_f32_16x16x32_bf16 v[52:55], a[28:31], v[128:131], v[52:55]
    ds_read_b128 v[128:131], v1 offset:1024
    s_waitcnt vmcnt(22)
    v_mfma_f32_16x16x32_bf16 v[56:59], a[16:19], v[132:135], v[56:59]
    ds_read_b64_tr_b16 a[0:1], v151 offset:0
    v_mfma_f32_16x16x32_bf16 v[60:63], a[20:23], v[132:135], v[60:63]
    ds_read_b64_tr_b16 a[4:5], v152 offset:0
    v_mfma_f32_16x16x32_bf16 v[64:67], a[24:27], v[132:135], v[64:67]
    ds_read_b64_tr_b16 a[8:9], v151 offset:512
    v_mfma_f32_16x16x32_bf16 v[68:71], a[28:31], v[132:135], v[68:71]
    ds_read_b128 v[132:135], v1 offset:2048
    s_waitcnt lgkmcnt(6)
    v_mfma_f32_16x16x32_bf16 v[72:75], a[16:19], v[136:139], v[72:75]
    ds_read_b64_tr_b16 a[12:13], v152 offset:512
    v_mfma_f32_16x16x32_bf16 v[76:79], a[20:23], v[136:139], v[76:79]
    v_mfma_f32_16x16x32_bf16 v[80:83], a[24:27], v[136:139], v[80:83]
    v_mfma_f32_16x16x32_bf16 v[84:87], a[28:31], v[136:139], v[84:87]
    ds_read_b128 v[136:139], v1 offset:3072
    v_mfma_f32_16x16x32_bf16 v[88:91], a[16:19], v[140:143], v[88:91]
    v_mfma_f32_16x16x32_bf16 v[92:95], a[20:23], v[140:143], v[92:95]
    v_mfma_f32_16x16x32_bf16 v[96:99], a[24:27], v[140:143], v[96:99]
    v_mfma_f32_16x16x32_bf16 v[100:103], a[28:31], v[140:143], v[100:103]
    ds_read_b128 v[140:143], v1 offset:4096
    s_waitcnt lgkmcnt(2)
    s_mov_b32 m0, s59
    v_mfma_f32_16x16x32_bf16 v[104:107], a[16:19], v[144:147], v[104:107]
    s_mul_i32 s92, s5, 28672
    buffer_load_dwordx4 v148, s[40:43], s92 offen lds
    v_mfma_f32_16x16x32_bf16 v[108:111], a[20:23], v[144:147], v[108:111]
    buffer_load_dwordx4 v148, s[44:47], s92 offen offset:1024 lds
    v_mfma_f32_16x16x32_bf16 v[112:115], a[24:27], v[144:147], v[112:115]
    v_mfma_f32_16x16x32_bf16 v[116:119], a[28:31], v[144:147], v[116:119]
    ds_read_b128 v[144:147], v1 offset:5120
    v_mfma_f32_16x16x32_bf16 v[8:11], a[32:35], v[120:123], v[8:11]
    v_mfma_f32_16x16x32_bf16 v[12:15], a[36:39], v[120:123], v[12:15]
    v_mfma_f32_16x16x32_bf16 v[16:19], a[40:43], v[120:123], v[16:19]
    v_mfma_f32_16x16x32_bf16 v[20:23], a[44:47], v[120:123], v[20:23]
    ds_read_b128 v[120:123], v1 offset:6144
    v_mfma_f32_16x16x32_bf16 v[24:27], a[32:35], v[124:127], v[24:27]
    v_mfma_f32_16x16x32_bf16 v[28:31], a[36:39], v[124:127], v[28:31]
    v_mfma_f32_16x16x32_bf16 v[32:35], a[40:43], v[124:127], v[32:35]
    v_mfma_f32_16x16x32_bf16 v[36:39], a[44:47], v[124:127], v[36:39]
    ds_read_b128 v[124:127], v1 offset:7168
    v_mfma_f32_16x16x32_bf16 v[40:43], a[32:35], v[128:131], v[40:43]
    s_waitcnt vmcnt(22)
    ds_read_b64_tr_b16 a[2:3], v151 offset:8192
    v_mfma_f32_16x16x32_bf16 v[44:47], a[36:39], v[128:131], v[44:47]
    ds_read_b64_tr_b16 a[6:7], v152 offset:8192
    v_mfma_f32_16x16x32_bf16 v[48:51], a[40:43], v[128:131], v[48:51]
    ds_read_b64_tr_b16 a[10:11], v151 offset:8704
    v_mfma_f32_16x16x32_bf16 v[52:55], a[44:47], v[128:131], v[52:55]
    ds_read_b128 v[128:131], v1 offset:8192
    v_mfma_f32_16x16x32_bf16 v[56:59], a[32:35], v[132:135], v[56:59]
    ds_read_b64_tr_b16 a[14:15], v152 offset:8704
    v_mfma_f32_16x16x32_bf16 v[60:63], a[36:39], v[132:135], v[60:63]
    v_mfma_f32_16x16x32_bf16 v[64:67], a[40:43], v[132:135], v[64:67]
    v_mfma_f32_16x16x32_bf16 v[68:71], a[44:47], v[132:135], v[68:71]
    ds_read_b128 v[132:135], v1 offset:9216
    s_waitcnt lgkmcnt(7)
    v_mfma_f32_16x16x32_bf16 v[72:75], a[32:35], v[136:139], v[72:75]
    v_mfma_f32_16x16x32_bf16 v[76:79], a[36:39], v[136:139], v[76:79]
    v_mfma_f32_16x16x32_bf16 v[80:83], a[40:43], v[136:139], v[80:83]
    v_mfma_f32_16x16x32_bf16 v[84:87], a[44:47], v[136:139], v[84:87]
    ds_read_b128 v[136:139], v1 offset:10240
    s_waitcnt lgkmcnt(2)
    s_mov_b32 m0, s60
    v_mfma_f32_16x16x32_bf16 v[88:91], a[32:35], v[140:143], v[88:91]
    s_addk_i32 s92, 14336
    buffer_load_dwordx4 v148, s[40:43], s92 offen lds
    v_mfma_f32_16x16x32_bf16 v[92:95], a[36:39], v[140:143], v[92:95]
    buffer_load_dwordx4 v148, s[44:47], s92 offen offset:1024 lds
    v_mfma_f32_16x16x32_bf16 v[96:99], a[40:43], v[140:143], v[96:99]
    v_mfma_f32_16x16x32_bf16 v[100:103], a[44:47], v[140:143], v[100:103]
    ds_read_b128 v[140:143], v1 offset:11264
    v_mfma_f32_16x16x32_bf16 v[104:107], a[32:35], v[144:147], v[104:107]
    v_mfma_f32_16x16x32_bf16 v[108:111], a[36:39], v[144:147], v[108:111]
    v_mfma_f32_16x16x32_bf16 v[112:115], a[40:43], v[144:147], v[112:115]
    v_mfma_f32_16x16x32_bf16 v[116:119], a[44:47], v[144:147], v[116:119]
    ds_read_b128 v[144:147], v1 offset:12288
    v_mfma_f32_16x16x32_bf16 v[8:11], a[0:3], v[120:123], v[8:11]
    v_mfma_f32_16x16x32_bf16 v[12:15], a[4:7], v[120:123], v[12:15]
    v_mfma_f32_16x16x32_bf16 v[16:19], a[8:11], v[120:123], v[16:19]
    v_mfma_f32_16x16x32_bf16 v[20:23], a[12:15], v[120:123], v[20:23]
    ds_read_b128 v[120:123], v1 offset:13312
    v_mfma_f32_16x16x32_bf16 v[24:27], a[0:3], v[124:127], v[24:27]
    v_mfma_f32_16x16x32_bf16 v[28:31], a[4:7], v[124:127], v[28:31]
    s_waitcnt vmcnt(22)
    ds_read_b64_tr_b16 a[16:17], v6 offset:40960
    v_mfma_f32_16x16x32_bf16 v[32:35], a[8:11], v[124:127], v[32:35]
    ds_read_b64_tr_b16 a[20:21], v7 offset:40960
    v_mfma_f32_16x16x32_bf16 v[36:39], a[12:15], v[124:127], v[36:39]
    ds_read_b128 v[124:127], v1 offset:14336
    v_mfma_f32_16x16x32_bf16 v[40:43], a[0:3], v[128:131], v[40:43]
    ds_read_b64_tr_b16 a[24:25], v6 offset:41472
    v_mfma_f32_16x16x32_bf16 v[44:47], a[4:7], v[128:131], v[44:47]
    ds_read_b64_tr_b16 a[28:29], v7 offset:41472
    v_mfma_f32_16x16x32_bf16 v[48:51], a[8:11], v[128:131], v[48:51]
    v_mfma_f32_16x16x32_bf16 v[52:55], a[12:15], v[128:131], v[52:55]
    ds_read_b128 v[128:131], v1 offset:15360
    s_waitcnt lgkmcnt(7)
    v_mfma_f32_16x16x32_bf16 v[56:59], a[0:3], v[132:135], v[56:59]
    s_waitcnt vmcnt(20)
    ds_read_b64_tr_b16 a[18:19], v151 offset:16384
    s_waitcnt lgkmcnt(1)
    v_mfma_f32_16x16x32_bf16 v[60:63], a[4:7], v[132:135], v[60:63]
    s_mov_b32 m0, s57
    s_addk_i32 s92, 14336
    s_cmp_ge_u32 s92, 229376
    s_cselect_b32 s13, 229376, 0
    s_sub_u32 s92, s92, s13
    v_mfma_f32_16x16x32_bf16 v[64:67], a[8:11], v[132:135], v[64:67]
    buffer_load_dwordx4 v148, s[40:43], s92 offen lds
    v_mfma_f32_16x16x32_bf16 v[68:71], a[12:15], v[132:135], v[68:71]
    ds_read_b128 v[132:135], v1 offset:16384
    v_mfma_f32_16x16x32_bf16 v[72:75], a[0:3], v[136:139], v[72:75]
    buffer_load_dwordx4 v148, s[44:47], s92 offen offset:1024 lds
    v_mfma_f32_16x16x32_bf16 v[76:79], a[4:7], v[136:139], v[76:79]
    ds_read_b64_tr_b16 a[22:23], v152 offset:16384
    v_mfma_f32_16x16x32_bf16 v[80:83], a[8:11], v[136:139], v[80:83]
    ds_read_b64_tr_b16 a[26:27], v151 offset:16896
    v_mfma_f32_16x16x32_bf16 v[84:87], a[12:15], v[136:139], v[84:87]
    ds_read_b128 v[136:139], v1 offset:17408
    v_mfma_f32_16x16x32_bf16 v[88:91], a[0:3], v[140:143], v[88:91]
    ds_read_b64_tr_b16 a[30:31], v152 offset:16896
    v_mfma_f32_16x16x32_bf16 v[92:95], a[4:7], v[140:143], v[92:95]
    v_mfma_f32_16x16x32_bf16 v[96:99], a[8:11], v[140:143], v[96:99]
    v_mfma_f32_16x16x32_bf16 v[100:103], a[12:15], v[140:143], v[100:103]
    ds_read_b128 v[140:143], v1 offset:18432
    v_mfma_f32_16x16x32_bf16 v[104:107], a[0:3], v[144:147], v[104:107]
    v_mfma_f32_16x16x32_bf16 v[108:111], a[4:7], v[144:147], v[108:111]
    v_mfma_f32_16x16x32_bf16 v[112:115], a[8:11], v[144:147], v[112:115]
    v_mfma_f32_16x16x32_bf16 v[116:119], a[12:15], v[144:147], v[116:119]
    ds_read_b128 v[144:147], v1 offset:19456
    s_waitcnt lgkmcnt(2)
    s_mov_b32 m0, s61
    v_mfma_f32_16x16x32_bf16 v[8:11], a[16:19], v[120:123], v[8:11]
    s_addk_i32 s92, 14336
    buffer_load_dwordx4 v148, s[40:43], s92 offen lds
    v_mfma_f32_16x16x32_bf16 v[12:15], a[20:23], v[120:123], v[12:15]
    buffer_load_dwordx4 v148, s[44:47], s92 offen offset:1024 lds
    v_mfma_f32_16x16x32_bf16 v[16:19], a[24:27], v[120:123], v[16:19]
    v_mfma_f32_16x16x32_bf16 v[20:23], a[28:31], v[120:123], v[20:23]
    ds_read_b128 v[120:123], v1 offset:20480
    v_mfma_f32_16x16x32_bf16 v[24:27], a[16:19], v[124:127], v[24:27]
    v_mfma_f32_16x16x32_bf16 v[28:31], a[20:23], v[124:127], v[28:31]
    v_mfma_f32_16x16x32_bf16 v[32:35], a[24:27], v[124:127], v[32:35]
    v_mfma_f32_16x16x32_bf16 v[36:39], a[28:31], v[124:127], v[36:39]
    ds_read_b128 v[124:127], v1 offset:21504
    v_mfma_f32_16x16x32_bf16 v[40:43], a[16:19], v[128:131], v[40:43]
    v_mfma_f32_16x16x32_bf16 v[44:47], a[20:23], v[128:131], v[44:47]
    v_mfma_f32_16x16x32_bf16 v[48:51], a[24:27], v[128:131], v[48:51]
    s_waitcnt vmcnt(22)
    ds_read_b64_tr_b16 a[0:1], v151 offset:24576
    v_mfma_f32_16x16x32_bf16 v[52:55], a[28:31], v[128:131], v[52:55]
    ds_read_b128 v[128:131], v1 offset:22528
    v_mfma_f32_16x16x32_bf16 v[56:59], a[16:19], v[132:135], v[56:59]
    ds_read_b64_tr_b16 a[4:5], v152 offset:24576
    v_mfma_f32_16x16x32_bf16 v[60:63], a[20:23], v[132:135], v[60:63]
    ds_read_b64_tr_b16 a[8:9], v151 offset:25088
    v_mfma_f32_16x16x32_bf16 v[64:67], a[24:27], v[132:135], v[64:67]
    ds_read_b64_tr_b16 a[12:13], v152 offset:25088
    s_waitcnt vmcnt(20)
    s_waitcnt lgkmcnt(0)
    v_mfma_f32_16x16x32_bf16 v[68:71], a[28:31], v[132:135], v[68:71]
    ds_read_b128 v[132:135], v1 offset:23552
    s_mov_b32 m0, s62
    s_addk_i32 s92, 14336
    s_cmp_ge_u32 s92, 229376
    s_cselect_b32 s13, 229376, 0
    s_sub_u32 s92, s92, s13
    v_mfma_f32_16x16x32_bf16 v[72:75], a[16:19], v[136:139], v[72:75]
    buffer_load_dwordx4 v148, s[40:43], s92 offen lds
    v_mfma_f32_16x16x32_bf16 v[76:79], a[20:23], v[136:139], v[76:79]
    buffer_load_dwordx4 v148, s[44:47], s92 offen offset:1024 lds
    v_mfma_f32_16x16x32_bf16 v[80:83], a[24:27], v[136:139], v[80:83]
    ds_read_b64_tr_b16 a[2:3], v6 offset:49152
    v_mfma_f32_16x16x32_bf16 v[84:87], a[28:31], v[136:139], v[84:87]
    ds_read_b128 v[136:139], v1 offset:24576
    v_mfma_f32_16x16x32_bf16 v[88:91], a[16:19], v[140:143], v[88:91]
    ds_read_b64_tr_b16 a[6:7], v7 offset:49152
    v_mfma_f32_16x16x32_bf16 v[92:95], a[20:23], v[140:143], v[92:95]
    ds_read_b64_tr_b16 a[10:11], v6 offset:49664
    v_mfma_f32_16x16x32_bf16 v[96:99], a[24:27], v[140:143], v[96:99]
    ds_read_b64_tr_b16 a[14:15], v7 offset:49664
    v_mfma_f32_16x16x32_bf16 v[100:103], a[28:31], v[140:143], v[100:103]
    ds_read_b128 v[140:143], v1 offset:25600
    v_mfma_f32_16x16x32_bf16 v[104:107], a[16:19], v[144:147], v[104:107]
    v_mfma_f32_16x16x32_bf16 v[108:111], a[20:23], v[144:147], v[108:111]
    v_mfma_f32_16x16x32_bf16 v[112:115], a[24:27], v[144:147], v[112:115]
    v_mfma_f32_16x16x32_bf16 v[116:119], a[28:31], v[144:147], v[116:119]
    ds_read_b128 v[144:147], v1 offset:26624
    s_waitcnt lgkmcnt(2)
    v_mfma_f32_16x16x32_bf16 v[8:11], a[0:3], v[120:123], v[8:11]
    s_mov_b32 m0, s58
    s_addk_i32 s92, 14336
    buffer_load_dwordx4 v148, s[40:43], s92 offen lds
    v_mfma_f32_16x16x32_bf16 v[12:15], a[4:7], v[120:123], v[12:15]
    buffer_load_dwordx4 v148, s[44:47], s92 offen offset:1024 lds
    v_mfma_f32_16x16x32_bf16 v[16:19], a[8:11], v[120:123], v[16:19]
    v_mfma_f32_16x16x32_bf16 v[20:23], a[12:15], v[120:123], v[20:23]
    ds_read_b128 v[120:123], v1 offset:27648
    v_mfma_f32_16x16x32_bf16 v[24:27], a[0:3], v[124:127], v[24:27]
    v_mfma_f32_16x16x32_bf16 v[28:31], a[4:7], v[124:127], v[28:31]
    v_mfma_f32_16x16x32_bf16 v[32:35], a[8:11], v[124:127], v[32:35]
    v_mfma_f32_16x16x32_bf16 v[36:39], a[12:15], v[124:127], v[36:39]
    ds_read_b128 v[124:127], v1 offset:28672
    v_mfma_f32_16x16x32_bf16 v[40:43], a[0:3], v[128:131], v[40:43]
    v_mfma_f32_16x16x32_bf16 v[44:47], a[4:7], v[128:131], v[44:47]
    v_mfma_f32_16x16x32_bf16 v[48:51], a[8:11], v[128:131], v[48:51]
    v_mfma_f32_16x16x32_bf16 v[52:55], a[12:15], v[128:131], v[52:55]
    ds_read_b128 v[128:131], v1 offset:29696
    s_waitcnt vmcnt(22)
    v_mfma_f32_16x16x32_bf16 v[56:59], a[0:3], v[132:135], v[56:59]
    ds_read_b64_tr_b16 a[16:17], v6 offset:24576
    v_mfma_f32_16x16x32_bf16 v[60:63], a[4:7], v[132:135], v[60:63]
    ds_read_b64_tr_b16 a[20:21], v7 offset:24576
    v_mfma_f32_16x16x32_bf16 v[64:67], a[8:11], v[132:135], v[64:67]
    ds_read_b64_tr_b16 a[24:25], v6 offset:25088
    v_mfma_f32_16x16x32_bf16 v[68:71], a[12:15], v[132:135], v[68:71]
    ds_read_b128 v[132:135], v1 offset:30720
    v_mfma_f32_16x16x32_bf16 v[72:75], a[0:3], v[136:139], v[72:75]
    ds_read_b64_tr_b16 a[28:29], v7 offset:25088
    s_waitcnt vmcnt(20)
    s_waitcnt lgkmcnt(0)
    v_mfma_f32_16x16x32_bf16 v[76:79], a[4:7], v[136:139], v[76:79]
    s_mov_b32 m0, s55
    s_addk_i32 s92, 14336
    s_cmp_ge_u32 s92, 229376
    s_cselect_b32 s13, 229376, 0
    s_sub_u32 s92, s92, s13
    v_mfma_f32_16x16x32_bf16 v[80:83], a[8:11], v[136:139], v[80:83]
    buffer_load_dwordx4 v148, s[40:43], s92 offen lds
    v_mfma_f32_16x16x32_bf16 v[84:87], a[12:15], v[136:139], v[84:87]
    ds_read_b128 v[136:139], v1 offset:31744
    v_mfma_f32_16x16x32_bf16 v[88:91], a[0:3], v[140:143], v[88:91]
    buffer_load_dwordx4 v148, s[44:47], s92 offen offset:1024 lds
    v_mfma_f32_16x16x32_bf16 v[92:95], a[4:7], v[140:143], v[92:95]
    ds_read_b64_tr_b16 a[18:19], v151 offset:32768
    v_mfma_f32_16x16x32_bf16 v[96:99], a[8:11], v[140:143], v[96:99]
    ds_read_b64_tr_b16 a[22:23], v152 offset:32768
    v_mfma_f32_16x16x32_bf16 v[100:103], a[12:15], v[140:143], v[100:103]
    ds_read_b128 v[140:143], v1 offset:32768
    v_mfma_f32_16x16x32_bf16 v[104:107], a[0:3], v[144:147], v[104:107]
    ds_read_b64_tr_b16 a[26:27], v151 offset:33280
    v_mfma_f32_16x16x32_bf16 v[108:111], a[4:7], v[144:147], v[108:111]
    ds_read_b64_tr_b16 a[30:31], v152 offset:33280
    v_mfma_f32_16x16x32_bf16 v[112:115], a[8:11], v[144:147], v[112:115]
    v_mfma_f32_16x16x32_bf16 v[116:119], a[12:15], v[144:147], v[116:119]
    ds_read_b128 v[144:147], v1 offset:33792
    s_waitcnt lgkmcnt(1)
    v_mfma_f32_16x16x32_bf16 v[8:11], a[16:19], v[120:123], v[8:11]
    s_mov_b32 m0, s63
    s_addk_i32 s92, 14336
    buffer_load_dwordx4 v148, s[40:43], s92 offen lds
    v_mfma_f32_16x16x32_bf16 v[12:15], a[20:23], v[120:123], v[12:15]
    buffer_load_dwordx4 v148, s[44:47], s92 offen offset:1024 lds
    v_mfma_f32_16x16x32_bf16 v[16:19], a[24:27], v[120:123], v[16:19]
    v_mfma_f32_16x16x32_bf16 v[20:23], a[28:31], v[120:123], v[20:23]
    ds_read_b128 v[120:123], v1 offset:34816
    v_mfma_f32_16x16x32_bf16 v[24:27], a[16:19], v[124:127], v[24:27]
    v_mfma_f32_16x16x32_bf16 v[28:31], a[20:23], v[124:127], v[28:31]
    v_mfma_f32_16x16x32_bf16 v[32:35], a[24:27], v[124:127], v[32:35]
    v_mfma_f32_16x16x32_bf16 v[36:39], a[28:31], v[124:127], v[36:39]
    ds_read_b128 v[124:127], v1 offset:35840
    v_mfma_f32_16x16x32_bf16 v[40:43], a[16:19], v[128:131], v[40:43]
    v_mfma_f32_16x16x32_bf16 v[44:47], a[20:23], v[128:131], v[44:47]
    v_mfma_f32_16x16x32_bf16 v[48:51], a[24:27], v[128:131], v[48:51]
    v_mfma_f32_16x16x32_bf16 v[52:55], a[28:31], v[128:131], v[52:55]
    ds_read_b128 v[128:131], v1 offset:36864
    v_mfma_f32_16x16x32_bf16 v[56:59], a[16:19], v[132:135], v[56:59]
    s_waitcnt vmcnt(22)
    ds_read_b64_tr_b16 a[0:1], v151 offset:40960
    v_mfma_f32_16x16x32_bf16 v[60:63], a[20:23], v[132:135], v[60:63]
    ds_read_b64_tr_b16 a[4:5], v152 offset:40960
    v_mfma_f32_16x16x32_bf16 v[64:67], a[24:27], v[132:135], v[64:67]
    ds_read_b64_tr_b16 a[8:9], v151 offset:41472
    v_mfma_f32_16x16x32_bf16 v[68:71], a[28:31], v[132:135], v[68:71]
    ds_read_b128 v[132:135], v1 offset:37888
    v_mfma_f32_16x16x32_bf16 v[72:75], a[16:19], v[136:139], v[72:75]
    ds_read_b64_tr_b16 a[12:13], v152 offset:41472
    s_waitcnt vmcnt(20)
    s_waitcnt lgkmcnt(0)
    v_mfma_f32_16x16x32_bf16 v[76:79], a[20:23], v[136:139], v[76:79]
    s_mov_b32 m0, s64
    s_addk_i32 s92, 14336
    s_cmp_ge_u32 s92, 229376
    s_cselect_b32 s13, 229376, 0
    s_sub_u32 s92, s92, s13
    v_mfma_f32_16x16x32_bf16 v[80:83], a[24:27], v[136:139], v[80:83]
    buffer_load_dwordx4 v148, s[40:43], s92 offen lds
    v_mfma_f32_16x16x32_bf16 v[84:87], a[28:31], v[136:139], v[84:87]
    ds_read_b128 v[136:139], v1 offset:38912
    v_mfma_f32_16x16x32_bf16 v[88:91], a[16:19], v[140:143], v[88:91]
    buffer_load_dwordx4 v148, s[44:47], s92 offen offset:1024 lds
    v_mfma_f32_16x16x32_bf16 v[92:95], a[20:23], v[140:143], v[92:95]
    ds_read_b64_tr_b16 a[2:3], v6 offset:32768
    v_mfma_f32_16x16x32_bf16 v[96:99], a[24:27], v[140:143], v[96:99]
    ds_read_b64_tr_b16 a[6:7], v7 offset:32768
    v_mfma_f32_16x16x32_bf16 v[100:103], a[28:31], v[140:143], v[100:103]
    ds_read_b128 v[140:143], v1 offset:39936
    v_mfma_f32_16x16x32_bf16 v[104:107], a[16:19], v[144:147], v[104:107]
    ds_read_b64_tr_b16 a[10:11], v6 offset:33280
    v_mfma_f32_16x16x32_bf16 v[108:111], a[20:23], v[144:147], v[108:111]
    ds_read_b64_tr_b16 a[14:15], v7 offset:33280
    v_mfma_f32_16x16x32_bf16 v[112:115], a[24:27], v[144:147], v[112:115]
    v_mfma_f32_16x16x32_bf16 v[116:119], a[28:31], v[144:147], v[116:119]
    ds_read_b128 v[144:147], v1 offset:40960
    s_waitcnt lgkmcnt(1)
    v_mfma_f32_16x16x32_bf16 v[8:11], a[0:3], v[120:123], v[8:11]
    s_mov_b32 m0, s56
    s_addk_i32 s92, 14336
    buffer_load_dwordx4 v148, s[40:43], s92 offen lds
    v_mfma_f32_16x16x32_bf16 v[12:15], a[4:7], v[120:123], v[12:15]
    buffer_load_dwordx4 v148, s[44:47], s92 offen offset:1024 lds
    v_mfma_f32_16x16x32_bf16 v[16:19], a[8:11], v[120:123], v[16:19]
    v_mfma_f32_16x16x32_bf16 v[20:23], a[12:15], v[120:123], v[20:23]
    ds_read_b128 v[120:123], v1 offset:41984
    v_mfma_f32_16x16x32_bf16 v[24:27], a[0:3], v[124:127], v[24:27]
    v_mfma_f32_16x16x32_bf16 v[28:31], a[4:7], v[124:127], v[28:31]
    v_mfma_f32_16x16x32_bf16 v[32:35], a[8:11], v[124:127], v[32:35]
    v_mfma_f32_16x16x32_bf16 v[36:39], a[12:15], v[124:127], v[36:39]
    ds_read_b128 v[124:127], v1 offset:43008
    v_mfma_f32_16x16x32_bf16 v[40:43], a[0:3], v[128:131], v[40:43]
    v_mfma_f32_16x16x32_bf16 v[44:47], a[4:7], v[128:131], v[44:47]
    v_mfma_f32_16x16x32_bf16 v[48:51], a[8:11], v[128:131], v[48:51]
    v_mfma_f32_16x16x32_bf16 v[52:55], a[12:15], v[128:131], v[52:55]
    ds_read_b128 v[128:131], v1 offset:44032
    v_mfma_f32_16x16x32_bf16 v[56:59], a[0:3], v[132:135], v[56:59]
    s_waitcnt vmcnt(22)
    ds_read_b64_tr_b16 a[16:17], v6 offset:16384
    v_mfma_f32_16x16x32_bf16 v[60:63], a[4:7], v[132:135], v[60:63]
    ds_read_b64_tr_b16 a[20:21], v7 offset:16384
    v_mfma_f32_16x16x32_bf16 v[64:67], a[8:11], v[132:135], v[64:67]
    ds_read_b64_tr_b16 a[24:25], v6 offset:16896
    v_mfma_f32_16x16x32_bf16 v[68:71], a[12:15], v[132:135], v[68:71]
    ds_read_b128 v[132:135], v1 offset:45056
    v_mfma_f32_16x16x32_bf16 v[72:75], a[0:3], v[136:139], v[72:75]
    ds_read_b64_tr_b16 a[28:29], v7 offset:16896
    s_waitcnt vmcnt(20)
    s_waitcnt lgkmcnt(0)
    v_mfma_f32_16x16x32_bf16 v[76:79], a[4:7], v[136:139], v[76:79]
    s_mov_b32 m0, s54
    s_addk_i32 s92, 14336
    s_cmp_ge_u32 s92, 229376
    s_cselect_b32 s13, 229376, 0
    s_sub_u32 s92, s92, s13
    v_mfma_f32_16x16x32_bf16 v[80:83], a[8:11], v[136:139], v[80:83]
    buffer_load_dwordx4 v148, s[40:43], s92 offen lds
    v_mfma_f32_16x16x32_bf16 v[84:87], a[12:15], v[136:139], v[84:87]
    ds_read_b128 v[136:139], v1 offset:46080
    v_mfma_f32_16x16x32_bf16 v[88:91], a[0:3], v[140:143], v[88:91]
    buffer_load_dwordx4 v148, s[44:47], s92 offen offset:1024 lds
    v_mfma_f32_16x16x32_bf16 v[92:95], a[4:7], v[140:143], v[92:95]
    ds_read_b64_tr_b16 a[18:19], v151 offset:49152
    v_mfma_f32_16x16x32_bf16 v[96:99], a[8:11], v[140:143], v[96:99]
    ds_read_b64_tr_b16 a[22:23], v152 offset:49152
    v_mfma_f32_16x16x32_bf16 v[100:103], a[12:15], v[140:143], v[100:103]
    ds_read_b128 v[140:143], v1 offset:47104
    v_mfma_f32_16x16x32_bf16 v[104:107], a[0:3], v[144:147], v[104:107]
    ds_read_b64_tr_b16 a[26:27], v151 offset:49664
    v_mfma_f32_16x16x32_bf16 v[108:111], a[4:7], v[144:147], v[108:111]
    ds_read_b64_tr_b16 a[30:31], v152 offset:49664
    s_waitcnt vmcnt(20)
    v_mfma_f32_16x16x32_bf16 v[112:115], a[8:11], v[144:147], v[112:115]
    ds_read_b64_tr_b16 a[32:33], v153 offset:0
    v_mfma_f32_16x16x32_bf16 v[116:119], a[12:15], v[144:147], v[116:119]
    ds_read_b128 v[144:147], v1 offset:48128
    s_waitcnt lgkmcnt(2)
    v_mfma_f32_16x16x32_bf16 v[8:11], a[16:19], v[120:123], v[8:11]
    ds_read_b64_tr_b16 a[36:37], v154 offset:0
    s_mov_b32 m0, s65
    s_addk_i32 s92, 14336
    v_mfma_f32_16x16x32_bf16 v[12:15], a[20:23], v[120:123], v[12:15]
    buffer_load_dwordx4 v148, s[40:43], s92 offen lds
    v_mfma_f32_16x16x32_bf16 v[16:19], a[24:27], v[120:123], v[16:19]
    buffer_load_dwordx4 v148, s[44:47], s92 offen offset:1024 lds
    v_mfma_f32_16x16x32_bf16 v[20:23], a[28:31], v[120:123], v[20:23]
    ds_read_b64_tr_b16 a[40:41], v153 offset:512
    v_mfma_f32_16x16x32_bf16 v[24:27], a[16:19], v[124:127], v[24:27]
    ds_read_b64_tr_b16 a[44:45], v154 offset:512
    s_waitcnt vmcnt(20)
    v_mfma_f32_16x16x32_bf16 v[28:31], a[20:23], v[124:127], v[28:31]
    ds_read_b64_tr_b16 a[34:35], v153 offset:8192
    v_mfma_f32_16x16x32_bf16 v[32:35], a[24:27], v[124:127], v[32:35]
    ds_read_b64_tr_b16 a[38:39], v154 offset:8192
    v_mfma_f32_16x16x32_bf16 v[36:39], a[28:31], v[124:127], v[36:39]
    ds_read_b64_tr_b16 a[42:43], v153 offset:8704
    v_mfma_f32_16x16x32_bf16 v[40:43], a[16:19], v[128:131], v[40:43]
    ds_read_b64_tr_b16 a[46:47], v154 offset:8704
    s_waitcnt vmcnt(18)
    v_mfma_f32_16x16x32_bf16 v[44:47], a[20:23], v[128:131], v[44:47]
    ds_read_b64_tr_b16 a[0:1], v149 offset:40960
    v_mfma_f32_16x16x32_bf16 v[48:51], a[24:27], v[128:131], v[48:51]
    ds_read_b64_tr_b16 a[4:5], v150 offset:40960
    v_mfma_f32_16x16x32_bf16 v[52:55], a[28:31], v[128:131], v[52:55]
    ds_read_b64_tr_b16 a[8:9], v149 offset:41472
    s_waitcnt lgkmcnt(7)
    s_mov_b32 m0, s59
    v_mfma_f32_16x16x32_bf16 v[56:59], a[16:19], v[132:135], v[56:59]
    s_addk_i32 s92, 14336
    s_cmp_ge_u32 s92, 229376
    s_cselect_b32 s13, 229376, 0
    s_sub_u32 s92, s92, s13
    v_mfma_f32_16x16x32_bf16 v[60:63], a[20:23], v[132:135], v[60:63]
    buffer_load_dwordx4 v148, s[40:43], s92 offen lds
    v_mfma_f32_16x16x32_bf16 v[64:67], a[24:27], v[132:135], v[64:67]
    buffer_load_dwordx4 v148, s[44:47], s92 offen offset:1024 lds
    v_mfma_f32_16x16x32_bf16 v[68:71], a[28:31], v[132:135], v[68:71]
    ds_read_b64_tr_b16 a[12:13], v150 offset:41472
    s_waitcnt lgkmcnt(4)
    s_mov_b32 m0, s60
    v_mfma_f32_16x16x32_bf16 v[72:75], a[16:19], v[136:139], v[72:75]
    s_addk_i32 s92, 14336
    buffer_load_dwordx4 v148, s[40:43], s92 offen lds
    s_waitcnt vmcnt(19)
    v_mfma_f32_16x16x32_bf16 v[76:79], a[20:23], v[136:139], v[76:79]
    buffer_load_dwordx4 v148, s[44:47], s92 offen offset:1024 lds
    v_mfma_f32_16x16x32_bf16 v[80:83], a[24:27], v[136:139], v[80:83]
    ds_read_b64_tr_b16 a[2:3], v153 offset:16384
    v_mfma_f32_16x16x32_bf16 v[84:87], a[28:31], v[136:139], v[84:87]
    ds_read_b64_tr_b16 a[6:7], v154 offset:16384
    v_mfma_f32_16x16x32_bf16 v[88:91], a[16:19], v[140:143], v[88:91]
    ds_read_b64_tr_b16 a[10:11], v153 offset:16896
    v_mfma_f32_16x16x32_bf16 v[92:95], a[20:23], v[140:143], v[92:95]
    ds_read_b64_tr_b16 a[14:15], v154 offset:16896
    s_waitcnt vmcnt(18)
    v_mfma_f32_16x16x32_bf16 v[96:99], a[24:27], v[140:143], v[96:99]
    ds_read_b64_tr_b16 a[48:49], v153 offset:24576
    s_waitcnt lgkmcnt(5)
    s_mov_b32 m0, s57
    v_mfma_f32_16x16x32_bf16 v[100:103], a[28:31], v[140:143], v[100:103]
    s_addk_i32 s92, 14336
    s_cmp_ge_u32 s92, 229376
    s_cselect_b32 s13, 229376, 0
    s_sub_u32 s92, s92, s13
    v_mfma_f32_16x16x32_bf16 v[104:107], a[16:19], v[144:147], v[104:107]
    buffer_load_dwordx4 v148, s[40:43], s92 offen lds
    v_mfma_f32_16x16x32_bf16 v[108:111], a[20:23], v[144:147], v[108:111]
    buffer_load_dwordx4 v148, s[44:47], s92 offen offset:1024 lds
    v_mfma_f32_16x16x32_bf16 v[112:115], a[24:27], v[144:147], v[112:115]
    ds_read_b64_tr_b16 a[52:53], v154 offset:24576
    v_mfma_f32_16x16x32_bf16 v[116:119], a[28:31], v[144:147], v[116:119]
    ds_read_b64_tr_b16 a[56:57], v153 offset:25088
    ds_read_b128 v[184:187], v2 offset:0
    ds_read_b128 v[188:191], v2 offset:256
    ds_read_b128 v[192:195], v2 offset:512
    ds_read_b128 v[196:199], v2 offset:768
    ds_read_b128 v[200:203], v2 offset:1024
    ds_read_b128 v[204:207], v2 offset:1280
    ds_read_b128 v[208:211], v2 offset:1536
    s_lshl_b32 s3, s66, 1
    s_sub_u32 s3, s3, s5
    s_and_b32 s19, s3, 7
    s_mul_i32 s19, s19, 7168
    s_add_u32 s19, s19, 57344
    v_add_u32 v2, s19, v0
    s_add_u32 s3, s3, 1
    s_and_b32 s19, s3, 7
    s_mul_i32 s19, s19, 7168
    s_add_u32 s19, s19, 57344
    v_add_u32 v3, s19, v0
    v_add_u32 v1, 57344, v0
    s_waitcnt lgkmcnt(6)
    v_add_f32 v184, v184, v185
    v_add_f32 v186, v186, v187
    s_waitcnt lgkmcnt(5)
    v_add_f32 v188, v188, v189
    v_add_f32 v190, v190, v191
    s_waitcnt lgkmcnt(4)
    v_add_f32 v192, v192, v193
    v_add_f32 v194, v194, v195
    s_waitcnt lgkmcnt(3)
    v_add_f32 v196, v196, v197
    v_add_f32 v198, v198, v199
    s_waitcnt lgkmcnt(2)
    v_add_f32 v200, v200, v201
    v_add_f32 v202, v202, v203
    s_waitcnt lgkmcnt(1)
    v_add_f32 v204, v204, v205
    v_add_f32 v206, v206, v207
    s_waitcnt lgkmcnt(0)
    v_add_f32 v208, v208, v209
    v_add_f32 v210, v210, v211
    v_add_f32 v184, v184, v186
    v_add_f32 v188, v188, v190
    v_add_f32 v192, v192, v194
    v_add_f32 v196, v196, v198
    v_add_f32 v200, v200, v202
    v_add_f32 v204, v204, v206
    v_add_f32 v208, v208, v210
    v_rcp_f32 v184, v184
    v_rcp_f32 v188, v188
    v_rcp_f32 v192, v192
    v_rcp_f32 v196, v196
    v_rcp_f32 v200, v200
    v_rcp_f32 v204, v204
    v_rcp_f32 v208, v208
    s_barrier
    s_lshr_b32 s35, s2, 3
    s_and_b32 s34, s35, 1
    s_and_b32 s36, s2, 7
    s_lshl_b32 s36, s36, 1
    s_add_u32 s34, s34, s36
    s_lshr_b32 s36, s35, 1
    s_and_b32 s36, s36, 1
    s_lshr_b32 s35, s35, 2
    s_mul_i32 s37, s36, 40
    s_sub_u32 s0, s0, s37
    s_subb_u32 s1, s1, 0
    s_load_dwordx4 s[8:11], s[0:1], 80
    s_lshl_b32 s32, s36, 3
    s_add_u32 s32, s32, s35
    s_lshl_b32 s32, s32, 4
    s_mul_i32 s33, s35, 200704
    s_mul_i32 s37, s36, 896
    s_add_u32 s33, s33, s37
    v_mov_b32 v156, 161792
    v_mov_b32 v157, 1
    v_mov_b32 v158, s32
    v_mov_b32 v160, 0
    v_mov_b32 v161, 0
    v_mov_b32 v162, 0
    v_mov_b32 v163, 0
    ds_write_b128 v156, v[160:163]
    s_memrealtime s[38:39]
    s_mul_i32 s37, s32, 512
    s_add_u32 s37, s37, 33554432
    v_lshrrev_b32 v166, 4, v0
    v_and_b32 v166, 15, v166
    v_mul_u32_u24 v166, 256, v166
    v_add_u32 v166, s37, v166
    s_mul_i32 s35, s34, 256
    s_add_u32 s37, s37, s35
    v_mov_b32 v167, s37
    v_mul_f32 v8, v8, v184
    v_mul_f32 v9, v9, v184
    v_mul_f32 v10, v10, v184
    v_mul_f32 v11, v11, v184
    v_mul_f32 v12, v12, v184
    v_mul_f32 v13, v13, v184
    v_mul_f32 v14, v14, v184
    v_mul_f32 v15, v15, v184
    v_mul_f32 v16, v16, v184
    v_mul_f32 v17, v17, v184
    v_mul_f32 v18, v18, v184
    v_mul_f32 v19, v19, v184
    v_mul_f32 v20, v20, v184
    v_mul_f32 v21, v21, v184
    v_mul_f32 v22, v22, v184
    v_mul_f32 v23, v23, v184
    ds_read_b64_tr_b16 a[60:61], v154 offset:25088
    s_mov_b32 m0, s61
    s_addk_i32 s92, 14336
    v_cvt_pk_bf16_f32 v212, v8, v9
    v_cvt_pk_bf16_f32 v213, v10, v11
    v_cvt_pk_bf16_f32 v214, v12, v13
    v_cvt_pk_bf16_f32 v215, v14, v15
    ds_write_b128 v2, v[212:215] offset:0
    buffer_load_dwordx4 v148, s[40:43], s92 offen lds
    s_waitcnt vmcnt(19)
    v_cvt_pk_bf16_f32 v216, v16, v17
    v_cvt_pk_bf16_f32 v217, v18, v19
    v_cvt_pk_bf16_f32 v218, v20, v21
    v_cvt_pk_bf16_f32 v219, v22, v23
    ds_write_b128 v3, v[216:219] offset:0
    buffer_load_dwordx4 v148, s[44:47], s92 offen offset:1024 lds
    v_mul_f32 v24, v24, v188
    v_mul_f32 v25, v25, v188
    v_mul_f32 v26, v26, v188
    v_mul_f32 v27, v27, v188
    v_mul_f32 v28, v28, v188
    v_mul_f32 v29, v29, v188
    v_mul_f32 v30, v30, v188
    v_mul_f32 v31, v31, v188
    v_mul_f32 v32, v32, v188
    v_mul_f32 v33, v33, v188
    v_mul_f32 v34, v34, v188
    v_mul_f32 v35, v35, v188
    v_mul_f32 v36, v36, v188
    v_mul_f32 v37, v37, v188
    v_mul_f32 v38, v38, v188
    v_mul_f32 v39, v39, v188
    ds_read_b64_tr_b16 a[50:51], v149 offset:49152
    s_waitcnt lgkmcnt(3)
    s_mov_b32 m0, s62
    v_cvt_pk_bf16_f32 v220, v24, v25
    v_cvt_pk_bf16_f32 v221, v26, v27
    v_cvt_pk_bf16_f32 v222, v28, v29
    v_cvt_pk_bf16_f32 v223, v30, v31
    ds_write_b128 v2, v[220:223] offset:1024
    s_addk_i32 s92, 14464
    s_cmp_ge_u32 s92, 229376
    s_cselect_b32 s13, 229376, 0
    s_sub_u32 s92, s92, s13
    v_cvt_pk_bf16_f32 v224, v32, v33
    v_cvt_pk_bf16_f32 v225, v34, v35
    v_cvt_pk_bf16_f32 v226, v36, v37
    v_cvt_pk_bf16_f32 v227, v38, v39
    ds_write_b128 v3, v[224:227] offset:1024
    buffer_load_dwordx4 v148, s[24:27], s92 offen lds
    v_mul_f32 v40, v40, v192
    v_mul_f32 v41, v41, v192
    v_mul_f32 v42, v42, v192
    v_mul_f32 v43, v43, v192
    v_mul_f32 v44, v44, v192
    v_mul_f32 v45, v45, v192
    v_mul_f32 v46, v46, v192
    v_mul_f32 v47, v47, v192
    v_mul_f32 v48, v48, v192
    v_mul_f32 v49, v49, v192
    v_mul_f32 v50, v50, v192
    v_mul_f32 v51, v51, v192
    v_mul_f32 v52, v52, v192
    v_mul_f32 v53, v53, v192
    v_mul_f32 v54, v54, v192
    v_mul_f32 v55, v55, v192
    buffer_load_dwordx4 v148, s[28:31], s92 offen offset:1024 lds
    v_cvt_pk_bf16_f32 v228, v40, v41
    v_cvt_pk_bf16_f32 v229, v42, v43
    v_cvt_pk_bf16_f32 v230, v44, v45
    v_cvt_pk_bf16_f32 v231, v46, v47
    ds_write_b128 v2, v[228:231] offset:2048
    ds_read_b64_tr_b16 a[54:55], v150 offset:49152
    v_cvt_pk_bf16_f32 v232, v48, v49
    v_cvt_pk_bf16_f32 v233, v50, v51
    v_cvt_pk_bf16_f32 v234, v52, v53
    v_cvt_pk_bf16_f32 v235, v54, v55
    ds_write_b128 v3, v[232:235] offset:2048
    ds_read_b64_tr_b16 a[58:59], v149 offset:49664
    v_mul_f32 v56, v56, v196
    v_mul_f32 v57, v57, v196
    v_mul_f32 v58, v58, v196
    v_mul_f32 v59, v59, v196
    v_mul_f32 v60, v60, v196
    v_mul_f32 v61, v61, v196
    v_mul_f32 v62, v62, v196
    v_mul_f32 v63, v63, v196
    v_mul_f32 v64, v64, v196
    v_mul_f32 v65, v65, v196
    v_mul_f32 v66, v66, v196
    v_mul_f32 v67, v67, v196
    v_mul_f32 v68, v68, v196
    v_mul_f32 v69, v69, v196
    v_mul_f32 v70, v70, v196
    v_mul_f32 v71, v71, v196
    ds_read_b64_tr_b16 a[62:63], v150 offset:49664
    s_waitcnt vmcnt(20)
    v_cvt_pk_bf16_f32 v236, v56, v57
    v_cvt_pk_bf16_f32 v237, v58, v59
    v_cvt_pk_bf16_f32 v238, v60, v61
    v_cvt_pk_bf16_f32 v239, v62, v63
    ds_write_b128 v2, v[236:239] offset:3072
    ds_read_b64_tr_b16 a[16:17], v149 offset:24576
    v_cvt_pk_bf16_f32 v240, v64, v65
    v_cvt_pk_bf16_f32 v241, v66, v67
    v_cvt_pk_bf16_f32 v242, v68, v69
    v_cvt_pk_bf16_f32 v243, v70, v71
    ds_write_b128 v3, v[240:243] offset:3072
    ds_read_b64_tr_b16 a[20:21], v150 offset:24576
    v_mul_f32 v72, v72, v200
    v_mul_f32 v73, v73, v200
    v_mul_f32 v74, v74, v200
    v_mul_f32 v75, v75, v200
    v_mul_f32 v76, v76, v200
    v_mul_f32 v77, v77, v200
    v_mul_f32 v78, v78, v200
    v_mul_f32 v79, v79, v200
    v_mul_f32 v80, v80, v200
    v_mul_f32 v81, v81, v200
    v_mul_f32 v82, v82, v200
    v_mul_f32 v83, v83, v200
    v_mul_f32 v84, v84, v200
    v_mul_f32 v85, v85, v200
    v_mul_f32 v86, v86, v200
    v_mul_f32 v87, v87, v200
    ds_read_b64_tr_b16 a[24:25], v149 offset:25088
    s_waitcnt lgkmcnt(5)
    s_mov_b32 m0, s58
    v_cvt_pk_bf16_f32 v212, v72, v73
    v_cvt_pk_bf16_f32 v213, v74, v75
    v_cvt_pk_bf16_f32 v214, v76, v77
    v_cvt_pk_bf16_f32 v215, v78, v79
    ds_write_b128 v2, v[212:215] offset:4096
    s_addk_i32 s92, 14336
    buffer_load_dwordx4 v148, s[24:27], s92 offen lds
    v_cvt_pk_bf16_f32 v216, v80, v81
    v_cvt_pk_bf16_f32 v217, v82, v83
    v_cvt_pk_bf16_f32 v218, v84, v85
    v_cvt_pk_bf16_f32 v219, v86, v87
    ds_write_b128 v3, v[216:219] offset:4096
    buffer_load_dwordx4 v148, s[28:31], s92 offen offset:1024 lds
    v_mul_f32 v88, v88, v204
    v_mul_f32 v89, v89, v204
    v_mul_f32 v90, v90, v204
    v_mul_f32 v91, v91, v204
    v_mul_f32 v92, v92, v204
    v_mul_f32 v93, v93, v204
    v_mul_f32 v94, v94, v204
    v_mul_f32 v95, v95, v204
    v_mul_f32 v96, v96, v204
    v_mul_f32 v97, v97, v204
    v_mul_f32 v98, v98, v204
    v_mul_f32 v99, v99, v204
    v_mul_f32 v100, v100, v204
    v_mul_f32 v101, v101, v204
    v_mul_f32 v102, v102, v204
    v_mul_f32 v103, v103, v204
    ds_read_b64_tr_b16 a[28:29], v150 offset:25088
    s_waitcnt vmcnt(20)
    v_cvt_pk_bf16_f32 v220, v88, v89
    v_cvt_pk_bf16_f32 v221, v90, v91
    v_cvt_pk_bf16_f32 v222, v92, v93
    v_cvt_pk_bf16_f32 v223, v94, v95
    ds_write_b128 v2, v[220:223] offset:5120
    ds_read_b64_tr_b16 a[18:19], v153 offset:32768
    v_cvt_pk_bf16_f32 v224, v96, v97
    v_cvt_pk_bf16_f32 v225, v98, v99
    v_cvt_pk_bf16_f32 v226, v100, v101
    v_cvt_pk_bf16_f32 v227, v102, v103
    ds_write_b128 v3, v[224:227] offset:5120
    ds_read_b64_tr_b16 a[22:23], v154 offset:32768
    v_mul_f32 v104, v104, v208
    v_mul_f32 v105, v105, v208
    v_mul_f32 v106, v106, v208
    v_mul_f32 v107, v107, v208
    v_mul_f32 v108, v108, v208
    v_mul_f32 v109, v109, v208
    v_mul_f32 v110, v110, v208
    v_mul_f32 v111, v111, v208
    v_mul_f32 v112, v112, v208
    v_mul_f32 v113, v113, v208
    v_mul_f32 v114, v114, v208
    v_mul_f32 v115, v115, v208
    v_mul_f32 v116, v116, v208
    v_mul_f32 v117, v117, v208
    v_mul_f32 v118, v118, v208
    v_mul_f32 v119, v119, v208
    ds_read_b64_tr_b16 a[26:27], v153 offset:33280
    s_waitcnt lgkmcnt(5)
    s_mov_b32 m0, s55
    v_cvt_pk_bf16_f32 v228, v104, v105
    v_cvt_pk_bf16_f32 v229, v106, v107
    v_cvt_pk_bf16_f32 v230, v108, v109
    v_cvt_pk_bf16_f32 v231, v110, v111
    ds_write_b128 v2, v[228:231] offset:6144
    s_addk_i32 s92, 14336
    s_cmp_ge_u32 s92, 229376
    s_cselect_b32 s13, 229376, 0
    s_sub_u32 s92, s92, s13
    v_cvt_pk_bf16_f32 v232, v112, v113
    v_cvt_pk_bf16_f32 v233, v114, v115
    v_cvt_pk_bf16_f32 v234, v116, v117
    v_cvt_pk_bf16_f32 v235, v118, v119
    ds_write_b128 v3, v[232:235] offset:6144
    buffer_load_dwordx4 v148, s[24:27], s92 offen lds
    s_waitcnt lgkmcnt(0)
    s_barrier
    s_cmp_eq_u32 s34, 0
    s_cselect_b32 s3, s66, 0
    s_cmp_eq_u32 s3, 3
    s_cbranch_scc0 L_nonce
    s_bitset1_b32 s39, 31
    v_mov_b32 v160, s38
    v_mov_b32 v161, s39
    s_mov_b64 exec, 1
    global_atomic_cmpswap_x2 v158, v[160:163], s[10:11]
    s_mov_b64 exec, -1
L_nonce:
    ds_read_b128 v[120:123], v1 offset:0
    ds_read_b128 v[124:127], v1 offset:1024
    ds_read_b128 v[128:131], v1 offset:2048
    ds_read_b128 v[132:135], v1 offset:3072
    ds_read_b128 v[136:139], v1 offset:4096
    ds_read_b128 v[140:143], v1 offset:5120
    ds_read_b128 v[144:147], v1 offset:6144
    s_waitcnt lgkmcnt(6)
    v_mfma_f32_16x16x32_bf16 v[8:11], a[32:35], v[120:123], 0
    buffer_load_dwordx4 v148, s[28:31], s92 offen offset:1024 lds
    v_mfma_f32_16x16x32_bf16 v[12:15], a[36:39], v[120:123], 0
    ds_read_b64_tr_b16 a[30:31], v154 offset:33280
    s_waitcnt vmcnt(20)
    v_mfma_f32_16x16x32_bf16 v[16:19], a[40:43], v[120:123], 0
    ds_read_b64_tr_b16 a[64:65], v153 offset:40960
    v_mfma_f32_16x16x32_bf16 v[20:23], a[44:47], v[120:123], 0
    ds_read_b128 v[120:123], v1 offset:7168
    s_waitcnt lgkmcnt(8)
    v_mfma_f32_16x16x32_bf16 v[24:27], a[32:35], v[124:127], 0
    ds_read_b64_tr_b16 a[68:69], v154 offset:40960
    v_mfma_f32_16x16x32_bf16 v[28:31], a[36:39], v[124:127], 0
    ds_read_b64_tr_b16 a[72:73], v153 offset:41472
    v_mfma_f32_16x16x32_bf16 v[32:35], a[40:43], v[124:127], 0
    ds_read_b64_tr_b16 a[76:77], v154 offset:41472
    s_waitcnt vmcnt(18)
    v_mfma_f32_16x16x32_bf16 v[36:39], a[44:47], v[124:127], 0
    ds_read_b128 v[124:127], v1 offset:8192
    s_waitcnt lgkmcnt(11)
    v_mfma_f32_16x16x32_bf16 v[40:43], a[32:35], v[128:131], 0
    ds_read_b64_tr_b16 a[66:67], v149 offset:32768
    s_waitcnt lgkmcnt(7)
    s_mov_b32 m0, s63
    v_mfma_f32_16x16x32_bf16 v[44:47], a[36:39], v[128:131], 0
    s_addk_i32 s92, 14336
    buffer_load_dwordx4 v148, s[24:27], s92 offen lds
    v_mfma_f32_16x16x32_bf16 v[48:51], a[40:43], v[128:131], 0
    buffer_load_dwordx4 v148, s[28:31], s92 offen offset:1024 lds
    v_mfma_f32_16x16x32_bf16 v[52:55], a[44:47], v[128:131], 0
    ds_read_b128 v[128:131], v1 offset:9216
    v_mfma_f32_16x16x32_bf16 v[56:59], a[32:35], v[132:135], 0
    ds_read_b64_tr_b16 a[70:71], v150 offset:32768
    v_mfma_f32_16x16x32_bf16 v[60:63], a[36:39], v[132:135], 0
    ds_read_b64_tr_b16 a[74:75], v149 offset:33280
    s_waitcnt lgkmcnt(5)
    s_mov_b32 m0, s64
    v_mfma_f32_16x16x32_bf16 v[64:67], a[40:43], v[132:135], 0
    s_addk_i32 s92, 14336
    s_cmp_ge_u32 s92, 229376
    s_cselect_b32 s13, 229376, 0
    s_sub_u32 s92, s92, s13
    v_mfma_f32_16x16x32_bf16 v[68:71], a[44:47], v[132:135], 0
    ds_read_b128 v[132:135], v1 offset:10240
    v_mfma_f32_16x16x32_bf16 v[72:75], a[32:35], v[136:139], 0
    buffer_load_dwordx4 v148, s[24:27], s92 offen lds
    v_mfma_f32_16x16x32_bf16 v[76:79], a[36:39], v[136:139], 0
    buffer_load_dwordx4 v148, s[28:31], s92 offen offset:1024 lds
    v_mfma_f32_16x16x32_bf16 v[80:83], a[40:43], v[136:139], 0
    ds_read_b64_tr_b16 a[78:79], v150 offset:33280
    s_waitcnt vmcnt(20)
    v_mfma_f32_16x16x32_bf16 v[84:87], a[44:47], v[136:139], 0
    ds_read_b128 v[136:139], v1 offset:11264
    v_mfma_f32_16x16x32_bf16 v[88:91], a[32:35], v[140:143], 0
    ds_read_b64_tr_b16 a[80:81], v149 offset:16384
    v_mfma_f32_16x16x32_bf16 v[92:95], a[36:39], v[140:143], 0
    ds_read_b64_tr_b16 a[84:85], v150 offset:16384
    v_mfma_f32_16x16x32_bf16 v[96:99], a[40:43], v[140:143], 0
    ds_read_b64_tr_b16 a[88:89], v149 offset:16896
    v_mfma_f32_16x16x32_bf16 v[100:103], a[44:47], v[140:143], 0
    ds_read_b128 v[140:143], v1 offset:12288
    v_mfma_f32_16x16x32_bf16 v[104:107], a[32:35], v[144:147], 0
    ds_read_b64_tr_b16 a[92:93], v150 offset:16896
    s_waitcnt vmcnt(18)
    v_mfma_f32_16x16x32_bf16 v[108:111], a[36:39], v[144:147], 0
    ds_read_b64_tr_b16 a[82:83], v153 offset:49152
    s_waitcnt lgkmcnt(7)
    s_mov_b32 m0, s56
    v_mfma_f32_16x16x32_bf16 v[112:115], a[40:43], v[144:147], 0
    s_addk_i32 s92, 14336
    buffer_load_dwordx4 v148, s[24:27], s92 offen lds
    v_mfma_f32_16x16x32_bf16 v[116:119], a[44:47], v[144:147], 0
    ds_read_b128 v[144:147], v1 offset:13312
    v_mfma_f32_16x16x32_bf16 v[8:11], a[0:3], v[120:123], v[8:11]
    buffer_load_dwordx4 v148, s[28:31], s92 offen offset:1024 lds
    v_mfma_f32_16x16x32_bf16 v[12:15], a[4:7], v[120:123], v[12:15]
    ds_read_b64_tr_b16 a[86:87], v154 offset:49152
    v_mfma_f32_16x16x32_bf16 v[16:19], a[8:11], v[120:123], v[16:19]
    ds_read_b64_tr_b16 a[90:91], v153 offset:49664
    v_mfma_f32_16x16x32_bf16 v[20:23], a[12:15], v[120:123], v[20:23]
    ds_read_b128 v[120:123], v1 offset:14336
    s_waitcnt lgkmcnt(5)
    s_mov_b32 m0, s54
    v_mfma_f32_16x16x32_bf16 v[24:27], a[0:3], v[124:127], v[24:27]
    s_addk_i32 s92, 14336
    s_cmp_ge_u32 s92, 229376
    s_cselect_b32 s13, 229376, 0
    s_sub_u32 s92, s92, s13
    v_mfma_f32_16x16x32_bf16 v[28:31], a[4:7], v[124:127], v[28:31]
    buffer_load_dwordx4 v148, s[24:27], s92 offen lds
    v_mfma_f32_16x16x32_bf16 v[32:35], a[8:11], v[124:127], v[32:35]
    buffer_load_dwordx4 v148, s[28:31], s92 offen offset:1024 lds
    v_mfma_f32_16x16x32_bf16 v[36:39], a[12:15], v[124:127], v[36:39]
    ds_read_b128 v[124:127], v1 offset:15360
    v_mfma_f32_16x16x32_bf16 v[40:43], a[0:3], v[128:131], v[40:43]
    ds_read_b64_tr_b16 a[94:95], v154 offset:49664
    s_waitcnt vmcnt(20)
    v_mfma_f32_16x16x32_bf16 v[44:47], a[4:7], v[128:131], v[44:47]
    ds_read_b64_tr_b16 a[32:33], v153 offset:0
    v_mfma_f32_16x16x32_bf16 v[48:51], a[8:11], v[128:131], v[48:51]
    ds_read_b64_tr_b16 a[36:37], v154 offset:0
    v_mfma_f32_16x16x32_bf16 v[52:55], a[12:15], v[128:131], v[52:55]
    ds_read_b128 v[128:131], v1 offset:16384
    v_mfma_f32_16x16x32_bf16 v[56:59], a[0:3], v[132:135], v[56:59]
    ds_read_b64_tr_b16 a[40:41], v153 offset:512
    v_mfma_f32_16x16x32_bf16 v[60:63], a[4:7], v[132:135], v[60:63]
    ds_read_b64_tr_b16 a[44:45], v154 offset:512
    s_waitcnt vmcnt(18)
    v_mfma_f32_16x16x32_bf16 v[64:67], a[8:11], v[132:135], v[64:67]
    ds_read_b64_tr_b16 a[34:35], v153 offset:8192
    v_mfma_f32_16x16x32_bf16 v[68:71], a[12:15], v[132:135], v[68:71]
    ds_read_b128 v[132:135], v1 offset:17408
    s_waitcnt lgkmcnt(7)
    s_mov_b32 m0, s65
    v_mfma_f32_16x16x32_bf16 v[72:75], a[0:3], v[136:139], v[72:75]
    s_addk_i32 s92, 14336
    buffer_load_dwordx4 v148, s[24:27], s92 offen lds
    v_mfma_f32_16x16x32_bf16 v[76:79], a[4:7], v[136:139], v[76:79]
    buffer_load_dwordx4 v148, s[28:31], s92 offen offset:1024 lds
    v_mfma_f32_16x16x32_bf16 v[80:83], a[8:11], v[136:139], v[80:83]
    ds_read_b64_tr_b16 a[38:39], v154 offset:8192
    v_mfma_f32_16x16x32_bf16 v[84:87], a[12:15], v[136:139], v[84:87]
    ds_read_b128 v[136:139], v1 offset:18432
    v_mfma_f32_16x16x32_bf16 v[88:91], a[0:3], v[140:143], v[88:91]
    ds_read_b64_tr_b16 a[42:43], v153 offset:8704
    s_waitcnt lgkmcnt(5)
    s_mov_b32 m0, s59
    v_mfma_f32_16x16x32_bf16 v[92:95], a[4:7], v[140:143], v[92:95]
    s_addk_i32 s92, 14336
    s_cmp_ge_u32 s92, 229376
    s_cselect_b32 s13, 229376, 0
    s_sub_u32 s92, s92, s13
    v_mfma_f32_16x16x32_bf16 v[96:99], a[8:11], v[140:143], v[96:99]
    buffer_load_dwordx4 v148, s[24:27], s92 offen lds
    v_mfma_f32_16x16x32_bf16 v[100:103], a[12:15], v[140:143], v[100:103]
    ds_read_b128 v[140:143], v1 offset:19456
    v_mfma_f32_16x16x32_bf16 v[104:107], a[0:3], v[144:147], v[104:107]
    buffer_load_dwordx4 v148, s[28:31], s92 offen offset:1024 lds
    v_mfma_f32_16x16x32_bf16 v[108:111], a[4:7], v[144:147], v[108:111]
    ds_read_b64_tr_b16 a[46:47], v154 offset:8704
    s_waitcnt vmcnt(20)
    v_mfma_f32_16x16x32_bf16 v[112:115], a[8:11], v[144:147], v[112:115]
    ds_read_b64_tr_b16 a[96:97], v149 offset:40960
    v_mfma_f32_16x16x32_bf16 v[116:119], a[12:15], v[144:147], v[116:119]
    ds_read_b128 v[144:147], v1 offset:20480
    v_mfma_f32_16x16x32_bf16 v[8:11], a[48:51], v[120:123], v[8:11]
    ds_read_b64_tr_b16 a[100:101], v150 offset:40960
    v_mfma_f32_16x16x32_bf16 v[12:15], a[52:55], v[120:123], v[12:15]
    ds_read_b64_tr_b16 a[104:105], v149 offset:41472
    v_mfma_f32_16x16x32_bf16 v[16:19], a[56:59], v[120:123], v[16:19]
    ds_read_b64_tr_b16 a[108:109], v150 offset:41472
    s_waitcnt vmcnt(18)
    v_mfma_f32_16x16x32_bf16 v[20:23], a[60:63], v[120:123], v[20:23]
    ds_read_b128 v[120:123], v1 offset:21504
    v_mfma_f32_16x16x32_bf16 v[24:27], a[48:51], v[124:127], v[24:27]
    ds_read_b64_tr_b16 a[98:99], v153 offset:16384
    s_waitcnt lgkmcnt(7)
    s_mov_b32 m0, s60
    v_mfma_f32_16x16x32_bf16 v[28:31], a[52:55], v[124:127], v[28:31]
    s_addk_i32 s92, 14336
    buffer_load_dwordx4 v148, s[24:27], s92 offen lds
    v_mfma_f32_16x16x32_bf16 v[32:35], a[56:59], v[124:127], v[32:35]
    buffer_load_dwordx4 v148, s[28:31], s92 offen offset:1024 lds
    v_mfma_f32_16x16x32_bf16 v[36:39], a[60:63], v[124:127], v[36:39]
    ds_read_b128 v[124:127], v1 offset:22528
    v_mfma_f32_16x16x32_bf16 v[40:43], a[48:51], v[128:131], v[40:43]
    ds_read_b64_tr_b16 a[102:103], v154 offset:16384
    v_mfma_f32_16x16x32_bf16 v[44:47], a[52:55], v[128:131], v[44:47]
    ds_read_b64_tr_b16 a[106:107], v153 offset:16896
    s_waitcnt lgkmcnt(5)
    s_mov_b32 m0, s57
    v_mfma_f32_16x16x32_bf16 v[48:51], a[56:59], v[128:131], v[48:51]
    s_addk_i32 s92, 14336
    s_cmp_ge_u32 s92, 229376
    s_cselect_b32 s13, 229376, 0
    s_sub_u32 s92, s92, s13
    v_mfma_f32_16x16x32_bf16 v[52:55], a[60:63], v[128:131], v[52:55]
    ds_read_b128 v[128:131], v1 offset:23552
    v_mfma_f32_16x16x32_bf16 v[56:59], a[48:51], v[132:135], v[56:59]
    buffer_load_dwordx4 v148, s[24:27], s92 offen lds
    v_mfma_f32_16x16x32_bf16 v[60:63], a[52:55], v[132:135], v[60:63]
    buffer_load_dwordx4 v148, s[28:31], s92 offen offset:1024 lds
    v_mfma_f32_16x16x32_bf16 v[64:67], a[56:59], v[132:135], v[64:67]
    ds_read_b64_tr_b16 a[110:111], v154 offset:16896
    s_waitcnt vmcnt(20)
    v_mfma_f32_16x16x32_bf16 v[68:71], a[60:63], v[132:135], v[68:71]
    ds_read_b128 v[132:135], v1 offset:24576
    v_mfma_f32_16x16x32_bf16 v[72:75], a[48:51], v[136:139], v[72:75]
    ds_read_b64_tr_b16 a[0:1], v153 offset:24576
    v_mfma_f32_16x16x32_bf16 v[76:79], a[52:55], v[136:139], v[76:79]
    ds_read_b64_tr_b16 a[4:5], v154 offset:24576
    v_mfma_f32_16x16x32_bf16 v[80:83], a[56:59], v[136:139], v[80:83]
    ds_read_b64_tr_b16 a[8:9], v153 offset:25088
    v_mfma_f32_16x16x32_bf16 v[84:87], a[60:63], v[136:139], v[84:87]
    ds_read_b128 v[136:139], v1 offset:25600
    v_mfma_f32_16x16x32_bf16 v[88:91], a[48:51], v[140:143], v[88:91]
    ds_read_b64_tr_b16 a[12:13], v154 offset:25088
    s_waitcnt vmcnt(18)
    v_mfma_f32_16x16x32_bf16 v[92:95], a[52:55], v[140:143], v[92:95]
    ds_read_b64_tr_b16 a[2:3], v149 offset:49152
    s_waitcnt lgkmcnt(7)
    s_mov_b32 m0, s61
    v_mfma_f32_16x16x32_bf16 v[96:99], a[56:59], v[140:143], v[96:99]
    s_addk_i32 s92, 14336
    buffer_load_dwordx4 v148, s[24:27], s92 offen lds
    v_mfma_f32_16x16x32_bf16 v[100:103], a[60:63], v[140:143], v[100:103]
    ds_read_b128 v[140:143], v1 offset:26624
    v_mfma_f32_16x16x32_bf16 v[104:107], a[48:51], v[144:147], v[104:107]
    buffer_load_dwordx4 v148, s[28:31], s92 offen offset:1024 lds
    v_mfma_f32_16x16x32_bf16 v[108:111], a[52:55], v[144:147], v[108:111]
    ds_read_b64_tr_b16 a[6:7], v150 offset:49152
    v_mfma_f32_16x16x32_bf16 v[112:115], a[56:59], v[144:147], v[112:115]
    ds_read_b64_tr_b16 a[10:11], v149 offset:49664
    v_mfma_f32_16x16x32_bf16 v[116:119], a[60:63], v[144:147], v[116:119]
    ds_read_b128 v[144:147], v1 offset:27648
    s_waitcnt lgkmcnt(5)
    s_mov_b32 m0, s62
    v_mfma_f32_16x16x32_bf16 v[8:11], a[16:19], v[120:123], v[8:11]
    s_addk_i32 s92, 14336
    s_cmp_ge_u32 s92, 229376
    s_cselect_b32 s13, 229376, 0
    s_sub_u32 s92, s92, s13
    v_mfma_f32_16x16x32_bf16 v[12:15], a[20:23], v[120:123], v[12:15]
    buffer_load_dwordx4 v148, s[24:27], s92 offen lds
    v_mfma_f32_16x16x32_bf16 v[16:19], a[24:27], v[120:123], v[16:19]
    buffer_load_dwordx4 v148, s[28:31], s92 offen offset:1024 lds
    v_mfma_f32_16x16x32_bf16 v[20:23], a[28:31], v[120:123], v[20:23]
    ds_read_b128 v[120:123], v1 offset:28672
    v_mfma_f32_16x16x32_bf16 v[24:27], a[16:19], v[124:127], v[24:27]
    ds_read_b64_tr_b16 a[14:15], v150 offset:49664
    s_waitcnt vmcnt(20)
    v_mfma_f32_16x16x32_bf16 v[28:31], a[20:23], v[124:127], v[28:31]
    ds_read_b64_tr_b16 a[48:49], v149 offset:24576
    v_mfma_f32_16x16x32_bf16 v[32:35], a[24:27], v[124:127], v[32:35]
    ds_read_b64_tr_b16 a[52:53], v150 offset:24576
    v_mfma_f32_16x16x32_bf16 v[36:39], a[28:31], v[124:127], v[36:39]
    ds_read_b128 v[124:127], v1 offset:29696
    v_mfma_f32_16x16x32_bf16 v[40:43], a[16:19], v[128:131], v[40:43]
    ds_read_b64_tr_b16 a[56:57], v149 offset:25088
    v_mfma_f32_16x16x32_bf16 v[44:47], a[20:23], v[128:131], v[44:47]
    ds_read_b64_tr_b16 a[60:61], v150 offset:25088
    s_waitcnt vmcnt(18)
    v_mfma_f32_16x16x32_bf16 v[48:51], a[24:27], v[128:131], v[48:51]
    ds_read_b64_tr_b16 a[50:51], v153 offset:32768
    v_mfma_f32_16x16x32_bf16 v[52:55], a[28:31], v[128:131], v[52:55]
    ds_read_b128 v[128:131], v1 offset:30720
    s_waitcnt lgkmcnt(7)
    s_mov_b32 m0, s58
    v_mfma_f32_16x16x32_bf16 v[56:59], a[16:19], v[132:135], v[56:59]
    s_addk_i32 s92, 14336
    buffer_load_dwordx4 v148, s[24:27], s92 offen lds
    v_mfma_f32_16x16x32_bf16 v[60:63], a[20:23], v[132:135], v[60:63]
    buffer_load_dwordx4 v148, s[28:31], s92 offen offset:1024 lds
    v_mfma_f32_16x16x32_bf16 v[64:67], a[24:27], v[132:135], v[64:67]
    ds_read_b64_tr_b16 a[54:55], v154 offset:32768
    v_mfma_f32_16x16x32_bf16 v[68:71], a[28:31], v[132:135], v[68:71]
    ds_read_b128 v[132:135], v1 offset:31744
    v_mfma_f32_16x16x32_bf16 v[72:75], a[16:19], v[136:139], v[72:75]
    ds_read_b64_tr_b16 a[58:59], v153 offset:33280
    s_waitcnt lgkmcnt(5)
    s_mov_b32 m0, s55
    v_mfma_f32_16x16x32_bf16 v[76:79], a[20:23], v[136:139], v[76:79]
    s_addk_i32 s92, 14336
    s_cmp_ge_u32 s92, 229376
    s_cselect_b32 s13, 229376, 0
    s_sub_u32 s92, s92, s13
    v_mfma_f32_16x16x32_bf16 v[80:83], a[24:27], v[136:139], v[80:83]
    buffer_load_dwordx4 v148, s[24:27], s92 offen lds
    v_mfma_f32_16x16x32_bf16 v[84:87], a[28:31], v[136:139], v[84:87]
    ds_read_b128 v[136:139], v1 offset:32768
    v_mfma_f32_16x16x32_bf16 v[88:91], a[16:19], v[140:143], v[88:91]
    buffer_load_dwordx4 v148, s[28:31], s92 offen offset:1024 lds
    v_mfma_f32_16x16x32_bf16 v[92:95], a[20:23], v[140:143], v[92:95]
    ds_read_b64_tr_b16 a[62:63], v154 offset:33280
    s_waitcnt vmcnt(20)
    v_mfma_f32_16x16x32_bf16 v[96:99], a[24:27], v[140:143], v[96:99]
    ds_read_b64_tr_b16 a[112:113], v153 offset:40960
    v_mfma_f32_16x16x32_bf16 v[100:103], a[28:31], v[140:143], v[100:103]
    ds_read_b128 v[140:143], v1 offset:33792
    v_mfma_f32_16x16x32_bf16 v[104:107], a[16:19], v[144:147], v[104:107]
    ds_read_b64_tr_b16 a[116:117], v154 offset:40960
    v_mfma_f32_16x16x32_bf16 v[108:111], a[20:23], v[144:147], v[108:111]
    ds_read_b64_tr_b16 a[120:121], v153 offset:41472
    v_mfma_f32_16x16x32_bf16 v[112:115], a[24:27], v[144:147], v[112:115]
    ds_read_b64_tr_b16 a[124:125], v154 offset:41472
    s_waitcnt vmcnt(18)
    v_mfma_f32_16x16x32_bf16 v[116:119], a[28:31], v[144:147], v[116:119]
    ds_read_b128 v[144:147], v1 offset:34816
    v_mfma_f32_16x16x32_bf16 v[8:11], a[64:67], v[120:123], v[8:11]
    ds_read_b64_tr_b16 a[114:115], v149 offset:32768
    s_waitcnt lgkmcnt(7)
    s_mov_b32 m0, s63
    v_mfma_f32_16x16x32_bf16 v[12:15], a[68:71], v[120:123], v[12:15]
    s_addk_i32 s92, 14336
    buffer_load_dwordx4 v148, s[24:27], s92 offen lds
    v_mfma_f32_16x16x32_bf16 v[16:19], a[72:75], v[120:123], v[16:19]
    buffer_load_dwordx4 v148, s[28:31], s92 offen offset:1024 lds
    v_mfma_f32_16x16x32_bf16 v[20:23], a[76:79], v[120:123], v[20:23]
    ds_read_b128 v[120:123], v1 offset:35840
    v_mfma_f32_16x16x32_bf16 v[24:27], a[64:67], v[124:127], v[24:27]
    ds_read_b64_tr_b16 a[118:119], v150 offset:32768
    v_mfma_f32_16x16x32_bf16 v[28:31], a[68:71], v[124:127], v[28:31]
    ds_read_b64_tr_b16 a[122:123], v149 offset:33280
    v_mfma_f32_16x16x32_bf16 v[32:35], a[72:75], v[124:127], v[32:35]
    ds_read_b64_tr_b16 a[126:127], v150 offset:33280
    s_waitcnt vmcnt(18)
    v_mfma_f32_16x16x32_bf16 v[36:39], a[76:79], v[124:127], v[36:39]
    ds_read_b128 v[124:127], v1 offset:36864
    v_mfma_f32_16x16x32_bf16 v[40:43], a[64:67], v[128:131], v[40:43]
    ds_read_b64_tr_b16 a[16:17], v149 offset:16384
    v_mfma_f32_16x16x32_bf16 v[44:47], a[68:71], v[128:131], v[44:47]
    ds_read_b64_tr_b16 a[20:21], v150 offset:16384
    v_mfma_f32_16x16x32_bf16 v[48:51], a[72:75], v[128:131], v[48:51]
    ds_read_b64_tr_b16 a[24:25], v149 offset:16896
    v_mfma_f32_16x16x32_bf16 v[52:55], a[76:79], v[128:131], v[52:55]
    ds_read_b128 v[128:131], v1 offset:37888
    v_mfma_f32_16x16x32_bf16 v[56:59], a[64:67], v[132:135], v[56:59]
    ds_read_b64_tr_b16 a[28:29], v150 offset:16896
    s_waitcnt vmcnt(16)
    v_mfma_f32_16x16x32_bf16 v[60:63], a[68:71], v[132:135], v[60:63]
    ds_read_b64_tr_b16 a[18:19], v153 offset:49152
    v_mfma_f32_16x16x32_bf16 v[64:67], a[72:75], v[132:135], v[64:67]
    ds_read_b64_tr_b16 a[22:23], v154 offset:49152
    v_mfma_f32_16x16x32_bf16 v[68:71], a[76:79], v[132:135], v[68:71]
    ds_read_b128 v[132:135], v1 offset:38912
    v_mfma_f32_16x16x32_bf16 v[72:75], a[64:67], v[136:139], v[72:75]
    ds_read_b64_tr_b16 a[26:27], v153 offset:49664
    v_mfma_f32_16x16x32_bf16 v[76:79], a[68:71], v[136:139], v[76:79]
    ds_read_b64_tr_b16 a[30:31], v154 offset:49664
    s_waitcnt vmcnt(14)
    v_mfma_f32_16x16x32_bf16 v[80:83], a[72:75], v[136:139], v[80:83]
    ds_read_b64_tr_b16 a[128:129], v153 offset:0
    v_mfma_f32_16x16x32_bf16 v[84:87], a[76:79], v[136:139], v[84:87]
    ds_read_b128 v[136:139], v1 offset:39936
    s_waitcnt lgkmcnt(10)
    v_mfma_f32_16x16x32_bf16 v[88:91], a[64:67], v[140:143], v[88:91]
    ds_read_b64_tr_b16 a[132:133], v154 offset:0
    v_mfma_f32_16x16x32_bf16 v[92:95], a[68:71], v[140:143], v[92:95]
    ds_read_b64_tr_b16 a[136:137], v153 offset:512
    v_mfma_f32_16x16x32_bf16 v[96:99], a[72:75], v[140:143], v[96:99]
    ds_read_b64_tr_b16 a[140:141], v154 offset:512
    s_waitcnt vmcnt(12)
    v_mfma_f32_16x16x32_bf16 v[100:103], a[76:79], v[140:143], v[100:103]
    ds_read_b128 v[140:143], v1 offset:40960
    v_mfma_f32_16x16x32_bf16 v[104:107], a[64:67], v[144:147], v[104:107]
    ds_read_b64_tr_b16 a[130:131], v153 offset:8192
    v_mfma_f32_16x16x32_bf16 v[108:111], a[68:71], v[144:147], v[108:111]
    ds_read_b64_tr_b16 a[134:135], v154 offset:8192
    v_mfma_f32_16x16x32_bf16 v[112:115], a[72:75], v[144:147], v[112:115]
    ds_read_b64_tr_b16 a[138:139], v153 offset:8704
    v_mfma_f32_16x16x32_bf16 v[116:119], a[76:79], v[144:147], v[116:119]
    ds_read_b128 v[144:147], v1 offset:41984
    v_mfma_f32_16x16x32_bf16 v[8:11], a[80:83], v[120:123], v[8:11]
    ds_read_b64_tr_b16 a[142:143], v154 offset:8704
    s_waitcnt vmcnt(10)
    v_mfma_f32_16x16x32_bf16 v[12:15], a[84:87], v[120:123], v[12:15]
    ds_read_b64_tr_b16 a[64:65], v149 offset:40960
    v_mfma_f32_16x16x32_bf16 v[16:19], a[88:91], v[120:123], v[16:19]
    ds_read_b64_tr_b16 a[68:69], v150 offset:40960
    v_mfma_f32_16x16x32_bf16 v[20:23], a[92:95], v[120:123], v[20:23]
    ds_read_b128 v[120:123], v1 offset:43008
    v_mfma_f32_16x16x32_bf16 v[24:27], a[80:83], v[124:127], v[24:27]
    ds_read_b64_tr_b16 a[72:73], v149 offset:41472
    v_mfma_f32_16x16x32_bf16 v[28:31], a[84:87], v[124:127], v[28:31]
    ds_read_b64_tr_b16 a[76:77], v150 offset:41472
    s_waitcnt vmcnt(8)
    v_mfma_f32_16x16x32_bf16 v[32:35], a[88:91], v[124:127], v[32:35]
    ds_read_b64_tr_b16 a[66:67], v153 offset:16384
    v_mfma_f32_16x16x32_bf16 v[36:39], a[92:95], v[124:127], v[36:39]
    ds_read_b128 v[124:127], v1 offset:44032
    s_waitcnt lgkmcnt(10)
    v_mfma_f32_16x16x32_bf16 v[40:43], a[80:83], v[128:131], v[40:43]
    ds_read_b64_tr_b16 a[70:71], v154 offset:16384
    v_mfma_f32_16x16x32_bf16 v[44:47], a[84:87], v[128:131], v[44:47]
    ds_read_b64_tr_b16 a[74:75], v153 offset:16896
    v_mfma_f32_16x16x32_bf16 v[48:51], a[88:91], v[128:131], v[48:51]
    ds_read_b64_tr_b16 a[78:79], v154 offset:16896
    s_waitcnt vmcnt(6)
    v_mfma_f32_16x16x32_bf16 v[52:55], a[92:95], v[128:131], v[52:55]
    ds_read_b128 v[128:131], v1 offset:45056
    v_mfma_f32_16x16x32_bf16 v[56:59], a[80:83], v[132:135], v[56:59]
    ds_read_b64_tr_b16 a[144:145], v153 offset:24576
    v_mfma_f32_16x16x32_bf16 v[60:63], a[84:87], v[132:135], v[60:63]
    ds_read_b64_tr_b16 a[148:149], v154 offset:24576
    v_mfma_f32_16x16x32_bf16 v[64:67], a[88:91], v[132:135], v[64:67]
    ds_read_b64_tr_b16 a[152:153], v153 offset:25088
    v_mfma_f32_16x16x32_bf16 v[68:71], a[92:95], v[132:135], v[68:71]
    ds_read_b128 v[132:135], v1 offset:46080
    v_mfma_f32_16x16x32_bf16 v[72:75], a[80:83], v[136:139], v[72:75]
    ds_read_b64_tr_b16 a[156:157], v154 offset:25088
    v_mfma_f32_16x16x32_bf16 v[76:79], a[84:87], v[136:139], v[76:79]
    v_mfma_f32_16x16x32_bf16 v[80:83], a[88:91], v[136:139], v[80:83]
    v_mfma_f32_16x16x32_bf16 v[84:87], a[92:95], v[136:139], v[84:87]
    ds_read_b128 v[136:139], v1 offset:47104
    v_mfma_f32_16x16x32_bf16 v[88:91], a[80:83], v[140:143], v[88:91]
    s_waitcnt vmcnt(4)
    ds_read_b64_tr_b16 a[146:147], v149 offset:49152
    v_mfma_f32_16x16x32_bf16 v[92:95], a[84:87], v[140:143], v[92:95]
    ds_read_b64_tr_b16 a[150:151], v150 offset:49152
    v_mfma_f32_16x16x32_bf16 v[96:99], a[88:91], v[140:143], v[96:99]
    ds_read_b64_tr_b16 a[154:155], v149 offset:49664
    v_mfma_f32_16x16x32_bf16 v[100:103], a[92:95], v[140:143], v[100:103]
    ds_read_b128 v[140:143], v1 offset:48128
    s_waitcnt lgkmcnt(8)
    v_mfma_f32_16x16x32_bf16 v[104:107], a[80:83], v[144:147], v[104:107]
    ds_read_b64_tr_b16 a[158:159], v150 offset:49664
    v_mfma_f32_16x16x32_bf16 v[108:111], a[84:87], v[144:147], v[108:111]
    v_mfma_f32_16x16x32_bf16 v[112:115], a[88:91], v[144:147], v[112:115]
    v_mfma_f32_16x16x32_bf16 v[116:119], a[92:95], v[144:147], v[116:119]
    ds_read_b128 v[144:147], v1 offset:49152
    s_waitcnt vmcnt(2)
    v_mfma_f32_16x16x32_bf16 v[8:11], a[32:35], v[120:123], v[8:11]
    ds_read_b64_tr_b16 a[80:81], v149 offset:24576
    v_mfma_f32_16x16x32_bf16 v[12:15], a[36:39], v[120:123], v[12:15]
    ds_read_b64_tr_b16 a[84:85], v150 offset:24576
    v_mfma_f32_16x16x32_bf16 v[16:19], a[40:43], v[120:123], v[16:19]
    ds_read_b64_tr_b16 a[88:89], v149 offset:25088
    v_mfma_f32_16x16x32_bf16 v[20:23], a[44:47], v[120:123], v[20:23]
    ds_read_b128 v[120:123], v1 offset:50176
    v_mfma_f32_16x16x32_bf16 v[24:27], a[32:35], v[124:127], v[24:27]
    ds_read_b64_tr_b16 a[92:93], v150 offset:25088
    v_mfma_f32_16x16x32_bf16 v[28:31], a[36:39], v[124:127], v[28:31]
    v_mfma_f32_16x16x32_bf16 v[32:35], a[40:43], v[124:127], v[32:35]
    v_mfma_f32_16x16x32_bf16 v[36:39], a[44:47], v[124:127], v[36:39]
    ds_read_b128 v[124:127], v1 offset:51200
    v_mfma_f32_16x16x32_bf16 v[40:43], a[32:35], v[128:131], v[40:43]
    v_mfma_f32_16x16x32_bf16 v[44:47], a[36:39], v[128:131], v[44:47]
    s_waitcnt vmcnt(0)
    ds_read_b64_tr_b16 a[82:83], v153 offset:32768
    v_mfma_f32_16x16x32_bf16 v[48:51], a[40:43], v[128:131], v[48:51]
    ds_read_b64_tr_b16 a[86:87], v154 offset:32768
    v_mfma_f32_16x16x32_bf16 v[52:55], a[44:47], v[128:131], v[52:55]
    ds_read_b128 v[128:131], v1 offset:52224
    s_waitcnt lgkmcnt(7)
    v_mfma_f32_16x16x32_bf16 v[56:59], a[32:35], v[132:135], v[56:59]
    ds_read_b64_tr_b16 a[90:91], v153 offset:33280
    v_mfma_f32_16x16x32_bf16 v[60:63], a[36:39], v[132:135], v[60:63]
    ds_read_b64_tr_b16 a[94:95], v154 offset:33280
    v_mfma_f32_16x16x32_bf16 v[64:67], a[40:43], v[132:135], v[64:67]
    v_mfma_f32_16x16x32_bf16 v[68:71], a[44:47], v[132:135], v[68:71]
    ds_read_b128 v[132:135], v1 offset:53248
    v_mfma_f32_16x16x32_bf16 v[72:75], a[32:35], v[136:139], v[72:75]
    v_mfma_f32_16x16x32_bf16 v[76:79], a[36:39], v[136:139], v[76:79]
    v_mfma_f32_16x16x32_bf16 v[80:83], a[40:43], v[136:139], v[80:83]
    v_mfma_f32_16x16x32_bf16 v[84:87], a[44:47], v[136:139], v[84:87]
    ds_read_b128 v[136:139], v1 offset:54272
    v_mfma_f32_16x16x32_bf16 v[88:91], a[32:35], v[140:143], v[88:91]
    v_mfma_f32_16x16x32_bf16 v[92:95], a[36:39], v[140:143], v[92:95]
    v_mfma_f32_16x16x32_bf16 v[96:99], a[40:43], v[140:143], v[96:99]
    v_mfma_f32_16x16x32_bf16 v[100:103], a[44:47], v[140:143], v[100:103]
    ds_read_b128 v[140:143], v1 offset:55296
    v_mfma_f32_16x16x32_bf16 v[104:107], a[32:35], v[144:147], v[104:107]
    v_mfma_f32_16x16x32_bf16 v[108:111], a[36:39], v[144:147], v[108:111]
    v_mfma_f32_16x16x32_bf16 v[112:115], a[40:43], v[144:147], v[112:115]
    v_mfma_f32_16x16x32_bf16 v[116:119], a[44:47], v[144:147], v[116:119]
    ds_read_b128 v[144:147], v1 offset:56320
    s_waitcnt lgkmcnt(3)
    v_mfma_f32_16x16x32_bf16 v[8:11], a[96:99], v[120:123], v[8:11]
    v_mfma_f32_16x16x32_bf16 v[12:15], a[100:103], v[120:123], v[12:15]
    v_mfma_f32_16x16x32_bf16 v[16:19], a[104:107], v[120:123], v[16:19]
    v_mfma_f32_16x16x32_bf16 v[20:23], a[108:111], v[120:123], v[20:23]
    ds_read_b128 v[120:123], v1 offset:0
    v_mfma_f32_16x16x32_bf16 v[24:27], a[96:99], v[124:127], v[24:27]
    v_mfma_f32_16x16x32_bf16 v[28:31], a[100:103], v[124:127], v[28:31]
    v_mfma_f32_16x16x32_bf16 v[32:35], a[104:107], v[124:127], v[32:35]
    v_mfma_f32_16x16x32_bf16 v[36:39], a[108:111], v[124:127], v[36:39]
    ds_read_b128 v[124:127], v1 offset:7168
    v_mfma_f32_16x16x32_bf16 v[40:43], a[96:99], v[128:131], v[40:43]
    v_mfma_f32_16x16x32_bf16 v[44:47], a[100:103], v[128:131], v[44:47]
    v_cvt_pk_bf16_f32 v188, v8, v9
    v_cvt_pk_bf16_f32 v189, v10, v11
    v_mfma_f32_16x16x32_bf16 v[48:51], a[104:107], v[128:131], v[48:51]
    v_cvt_pk_bf16_f32 v190, v12, v13
    v_cvt_pk_bf16_f32 v191, v14, v15
    v_mfma_f32_16x16x32_bf16 v[52:55], a[108:111], v[128:131], v[52:55]
    ds_read_b128 v[128:131], v1 offset:14336
    v_cvt_pk_bf16_f32 v192, v16, v17
    v_cvt_pk_bf16_f32 v193, v18, v19
    s_add_u32 s19, s18, 0
    buffer_store_dwordx4 v[188:191], v0, s[48:51], s19 offen offset:0 sc1
    v_mfma_f32_16x16x32_bf16 v[56:59], a[96:99], v[132:135], v[56:59]
    v_cvt_pk_bf16_f32 v194, v20, v21
    v_cvt_pk_bf16_f32 v195, v22, v23
    s_add_u32 s19, s18, 0
    buffer_store_dwordx4 v[192:195], v0, s[48:51], s19 offen offset:1024 sc1
    v_mfma_f32_16x16x32_bf16 v[60:63], a[100:103], v[132:135], v[60:63]
    v_cvt_pk_bf16_f32 v196, v24, v25
    v_cvt_pk_bf16_f32 v197, v26, v27
    v_mfma_f32_16x16x32_bf16 v[64:67], a[104:107], v[132:135], v[64:67]
    v_cvt_pk_bf16_f32 v198, v28, v29
    v_cvt_pk_bf16_f32 v199, v30, v31
    v_mfma_f32_16x16x32_bf16 v[68:71], a[108:111], v[132:135], v[68:71]
    ds_read_b128 v[132:135], v1 offset:21504
    v_cvt_pk_bf16_f32 v200, v32, v33
    v_cvt_pk_bf16_f32 v201, v34, v35
    s_add_u32 s19, s18, 0
    buffer_store_dwordx4 v[196:199], v0, s[48:51], s19 offen offset:2048 sc1
    s_waitcnt lgkmcnt(3)
    v_mfma_f32_16x16x32_bf16 v[72:75], a[96:99], v[136:139], v[72:75]
    v_cvt_pk_bf16_f32 v202, v36, v37
    v_cvt_pk_bf16_f32 v203, v38, v39
    s_add_u32 s19, s18, 0
    buffer_store_dwordx4 v[200:203], v0, s[48:51], s19 offen offset:3072 sc1
    v_mfma_f32_16x16x32_bf16 v[76:79], a[100:103], v[136:139], v[76:79]
    v_cvt_pk_bf16_f32 v204, v40, v41
    v_cvt_pk_bf16_f32 v205, v42, v43
    v_mfma_f32_16x16x32_bf16 v[80:83], a[104:107], v[136:139], v[80:83]
    v_cvt_pk_bf16_f32 v206, v44, v45
    v_cvt_pk_bf16_f32 v207, v46, v47
    v_mfma_f32_16x16x32_bf16 v[84:87], a[108:111], v[136:139], v[84:87]
    ds_read_b128 v[136:139], v1 offset:28672
    v_cvt_pk_bf16_f32 v208, v48, v49
    v_cvt_pk_bf16_f32 v209, v50, v51
    s_add_u32 s19, s18, 4096
    buffer_store_dwordx4 v[204:207], v0, s[48:51], s19 offen offset:0 sc1
    v_mfma_f32_16x16x32_bf16 v[88:91], a[96:99], v[140:143], v[88:91]
    v_cvt_pk_bf16_f32 v210, v52, v53
    v_cvt_pk_bf16_f32 v211, v54, v55
    s_add_u32 s19, s18, 4096
    buffer_store_dwordx4 v[208:211], v0, s[48:51], s19 offen offset:1024 sc1
    v_mfma_f32_16x16x32_bf16 v[92:95], a[100:103], v[140:143], v[92:95]
    v_cvt_pk_bf16_f32 v212, v56, v57
    v_cvt_pk_bf16_f32 v213, v58, v59
    v_mfma_f32_16x16x32_bf16 v[96:99], a[104:107], v[140:143], v[96:99]
    v_cvt_pk_bf16_f32 v214, v60, v61
    v_cvt_pk_bf16_f32 v215, v62, v63
    v_mfma_f32_16x16x32_bf16 v[100:103], a[108:111], v[140:143], v[100:103]
    ds_read_b128 v[140:143], v1 offset:35840
    v_cvt_pk_bf16_f32 v216, v64, v65
    v_cvt_pk_bf16_f32 v217, v66, v67
    s_add_u32 s19, s18, 4096
    buffer_store_dwordx4 v[212:215], v0, s[48:51], s19 offen offset:2048 sc1
    v_mfma_f32_16x16x32_bf16 v[104:107], a[96:99], v[144:147], v[104:107]
    v_cvt_pk_bf16_f32 v218, v68, v69
    v_cvt_pk_bf16_f32 v219, v70, v71
    s_add_u32 s19, s18, 4096
    buffer_store_dwordx4 v[216:219], v0, s[48:51], s19 offen offset:3072 sc1
    v_mfma_f32_16x16x32_bf16 v[108:111], a[100:103], v[144:147], v[108:111]
    v_cvt_pk_bf16_f32 v220, v72, v73
    v_cvt_pk_bf16_f32 v221, v74, v75
    v_mfma_f32_16x16x32_bf16 v[112:115], a[104:107], v[144:147], v[112:115]
    v_cvt_pk_bf16_f32 v222, v76, v77
    v_cvt_pk_bf16_f32 v223, v78, v79
    v_mfma_f32_16x16x32_bf16 v[116:119], a[108:111], v[144:147], v[116:119]
    ds_read_b128 v[144:147], v1 offset:43008
    v_cvt_pk_bf16_f32 v224, v80, v81
    v_cvt_pk_bf16_f32 v225, v82, v83
    s_add_u32 s19, s18, 8192
    buffer_store_dwordx4 v[220:223], v0, s[48:51], s19 offen offset:0 sc1
    s_cmp_eq_u32 s66, 3
    s_cbranch_scc1 L_w3
    v_mfma_f32_16x16x32_bf16 v[8:11], a[0:3], v[120:123], 0
    v_cvt_pk_bf16_f32 v226, v84, v85
    v_cvt_pk_bf16_f32 v227, v86, v87
    s_add_u32 s19, s18, 8192
    buffer_store_dwordx4 v[224:227], v0, s[48:51], s19 offen offset:1024 sc1
    v_mfma_f32_16x16x32_bf16 v[12:15], a[4:7], v[120:123], 0
    v_cvt_pk_bf16_f32 v228, v88, v89
    v_cvt_pk_bf16_f32 v229, v90, v91
    v_mfma_f32_16x16x32_bf16 v[16:19], a[8:11], v[120:123], 0
    v_cvt_pk_bf16_f32 v230, v92, v93
    v_cvt_pk_bf16_f32 v231, v94, v95
    v_mfma_f32_16x16x32_bf16 v[20:23], a[12:15], v[120:123], 0
    ds_read_b128 v[120:123], v1 offset:50176
    v_cvt_pk_bf16_f32 v232, v96, v97
    v_cvt_pk_bf16_f32 v233, v98, v99
    s_add_u32 s19, s18, 8192
    buffer_store_dwordx4 v[228:231], v0, s[48:51], s19 offen offset:2048 sc1
    s_waitcnt lgkmcnt(2)
    v_mfma_f32_16x16x32_bf16 v[8:11], a[48:51], v[124:127], v[8:11]
    v_cvt_pk_bf16_f32 v234, v100, v101
    v_cvt_pk_bf16_f32 v235, v102, v103
    s_add_u32 s19, s18, 8192
    buffer_store_dwordx4 v[232:235], v0, s[48:51], s19 offen offset:3072 sc1
    v_mfma_f32_16x16x32_bf16 v[12:15], a[52:55], v[124:127], v[12:15]
    v_cvt_pk_bf16_f32 v236, v104, v105
    v_cvt_pk_bf16_f32 v237, v106, v107
    v_mfma_f32_16x16x32_bf16 v[16:19], a[56:59], v[124:127], v[16:19]
    v_cvt_pk_bf16_f32 v238, v108, v109
    v_cvt_pk_bf16_f32 v239, v110, v111
    v_mfma_f32_16x16x32_bf16 v[20:23], a[60:63], v[124:127], v[20:23]
    ds_read_b128 v[124:127], v1 offset:1024
    v_cvt_pk_bf16_f32 v240, v112, v113
    v_cvt_pk_bf16_f32 v241, v114, v115
    s_add_u32 s19, s18, 12288
    buffer_store_dwordx4 v[236:239], v0, s[48:51], s19 offen offset:0 sc1
    v_mfma_f32_16x16x32_bf16 v[8:11], a[112:115], v[128:131], v[8:11]
    v_cvt_pk_bf16_f32 v242, v116, v117
    v_cvt_pk_bf16_f32 v243, v118, v119
    s_add_u32 s19, s18, 12288
    buffer_store_dwordx4 v[240:243], v0, s[48:51], s19 offen offset:1024 sc1
    v_mfma_f32_16x16x32_bf16 v[12:15], a[116:119], v[128:131], v[12:15]
    v_mfma_f32_16x16x32_bf16 v[16:19], a[120:123], v[128:131], v[16:19]
    v_mfma_f32_16x16x32_bf16 v[20:23], a[124:127], v[128:131], v[20:23]
    ds_read_b128 v[128:131], v1 offset:8192
    v_mfma_f32_16x16x32_bf16 v[8:11], a[16:19], v[132:135], v[8:11]
    v_mfma_f32_16x16x32_bf16 v[12:15], a[20:23], v[132:135], v[12:15]
    v_mfma_f32_16x16x32_bf16 v[16:19], a[24:27], v[132:135], v[16:19]
    v_mfma_f32_16x16x32_bf16 v[20:23], a[28:31], v[132:135], v[20:23]
    ds_read_b128 v[132:135], v1 offset:15360
    v_mfma_f32_16x16x32_bf16 v[8:11], a[128:131], v[136:139], v[8:11]
    v_mfma_f32_16x16x32_bf16 v[12:15], a[132:135], v[136:139], v[12:15]
    v_mfma_f32_16x16x32_bf16 v[16:19], a[136:139], v[136:139], v[16:19]
    v_mfma_f32_16x16x32_bf16 v[20:23], a[140:143], v[136:139], v[20:23]
    ds_read_b128 v[136:139], v1 offset:22528
    v_mfma_f32_16x16x32_bf16 v[8:11], a[64:67], v[140:143], v[8:11]
    v_mfma_f32_16x16x32_bf16 v[12:15], a[68:71], v[140:143], v[12:15]
    v_mfma_f32_16x16x32_bf16 v[16:19], a[72:75], v[140:143], v[16:19]
    v_mfma_f32_16x16x32_bf16 v[20:23], a[76:79], v[140:143], v[20:23]
    ds_read_b128 v[140:143], v1 offset:29696
    s_waitcnt lgkmcnt(3)
    v_mfma_f32_16x16x32_bf16 v[8:11], a[144:147], v[144:147], v[8:11]
    v_mfma_f32_16x16x32_bf16 v[12:15], a[148:151], v[144:147], v[12:15]
    v_mfma_f32_16x16x32_bf16 v[16:19], a[152:155], v[144:147], v[16:19]
    v_mfma_f32_16x16x32_bf16 v[20:23], a[156:159], v[144:147], v[20:23]
    ds_read_b128 v[144:147], v1 offset:36864
    v_mfma_f32_16x16x32_bf16 v[8:11], a[80:83], v[120:123], v[8:11]
    v_mfma_f32_16x16x32_bf16 v[12:15], a[84:87], v[120:123], v[12:15]
    v_mfma_f32_16x16x32_bf16 v[16:19], a[88:91], v[120:123], v[16:19]
    v_mfma_f32_16x16x32_bf16 v[20:23], a[92:95], v[120:123], v[20:23]
    ds_read_b128 v[120:123], v1 offset:44032
    v_mfma_f32_16x16x32_bf16 v[24:27], a[0:3], v[124:127], 0
    v_mfma_f32_16x16x32_bf16 v[28:31], a[4:7], v[124:127], 0
    v_mfma_f32_16x16x32_bf16 v[32:35], a[8:11], v[124:127], 0
    v_mfma_f32_16x16x32_bf16 v[36:39], a[12:15], v[124:127], 0
    ds_read_b128 v[124:127], v1 offset:51200
    v_mfma_f32_16x16x32_bf16 v[24:27], a[48:51], v[128:131], v[24:27]
    v_mfma_f32_16x16x32_bf16 v[28:31], a[52:55], v[128:131], v[28:31]
    v_cvt_pk_bf16_f32 v188, v8, v9
    v_cvt_pk_bf16_f32 v189, v10, v11
    v_mfma_f32_16x16x32_bf16 v[32:35], a[56:59], v[128:131], v[32:35]
    v_cvt_pk_bf16_f32 v190, v12, v13
    v_cvt_pk_bf16_f32 v191, v14, v15
    v_mfma_f32_16x16x32_bf16 v[36:39], a[60:63], v[128:131], v[36:39]
    ds_read_b128 v[128:131], v1 offset:2048
    v_cvt_pk_bf16_f32 v192, v16, v17
    v_cvt_pk_bf16_f32 v193, v18, v19
    s_add_u32 s19, s18, 12288
    buffer_store_dwordx4 v[188:191], v0, s[48:51], s19 offen offset:2048 sc1
    s_waitcnt lgkmcnt(3)
    v_mfma_f32_16x16x32_bf16 v[24:27], a[112:115], v[132:135], v[24:27]
    v_cvt_pk_bf16_f32 v194, v20, v21
    v_cvt_pk_bf16_f32 v195, v22, v23
    s_add_u32 s19, s18, 12288
    buffer_store_dwordx4 v[192:195], v0, s[48:51], s19 offen offset:3072 sc1
    v_mfma_f32_16x16x32_bf16 v[28:31], a[116:119], v[132:135], v[28:31]
    v_mfma_f32_16x16x32_bf16 v[32:35], a[120:123], v[132:135], v[32:35]
    v_mfma_f32_16x16x32_bf16 v[36:39], a[124:127], v[132:135], v[36:39]
    ds_read_b128 v[132:135], v1 offset:9216
    v_mfma_f32_16x16x32_bf16 v[24:27], a[16:19], v[136:139], v[24:27]
    v_mfma_f32_16x16x32_bf16 v[28:31], a[20:23], v[136:139], v[28:31]
    v_mfma_f32_16x16x32_bf16 v[32:35], a[24:27], v[136:139], v[32:35]
    v_mfma_f32_16x16x32_bf16 v[36:39], a[28:31], v[136:139], v[36:39]
    ds_read_b128 v[136:139], v1 offset:16384
    v_mfma_f32_16x16x32_bf16 v[24:27], a[128:131], v[140:143], v[24:27]
    v_mfma_f32_16x16x32_bf16 v[28:31], a[132:135], v[140:143], v[28:31]
    v_mfma_f32_16x16x32_bf16 v[32:35], a[136:139], v[140:143], v[32:35]
    v_mfma_f32_16x16x32_bf16 v[36:39], a[140:143], v[140:143], v[36:39]
    ds_read_b128 v[140:143], v1 offset:23552
    v_mfma_f32_16x16x32_bf16 v[24:27], a[64:67], v[144:147], v[24:27]
    v_mfma_f32_16x16x32_bf16 v[28:31], a[68:71], v[144:147], v[28:31]
    v_mfma_f32_16x16x32_bf16 v[32:35], a[72:75], v[144:147], v[32:35]
    v_mfma_f32_16x16x32_bf16 v[36:39], a[76:79], v[144:147], v[36:39]
    ds_read_b128 v[144:147], v1 offset:30720
    s_waitcnt lgkmcnt(3)
    v_mfma_f32_16x16x32_bf16 v[24:27], a[144:147], v[120:123], v[24:27]
    v_mfma_f32_16x16x32_bf16 v[28:31], a[148:151], v[120:123], v[28:31]
    v_mfma_f32_16x16x32_bf16 v[32:35], a[152:155], v[120:123], v[32:35]
    v_mfma_f32_16x16x32_bf16 v[36:39], a[156:159], v[120:123], v[36:39]
    ds_read_b128 v[120:123], v1 offset:37888
    v_mfma_f32_16x16x32_bf16 v[24:27], a[80:83], v[124:127], v[24:27]
    v_mfma_f32_16x16x32_bf16 v[28:31], a[84:87], v[124:127], v[28:31]
    v_mfma_f32_16x16x32_bf16 v[32:35], a[88:91], v[124:127], v[32:35]
    v_mfma_f32_16x16x32_bf16 v[36:39], a[92:95], v[124:127], v[36:39]
    ds_read_b128 v[124:127], v1 offset:45056
    v_mfma_f32_16x16x32_bf16 v[40:43], a[0:3], v[128:131], 0
    v_mfma_f32_16x16x32_bf16 v[44:47], a[4:7], v[128:131], 0
    v_mfma_f32_16x16x32_bf16 v[48:51], a[8:11], v[128:131], 0
    v_mfma_f32_16x16x32_bf16 v[52:55], a[12:15], v[128:131], 0
    ds_read_b128 v[128:131], v1 offset:52224
    v_mfma_f32_16x16x32_bf16 v[40:43], a[48:51], v[132:135], v[40:43]
    v_mfma_f32_16x16x32_bf16 v[44:47], a[52:55], v[132:135], v[44:47]
    v_cvt_pk_bf16_f32 v196, v24, v25
    v_cvt_pk_bf16_f32 v197, v26, v27
    v_mfma_f32_16x16x32_bf16 v[48:51], a[56:59], v[132:135], v[48:51]
    v_cvt_pk_bf16_f32 v198, v28, v29
    v_cvt_pk_bf16_f32 v199, v30, v31
    v_mfma_f32_16x16x32_bf16 v[52:55], a[60:63], v[132:135], v[52:55]
    ds_read_b128 v[132:135], v1 offset:3072
    v_cvt_pk_bf16_f32 v200, v32, v33
    v_cvt_pk_bf16_f32 v201, v34, v35
    s_add_u32 s19, s18, 16384
    buffer_store_dwordx4 v[196:199], v0, s[48:51], s19 offen offset:0 sc1
    s_waitcnt lgkmcnt(3)
    v_mfma_f32_16x16x32_bf16 v[40:43], a[112:115], v[136:139], v[40:43]
    v_cvt_pk_bf16_f32 v202, v36, v37
    v_cvt_pk_bf16_f32 v203, v38, v39
    s_add_u32 s19, s18, 16384
    buffer_store_dwordx4 v[200:203], v0, s[48:51], s19 offen offset:1024 sc1
    v_mfma_f32_16x16x32_bf16 v[44:47], a[116:119], v[136:139], v[44:47]
    v_mfma_f32_16x16x32_bf16 v[48:51], a[120:123], v[136:139], v[48:51]
    v_mfma_f32_16x16x32_bf16 v[52:55], a[124:127], v[136:139], v[52:55]
    ds_read_b128 v[136:139], v1 offset:10240
    v_mfma_f32_16x16x32_bf16 v[40:43], a[16:19], v[140:143], v[40:43]
    v_mfma_f32_16x16x32_bf16 v[44:47], a[20:23], v[140:143], v[44:47]
    v_mfma_f32_16x16x32_bf16 v[48:51], a[24:27], v[140:143], v[48:51]
    v_mfma_f32_16x16x32_bf16 v[52:55], a[28:31], v[140:143], v[52:55]
    ds_read_b128 v[140:143], v1 offset:17408
    v_mfma_f32_16x16x32_bf16 v[40:43], a[128:131], v[144:147], v[40:43]
    v_mfma_f32_16x16x32_bf16 v[44:47], a[132:135], v[144:147], v[44:47]
    v_mfma_f32_16x16x32_bf16 v[48:51], a[136:139], v[144:147], v[48:51]
    v_mfma_f32_16x16x32_bf16 v[52:55], a[140:143], v[144:147], v[52:55]
    ds_read_b128 v[144:147], v1 offset:24576
    v_mfma_f32_16x16x32_bf16 v[40:43], a[64:67], v[120:123], v[40:43]
    v_mfma_f32_16x16x32_bf16 v[44:47], a[68:71], v[120:123], v[44:47]
    v_mfma_f32_16x16x32_bf16 v[48:51], a[72:75], v[120:123], v[48:51]
    v_mfma_f32_16x16x32_bf16 v[52:55], a[76:79], v[120:123], v[52:55]
    ds_read_b128 v[120:123], v1 offset:31744
    s_waitcnt lgkmcnt(3)
    v_mfma_f32_16x16x32_bf16 v[40:43], a[144:147], v[124:127], v[40:43]
    v_mfma_f32_16x16x32_bf16 v[44:47], a[148:151], v[124:127], v[44:47]
    v_mfma_f32_16x16x32_bf16 v[48:51], a[152:155], v[124:127], v[48:51]
    v_mfma_f32_16x16x32_bf16 v[52:55], a[156:159], v[124:127], v[52:55]
    ds_read_b128 v[124:127], v1 offset:38912
    v_mfma_f32_16x16x32_bf16 v[40:43], a[80:83], v[128:131], v[40:43]
    v_mfma_f32_16x16x32_bf16 v[44:47], a[84:87], v[128:131], v[44:47]
    v_mfma_f32_16x16x32_bf16 v[48:51], a[88:91], v[128:131], v[48:51]
    v_mfma_f32_16x16x32_bf16 v[52:55], a[92:95], v[128:131], v[52:55]
    ds_read_b128 v[128:131], v1 offset:46080
    v_mfma_f32_16x16x32_bf16 v[56:59], a[0:3], v[132:135], 0
    v_mfma_f32_16x16x32_bf16 v[60:63], a[4:7], v[132:135], 0
    v_mfma_f32_16x16x32_bf16 v[64:67], a[8:11], v[132:135], 0
    v_mfma_f32_16x16x32_bf16 v[68:71], a[12:15], v[132:135], 0
    ds_read_b128 v[132:135], v1 offset:53248
    v_mfma_f32_16x16x32_bf16 v[56:59], a[48:51], v[136:139], v[56:59]
    v_mfma_f32_16x16x32_bf16 v[60:63], a[52:55], v[136:139], v[60:63]
    v_cvt_pk_bf16_f32 v204, v40, v41
    v_cvt_pk_bf16_f32 v205, v42, v43
    v_mfma_f32_16x16x32_bf16 v[64:67], a[56:59], v[136:139], v[64:67]
    v_cvt_pk_bf16_f32 v206, v44, v45
    v_cvt_pk_bf16_f32 v207, v46, v47
    v_mfma_f32_16x16x32_bf16 v[68:71], a[60:63], v[136:139], v[68:71]
    ds_read_b128 v[136:139], v1 offset:4096
    v_cvt_pk_bf16_f32 v208, v48, v49
    v_cvt_pk_bf16_f32 v209, v50, v51
    s_add_u32 s19, s18, 16384
    buffer_store_dwordx4 v[204:207], v0, s[48:51], s19 offen offset:2048 sc1
    s_waitcnt lgkmcnt(3)
    v_mfma_f32_16x16x32_bf16 v[56:59], a[112:115], v[140:143], v[56:59]
    v_cvt_pk_bf16_f32 v210, v52, v53
    v_cvt_pk_bf16_f32 v211, v54, v55
    s_add_u32 s19, s18, 16384
    buffer_store_dwordx4 v[208:211], v0, s[48:51], s19 offen offset:3072 sc1
    v_mfma_f32_16x16x32_bf16 v[60:63], a[116:119], v[140:143], v[60:63]
    v_mfma_f32_16x16x32_bf16 v[64:67], a[120:123], v[140:143], v[64:67]
    v_mfma_f32_16x16x32_bf16 v[68:71], a[124:127], v[140:143], v[68:71]
    ds_read_b128 v[140:143], v1 offset:11264
    v_mfma_f32_16x16x32_bf16 v[56:59], a[16:19], v[144:147], v[56:59]
    v_mfma_f32_16x16x32_bf16 v[60:63], a[20:23], v[144:147], v[60:63]
    v_mfma_f32_16x16x32_bf16 v[64:67], a[24:27], v[144:147], v[64:67]
    v_mfma_f32_16x16x32_bf16 v[68:71], a[28:31], v[144:147], v[68:71]
    ds_read_b128 v[144:147], v1 offset:18432
    s_waitcnt vmcnt(6)
    s_mov_b64 exec, 1
    ds_add_u32 v156, v157
    s_mov_b64 exec, -1
    v_mfma_f32_16x16x32_bf16 v[56:59], a[128:131], v[120:123], v[56:59]
    v_mfma_f32_16x16x32_bf16 v[60:63], a[132:135], v[120:123], v[60:63]
    v_mfma_f32_16x16x32_bf16 v[64:67], a[136:139], v[120:123], v[64:67]
    v_mfma_f32_16x16x32_bf16 v[68:71], a[140:143], v[120:123], v[68:71]
    ds_read_b128 v[120:123], v1 offset:25600
    v_mfma_f32_16x16x32_bf16 v[56:59], a[64:67], v[124:127], v[56:59]
    v_mfma_f32_16x16x32_bf16 v[60:63], a[68:71], v[124:127], v[60:63]
    v_mfma_f32_16x16x32_bf16 v[64:67], a[72:75], v[124:127], v[64:67]
    v_mfma_f32_16x16x32_bf16 v[68:71], a[76:79], v[124:127], v[68:71]
    ds_read_b128 v[124:127], v1 offset:32768
    s_waitcnt lgkmcnt(4)
    v_mfma_f32_16x16x32_bf16 v[56:59], a[144:147], v[128:131], v[56:59]
    v_mfma_f32_16x16x32_bf16 v[60:63], a[148:151], v[128:131], v[60:63]
    v_mfma_f32_16x16x32_bf16 v[64:67], a[152:155], v[128:131], v[64:67]
    v_mfma_f32_16x16x32_bf16 v[68:71], a[156:159], v[128:131], v[68:71]
    ds_read_b128 v[128:131], v1 offset:39936
    v_mfma_f32_16x16x32_bf16 v[56:59], a[80:83], v[132:135], v[56:59]
    v_mfma_f32_16x16x32_bf16 v[60:63], a[84:87], v[132:135], v[60:63]
    v_mfma_f32_16x16x32_bf16 v[64:67], a[88:91], v[132:135], v[64:67]
    v_mfma_f32_16x16x32_bf16 v[68:71], a[92:95], v[132:135], v[68:71]
    ds_read_b128 v[132:135], v1 offset:47104
    v_mfma_f32_16x16x32_bf16 v[72:75], a[0:3], v[136:139], 0
    v_mfma_f32_16x16x32_bf16 v[76:79], a[4:7], v[136:139], 0
    v_mfma_f32_16x16x32_bf16 v[80:83], a[8:11], v[136:139], 0
    v_mfma_f32_16x16x32_bf16 v[84:87], a[12:15], v[136:139], 0
    ds_read_b128 v[136:139], v1 offset:54272
    v_mfma_f32_16x16x32_bf16 v[72:75], a[48:51], v[140:143], v[72:75]
    v_mfma_f32_16x16x32_bf16 v[76:79], a[52:55], v[140:143], v[76:79]
    v_cvt_pk_bf16_f32 v212, v56, v57
    v_cvt_pk_bf16_f32 v213, v58, v59
    v_mfma_f32_16x16x32_bf16 v[80:83], a[56:59], v[140:143], v[80:83]
    v_cvt_pk_bf16_f32 v214, v60, v61
    v_cvt_pk_bf16_f32 v215, v62, v63
    v_mfma_f32_16x16x32_bf16 v[84:87], a[60:63], v[140:143], v[84:87]
    ds_read_b128 v[140:143], v1 offset:5120
    v_cvt_pk_bf16_f32 v216, v64, v65
    v_cvt_pk_bf16_f32 v217, v66, v67
    s_add_u32 s19, s18, 20480
    buffer_store_dwordx4 v[212:215], v0, s[48:51], s19 offen offset:0 sc1
    s_waitcnt lgkmcnt(3)
    v_mfma_f32_16x16x32_bf16 v[72:75], a[112:115], v[144:147], v[72:75]
    v_cvt_pk_bf16_f32 v218, v68, v69
    v_cvt_pk_bf16_f32 v219, v70, v71
    s_add_u32 s19, s18, 20480
    buffer_store_dwordx4 v[216:219], v0, s[48:51], s19 offen offset:1024 sc1
    v_mfma_f32_16x16x32_bf16 v[76:79], a[116:119], v[144:147], v[76:79]
    v_mfma_f32_16x16x32_bf16 v[80:83], a[120:123], v[144:147], v[80:83]
    v_mfma_f32_16x16x32_bf16 v[84:87], a[124:127], v[144:147], v[84:87]
    ds_read_b128 v[144:147], v1 offset:12288
    v_mfma_f32_16x16x32_bf16 v[72:75], a[16:19], v[120:123], v[72:75]
    v_mfma_f32_16x16x32_bf16 v[76:79], a[20:23], v[120:123], v[76:79]
    v_mfma_f32_16x16x32_bf16 v[80:83], a[24:27], v[120:123], v[80:83]
    v_mfma_f32_16x16x32_bf16 v[84:87], a[28:31], v[120:123], v[84:87]
    ds_read_b128 v[120:123], v1 offset:19456
    v_mfma_f32_16x16x32_bf16 v[72:75], a[128:131], v[124:127], v[72:75]
    v_mfma_f32_16x16x32_bf16 v[76:79], a[132:135], v[124:127], v[76:79]
    v_mfma_f32_16x16x32_bf16 v[80:83], a[136:139], v[124:127], v[80:83]
    v_mfma_f32_16x16x32_bf16 v[84:87], a[140:143], v[124:127], v[84:87]
    ds_read_b128 v[124:127], v1 offset:26624
    v_mfma_f32_16x16x32_bf16 v[72:75], a[64:67], v[128:131], v[72:75]
    v_mfma_f32_16x16x32_bf16 v[76:79], a[68:71], v[128:131], v[76:79]
    v_mfma_f32_16x16x32_bf16 v[80:83], a[72:75], v[128:131], v[80:83]
    v_mfma_f32_16x16x32_bf16 v[84:87], a[76:79], v[128:131], v[84:87]
    ds_read_b128 v[128:131], v1 offset:33792
    s_waitcnt lgkmcnt(3)
    v_mfma_f32_16x16x32_bf16 v[72:75], a[144:147], v[132:135], v[72:75]
    v_mfma_f32_16x16x32_bf16 v[76:79], a[148:151], v[132:135], v[76:79]
    v_mfma_f32_16x16x32_bf16 v[80:83], a[152:155], v[132:135], v[80:83]
    v_mfma_f32_16x16x32_bf16 v[84:87], a[156:159], v[132:135], v[84:87]
    ds_read_b128 v[132:135], v1 offset:40960
    v_mfma_f32_16x16x32_bf16 v[72:75], a[80:83], v[136:139], v[72:75]
    v_mfma_f32_16x16x32_bf16 v[76:79], a[84:87], v[136:139], v[76:79]
    v_mfma_f32_16x16x32_bf16 v[80:83], a[88:91], v[136:139], v[80:83]
    v_mfma_f32_16x16x32_bf16 v[84:87], a[92:95], v[136:139], v[84:87]
    ds_read_b128 v[136:139], v1 offset:48128
    v_mfma_f32_16x16x32_bf16 v[88:91], a[0:3], v[140:143], 0
    v_mfma_f32_16x16x32_bf16 v[92:95], a[4:7], v[140:143], 0
    v_mfma_f32_16x16x32_bf16 v[96:99], a[8:11], v[140:143], 0
    v_mfma_f32_16x16x32_bf16 v[100:103], a[12:15], v[140:143], 0
    ds_read_b128 v[140:143], v1 offset:55296
    v_mfma_f32_16x16x32_bf16 v[88:91], a[48:51], v[144:147], v[88:91]
    v_mfma_f32_16x16x32_bf16 v[92:95], a[52:55], v[144:147], v[92:95]
    v_cvt_pk_bf16_f32 v220, v72, v73
    v_cvt_pk_bf16_f32 v221, v74, v75
    v_mfma_f32_16x16x32_bf16 v[96:99], a[56:59], v[144:147], v[96:99]
    v_cvt_pk_bf16_f32 v222, v76, v77
    v_cvt_pk_bf16_f32 v223, v78, v79
    v_mfma_f32_16x16x32_bf16 v[100:103], a[60:63], v[144:147], v[100:103]
    ds_read_b128 v[144:147], v1 offset:6144
    v_cvt_pk_bf16_f32 v224, v80, v81
    v_cvt_pk_bf16_f32 v225, v82, v83
    s_add_u32 s19, s18, 20480
    buffer_store_dwordx4 v[220:223], v0, s[48:51], s19 offen offset:2048 sc1
    s_waitcnt lgkmcnt(3)
    v_mfma_f32_16x16x32_bf16 v[88:91], a[112:115], v[120:123], v[88:91]
    v_cvt_pk_bf16_f32 v226, v84, v85
    v_cvt_pk_bf16_f32 v227, v86, v87
    s_add_u32 s19, s18, 20480
    buffer_store_dwordx4 v[224:227], v0, s[48:51], s19 offen offset:3072 sc1
    v_mfma_f32_16x16x32_bf16 v[92:95], a[116:119], v[120:123], v[92:95]
    v_mfma_f32_16x16x32_bf16 v[96:99], a[120:123], v[120:123], v[96:99]
    v_mfma_f32_16x16x32_bf16 v[100:103], a[124:127], v[120:123], v[100:103]
    ds_read_b128 v[120:123], v1 offset:13312
    v_mfma_f32_16x16x32_bf16 v[88:91], a[16:19], v[124:127], v[88:91]
    v_mfma_f32_16x16x32_bf16 v[92:95], a[20:23], v[124:127], v[92:95]
    v_mfma_f32_16x16x32_bf16 v[96:99], a[24:27], v[124:127], v[96:99]
    v_mfma_f32_16x16x32_bf16 v[100:103], a[28:31], v[124:127], v[100:103]
    ds_read_b128 v[124:127], v1 offset:20480
    v_mfma_f32_16x16x32_bf16 v[88:91], a[128:131], v[128:131], v[88:91]
    v_mfma_f32_16x16x32_bf16 v[92:95], a[132:135], v[128:131], v[92:95]
    v_mfma_f32_16x16x32_bf16 v[96:99], a[136:139], v[128:131], v[96:99]
    v_mfma_f32_16x16x32_bf16 v[100:103], a[140:143], v[128:131], v[100:103]
    ds_read_b128 v[128:131], v1 offset:27648
    v_mfma_f32_16x16x32_bf16 v[88:91], a[64:67], v[132:135], v[88:91]
    v_mfma_f32_16x16x32_bf16 v[92:95], a[68:71], v[132:135], v[92:95]
    v_mfma_f32_16x16x32_bf16 v[96:99], a[72:75], v[132:135], v[96:99]
    v_mfma_f32_16x16x32_bf16 v[100:103], a[76:79], v[132:135], v[100:103]
    ds_read_b128 v[132:135], v1 offset:34816
    s_waitcnt lgkmcnt(3)
    v_mfma_f32_16x16x32_bf16 v[88:91], a[144:147], v[136:139], v[88:91]
    v_mfma_f32_16x16x32_bf16 v[92:95], a[148:151], v[136:139], v[92:95]
    v_mfma_f32_16x16x32_bf16 v[96:99], a[152:155], v[136:139], v[96:99]
    v_mfma_f32_16x16x32_bf16 v[100:103], a[156:159], v[136:139], v[100:103]
    ds_read_b128 v[136:139], v1 offset:41984
    v_mfma_f32_16x16x32_bf16 v[88:91], a[80:83], v[140:143], v[88:91]
    v_mfma_f32_16x16x32_bf16 v[92:95], a[84:87], v[140:143], v[92:95]
    v_mfma_f32_16x16x32_bf16 v[96:99], a[88:91], v[140:143], v[96:99]
    v_mfma_f32_16x16x32_bf16 v[100:103], a[92:95], v[140:143], v[100:103]
    ds_read_b128 v[140:143], v1 offset:49152
    v_mfma_f32_16x16x32_bf16 v[104:107], a[0:3], v[144:147], 0
    v_mfma_f32_16x16x32_bf16 v[108:111], a[4:7], v[144:147], 0
    v_mfma_f32_16x16x32_bf16 v[112:115], a[8:11], v[144:147], 0
    v_mfma_f32_16x16x32_bf16 v[116:119], a[12:15], v[144:147], 0
    ds_read_b128 v[144:147], v1 offset:56320
    v_mfma_f32_16x16x32_bf16 v[104:107], a[48:51], v[120:123], v[104:107]
    v_mfma_f32_16x16x32_bf16 v[108:111], a[52:55], v[120:123], v[108:111]
    v_cvt_pk_bf16_f32 v228, v88, v89
    v_cvt_pk_bf16_f32 v229, v90, v91
    v_mfma_f32_16x16x32_bf16 v[112:115], a[56:59], v[120:123], v[112:115]
    v_cvt_pk_bf16_f32 v230, v92, v93
    v_cvt_pk_bf16_f32 v231, v94, v95
    v_mfma_f32_16x16x32_bf16 v[116:119], a[60:63], v[120:123], v[116:119]
    v_cvt_pk_bf16_f32 v232, v96, v97
    v_cvt_pk_bf16_f32 v233, v98, v99
    s_add_u32 s19, s18, 24576
    buffer_store_dwordx4 v[228:231], v0, s[48:51], s19 offen offset:0 sc1
    s_waitcnt lgkmcnt(2)
    v_mfma_f32_16x16x32_bf16 v[104:107], a[112:115], v[124:127], v[104:107]
    v_cvt_pk_bf16_f32 v234, v100, v101
    v_cvt_pk_bf16_f32 v235, v102, v103
    s_add_u32 s19, s18, 24576
    buffer_store_dwordx4 v[232:235], v0, s[48:51], s19 offen offset:1024 sc1
    v_mfma_f32_16x16x32_bf16 v[108:111], a[116:119], v[124:127], v[108:111]
    v_mfma_f32_16x16x32_bf16 v[112:115], a[120:123], v[124:127], v[112:115]
    v_mfma_f32_16x16x32_bf16 v[116:119], a[124:127], v[124:127], v[116:119]
    v_mfma_f32_16x16x32_bf16 v[104:107], a[16:19], v[128:131], v[104:107]
    v_mfma_f32_16x16x32_bf16 v[108:111], a[20:23], v[128:131], v[108:111]
    v_mfma_f32_16x16x32_bf16 v[112:115], a[24:27], v[128:131], v[112:115]
    v_mfma_f32_16x16x32_bf16 v[116:119], a[28:31], v[128:131], v[116:119]
    v_mfma_f32_16x16x32_bf16 v[104:107], a[128:131], v[132:135], v[104:107]
    v_mfma_f32_16x16x32_bf16 v[108:111], a[132:135], v[132:135], v[108:111]
    v_mfma_f32_16x16x32_bf16 v[112:115], a[136:139], v[132:135], v[112:115]
    v_mfma_f32_16x16x32_bf16 v[116:119], a[140:143], v[132:135], v[116:119]
    v_mfma_f32_16x16x32_bf16 v[104:107], a[64:67], v[136:139], v[104:107]
    v_mfma_f32_16x16x32_bf16 v[108:111], a[68:71], v[136:139], v[108:111]
    v_mfma_f32_16x16x32_bf16 v[112:115], a[72:75], v[136:139], v[112:115]
    v_mfma_f32_16x16x32_bf16 v[116:119], a[76:79], v[136:139], v[116:119]
    s_waitcnt lgkmcnt(0)
    v_mfma_f32_16x16x32_bf16 v[104:107], a[144:147], v[140:143], v[104:107]
    v_mfma_f32_16x16x32_bf16 v[108:111], a[148:151], v[140:143], v[108:111]
    v_mfma_f32_16x16x32_bf16 v[112:115], a[152:155], v[140:143], v[112:115]
    v_mfma_f32_16x16x32_bf16 v[116:119], a[156:159], v[140:143], v[116:119]
    v_mfma_f32_16x16x32_bf16 v[104:107], a[80:83], v[144:147], v[104:107]
    v_mfma_f32_16x16x32_bf16 v[108:111], a[84:87], v[144:147], v[108:111]
    v_mfma_f32_16x16x32_bf16 v[112:115], a[88:91], v[144:147], v[112:115]
    v_mfma_f32_16x16x32_bf16 v[116:119], a[92:95], v[144:147], v[116:119]
    s_nop 7
    v_cvt_pk_bf16_f32 v236, v104, v105
    v_cvt_pk_bf16_f32 v237, v106, v107
    v_cvt_pk_bf16_f32 v238, v108, v109
    v_cvt_pk_bf16_f32 v239, v110, v111
    v_cvt_pk_bf16_f32 v240, v112, v113
    v_cvt_pk_bf16_f32 v241, v114, v115
    s_add_u32 s19, s18, 24576
    buffer_store_dwordx4 v[236:239], v0, s[48:51], s19 offen offset:2048 sc1
    v_cvt_pk_bf16_f32 v242, v116, v117
    v_cvt_pk_bf16_f32 v243, v118, v119
    s_add_u32 s19, s18, 24576
    buffer_store_dwordx4 v[240:243], v0, s[48:51], s19 offen offset:3072 sc1
    s_branch L_done
L_w3:
    s_nop 7
    s_waitcnt lgkmcnt(0)
    v_cvt_pk_bf16_f32 v226, v84, v85
    v_cvt_pk_bf16_f32 v227, v86, v87
    s_add_u32 s19, s18, 8192
    buffer_store_dwordx4 v[224:227], v0, s[48:51], s19 offen offset:1024 sc1
    v_cvt_pk_bf16_f32 v228, v88, v89
    v_cvt_pk_bf16_f32 v229, v90, v91
    v_cvt_pk_bf16_f32 v230, v92, v93
    v_cvt_pk_bf16_f32 v231, v94, v95
    v_cvt_pk_bf16_f32 v232, v96, v97
    v_cvt_pk_bf16_f32 v233, v98, v99
    s_add_u32 s19, s18, 8192
    buffer_store_dwordx4 v[228:231], v0, s[48:51], s19 offen offset:2048 sc1
    v_cvt_pk_bf16_f32 v234, v100, v101
    v_cvt_pk_bf16_f32 v235, v102, v103
    s_add_u32 s19, s18, 8192
    buffer_store_dwordx4 v[232:235], v0, s[48:51], s19 offen offset:3072 sc1
    v_cvt_pk_bf16_f32 v236, v104, v105
    v_cvt_pk_bf16_f32 v237, v106, v107
    v_cvt_pk_bf16_f32 v238, v108, v109
    v_cvt_pk_bf16_f32 v239, v110, v111
    v_cvt_pk_bf16_f32 v240, v112, v113
    v_cvt_pk_bf16_f32 v241, v114, v115
    s_add_u32 s19, s18, 12288
    buffer_store_dwordx4 v[236:239], v0, s[48:51], s19 offen offset:0 sc1
    v_cvt_pk_bf16_f32 v242, v116, v117
    v_cvt_pk_bf16_f32 v243, v118, v119
    s_add_u32 s19, s18, 12288
    buffer_store_dwordx4 v[240:243], v0, s[48:51], s19 offen offset:1024 sc1
    s_mov_b64 exec, 1
    global_load_dwordx2 v[164:165], v158, s[10:11] sc1
    s_mov_b64 exec, -1
    s_waitcnt vmcnt(0)
    s_mov_b64 exec, 1
    v_readfirstlane_b32 s3, v165
    s_nop 1
    s_cmp_lg_u32 s3, 0
    s_cbranch_scc1 L3_have
    s_bitset1_b32 s39, 31
    v_mov_b32 v160, s38
    v_mov_b32 v161, s39
    s_nop 1
    global_atomic_cmpswap_x2 v[164:165], v158, v[160:163], s[10:11] sc0
    s_waitcnt vmcnt(0)
    v_readfirstlane_b32 s3, v165
    s_nop 1
    s_cmp_lg_u32 s3, 0
    s_cbranch_scc1 L3_have
    v_mov_b32 v164, v160
    v_mov_b32 v165, v161
L3_have:
    ds_write_b64 v156, v[164:165] offset:16
    s_waitcnt lgkmcnt(0)
    ds_add_u32 v156, v157 offset:4
    v_readfirstlane_b32 s20, v164
    v_readfirstlane_b32 s21, v165
    s_movk_i32 s17, 400
    s_lshl_b32 s26, 1, s34
    s_mov_b32 s16, s26
L3_a0:
    ds_read_b32 v6, v156
    s_waitcnt lgkmcnt(0)
    v_readfirstlane_b32 s3, v6
    s_nop 1
    s_cmp_eq_u32 s3, 3
    s_cbranch_scc1 L3_sig
    s_sleep 1
    s_branch L3_a0
L3_sig:
    global_store_dwordx2 v167, v[164:165], s[14:15] sc1
    s_mov_b64 exec, 0xffff
    v_mov_b32 v164, s20
    v_mov_b32 v165, s21
L3_poll:
    global_load_dwordx2 v[6:7], v166, s[14:15] sc1
    s_waitcnt vmcnt(0)
    v_cmp_eq_u64 vcc, v[6:7], v[164:165]
    s_nop 1
    s_cmp_eq_u32 vcc_lo, 0xffff
    s_cbranch_scc1 L3_ok
    s_sleep 2
    s_sub_u32 s17, s17, 1
    s_cmp_lg_u32 s17, 0
    s_cbranch_scc1 L3_poll
    s_mov_b32 s16, 0
    s_mov_b32 s26, 0
L3_ok:
    s_mov_b64 exec, 1
    s_or_b32 s3, s16, 0x80000000
    v_mov_b32 v4, s3
    s_nop 0
    ds_write_b32 v156, v4 offset:12
    s_mov_b64 exec, -1
    v_lshrrev_b32 v8, 4, v0
    v_and_b32 v9, 15, v8
    v_bfe_u32 v11, v8, 4, 2
    v_lshlrev_b32 v11, 4, v11
    v_mul_u32_u24 v9, 1792, v9
    v_add_u32 v9, v9, v11
    v_and_b32 v12, 16, v8
    v_cmp_ne_u32 vcc, 0, v12
    s_mov_b32 s28, s8
    s_and_b32 s29, s9, 0xffff
    s_mov_b32 s30, 1605632
    s_mov_b32 s31, 0x20000
    s_mov_b32 s24, 0xffff0000
    s_mov_b32 s25, 0
    s_cmp_eq_u32 s16, 0
    s_cbranch_scc1 L3_next
    s_mov_b32 s16, 0
    s_cmp_ge_u32 s34, 14
    s_cbranch_scc1 L3_next
    s_lshl_b32 s27, s34, 2
    s_mul_i32 s3, s27, 37
    s_lshr_b32 s3, s3, 9
    s_mul_i32 s4, s3, 14
    s_sub_u32 s4, s27, s4
    s_mul_i32 s20, s3, 28672
    s_lshl_b32 s7, s4, 10
    s_add_u32 s20, s20, s7
    s_lshl_b32 s36, s3, 8
    s_and_b32 s7, s4, 1
    s_lshl_b32 s7, s7, 6
    s_add_u32 s36, s36, s7
    s_lshr_b32 s7, s4, 1
    s_mul_i32 s7, s7, 28672
    s_add_u32 s36, s36, s7
    s_add_u32 s36, s36, s33
    s_add_u32 s27, s27, 1
    s_mul_i32 s3, s27, 37
    s_lshr_b32 s3, s3, 9
    s_mul_i32 s4, s3, 14
    s_sub_u32 s4, s27, s4
    s_mul_i32 s21, s3, 28672
    s_lshl_b32 s7, s4, 10
    s_add_u32 s21, s21, s7
    s_lshl_b32 s37, s3, 8
    s_and_b32 s7, s4, 1
    s_lshl_b32 s7, s7, 6
    s_add_u32 s37, s37, s7
    s_lshr_b32 s7, s4, 1
    s_mul_i32 s7, s7, 28672
    s_add_u32 s37, s37, s7
    s_add_u32 s37, s37, s33
    buffer_load_dwordx4 v[16:19], v0, s[48:51], s20 offen sc1
    s_add_u32 s20, s20, 100352
    buffer_load_dwordx4 v[20:23], v0, s[48:51], s20 offen sc1
    s_add_u32 s20, s20, 100352
    buffer_load_dwordx4 v[24:27], v0, s[48:51], s20 offen sc1
    s_add_u32 s20, s20, 100352
    buffer_load_dwordx4 v[28:31], v0, s[48:51], s20 offen sc1
    s_add_u32 s20, s20, 100352
    buffer_load_dwordx4 v[32:35], v0, s[48:51], s20 offen sc1
    s_add_u32 s20, s20, 100352
    buffer_load_dwordx4 v[36:39], v0, s[48:51], s20 offen sc1
    s_add_u32 s20, s20, 100352
    buffer_load_dwordx4 v[40:43], v0, s[48:51], s20 offen sc1
    s_add_u32 s20, s20, 100352
    buffer_load_dwordx4 v[44:47], v0, s[48:51], s20 offen sc1
    s_add_u32 s20, s20, 100352
    buffer_load_dwordx4 v[48:51], v0, s[48:51], s20 offen sc1
    s_add_u32 s20, s20, 100352
    buffer_load_dwordx4 v[52:55], v0, s[48:51], s20 offen sc1
    s_add_u32 s20, s20, 100352
    buffer_load_dwordx4 v[56:59], v0, s[48:51], s20 offen sc1
    s_add_u32 s20, s20, 100352
    buffer_load_dwordx4 v[60:63], v0, s[48:51], s20 offen sc1
    s_add_u32 s20, s20, 100352
    buffer_load_dwordx4 v[64:67], v0, s[48:51], s20 offen sc1
    s_add_u32 s20, s20, 100352
    buffer_load_dwordx4 v[68:71], v0, s[48:51], s20 offen sc1
    s_add_u32 s20, s20, 100352
    buffer_load_dwordx4 v[72:75], v0, s[48:51], s20 offen sc1
    s_add_u32 s20, s20, 100352
    buffer_load_dwordx4 v[76:79], v0, s[48:51], s20 offen sc1
    buffer_load_dwordx4 v[80:83], v0, s[48:51], s21 offen sc1
    s_add_u32 s21, s21, 100352
    buffer_load_dwordx4 v[84:87], v0, s[48:51], s21 offen sc1
    s_add_u32 s21, s21, 100352
    buffer_load_dwordx4 v[88:91], v0, s[48:51], s21 offen sc1
    s_add_u32 s21, s21, 100352
    buffer_load_dwordx4 v[92:95], v0, s[48:51], s21 offen sc1
    s_add_u32 s21, s21, 100352
    buffer_load_dwordx4 v[96:99], v0, s[48:51], s21 offen sc1
    s_add_u32 s21, s21, 100352
    buffer_load_dwordx4 v[100:103], v0, s[48:51], s21 offen sc1
    s_add_u32 s21, s21, 100352
    buffer_load_dwordx4 v[104:107], v0, s[48:51], s21 offen sc1
    s_add_u32 s21, s21, 100352
    buffer_load_dwordx4 v[108:111], v0, s[48:51], s21 offen sc1
    s_add_u32 s21, s21, 100352
    buffer_load_dwordx4 v[112:115], v0, s[48:51], s21 offen sc1
    s_add_u32 s21, s21, 100352
    buffer_load_dwordx4 v[116:119], v0, s[48:51], s21 offen sc1
    s_add_u32 s21, s21, 100352
    buffer_load_dwordx4 v[120:123], v0, s[48:51], s21 offen sc1
    s_add_u32 s21, s21, 100352
    buffer_load_dwordx4 v[124:127], v0, s[48:51], s21 offen sc1
    s_add_u32 s21, s21, 100352
    buffer_load_dwordx4 v[128:131], v0, s[48:51], s21 offen sc1
    s_add_u32 s21, s21, 100352
    buffer_load_dwordx4 v[132:135], v0, s[48:51], s21 offen sc1
    s_add_u32 s21, s21, 100352
    buffer_load_dwordx4 v[136:139], v0, s[48:51], s21 offen sc1
    s_add_u32 s21, s21, 100352
    buffer_load_dwordx4 v[140:143], v0, s[48:51], s21 offen sc1
    s_waitcnt vmcnt(31)
    v_lshlrev_b32 v208, 16, v16
    v_and_b32 v209, s24, v16
    v_lshlrev_b32 v210, 16, v17
    v_and_b32 v211, s24, v17
    v_lshlrev_b32 v212, 16, v18
    v_and_b32 v213, s24, v18
    v_lshlrev_b32 v214, 16, v19
    v_and_b32 v215, s24, v19
    s_waitcnt vmcnt(30)
    v_lshlrev_b32 v216, 16, v20
    v_and_b32 v217, s24, v20
    v_lshlrev_b32 v218, 16, v21
    v_and_b32 v219, s24, v21
    v_lshlrev_b32 v220, 16, v22
    v_and_b32 v221, s24, v22
    v_lshlrev_b32 v222, 16, v23
    v_and_b32 v223, s24, v23
    v_pk_add_f32 v[208:209], v[208:209], v[216:217]
    v_pk_add_f32 v[210:211], v[210:211], v[218:219]
    v_pk_add_f32 v[212:213], v[212:213], v[220:221]
    v_pk_add_f32 v[214:215], v[214:215], v[222:223]
    s_waitcnt vmcnt(29)
    v_lshlrev_b32 v216, 16, v24
    v_and_b32 v217, s24, v24
    v_lshlrev_b32 v218, 16, v25
    v_and_b32 v219, s24, v25
    v_lshlrev_b32 v220, 16, v26
    v_and_b32 v221, s24, v26
    v_lshlrev_b32 v222, 16, v27
    v_and_b32 v223, s24, v27
    v_pk_add_f32 v[208:209], v[208:209], v[216:217]
    v_pk_add_f32 v[210:211], v[210:211], v[218:219]
    v_pk_add_f32 v[212:213], v[212:213], v[220:221]
    v_pk_add_f32 v[214:215], v[214:215], v[222:223]
    s_waitcnt vmcnt(28)
    v_lshlrev_b32 v216, 16, v28
    v_and_b32 v217, s24, v28
    v_lshlrev_b32 v218, 16, v29
    v_and_b32 v219, s24, v29
    v_lshlrev_b32 v220, 16, v30
    v_and_b32 v221, s24, v30
    v_lshlrev_b32 v222, 16, v31
    v_and_b32 v223, s24, v31
    v_pk_add_f32 v[208:209], v[208:209], v[216:217]
    v_pk_add_f32 v[210:211], v[210:211], v[218:219]
    v_pk_add_f32 v[212:213], v[212:213], v[220:221]
    v_pk_add_f32 v[214:215], v[214:215], v[222:223]
    s_waitcnt vmcnt(27)
    v_lshlrev_b32 v216, 16, v32
    v_and_b32 v217, s24, v32
    v_lshlrev_b32 v218, 16, v33
    v_and_b32 v219, s24, v33
    v_lshlrev_b32 v220, 16, v34
    v_and_b32 v221, s24, v34
    v_lshlrev_b32 v222, 16, v35
    v_and_b32 v223, s24, v35
    v_pk_add_f32 v[208:209], v[208:209], v[216:217]
    v_pk_add_f32 v[210:211], v[210:211], v[218:219]
    v_pk_add_f32 v[212:213], v[212:213], v[220:221]
    v_pk_add_f32 v[214:215], v[214:215], v[222:223]
    s_waitcnt vmcnt(26)
    v_lshlrev_b32 v216, 16, v36
    v_and_b32 v217, s24, v36
    v_lshlrev_b32 v218, 16, v37
    v_and_b32 v219, s24, v37
    v_lshlrev_b32 v220, 16, v38
    v_and_b32 v221, s24, v38
    v_lshlrev_b32 v222, 16, v39
    v_and_b32 v223, s24, v39
    v_pk_add_f32 v[208:209], v[208:209], v[216:217]
    v_pk_add_f32 v[210:211], v[210:211], v[218:219]
    v_pk_add_f32 v[212:213], v[212:213], v[220:221]
    v_pk_add_f32 v[214:215], v[214:215], v[222:223]
    s_waitcnt vmcnt(25)
    v_lshlrev_b32 v216, 16, v40
    v_and_b32 v217, s24, v40
    v_lshlrev_b32 v218, 16, v41
    v_and_b32 v219, s24, v41
    v_lshlrev_b32 v220, 16, v42
    v_and_b32 v221, s24, v42
    v_lshlrev_b32 v222, 16, v43
    v_and_b32 v223, s24, v43
    v_pk_add_f32 v[208:209], v[208:209], v[216:217]
    v_pk_add_f32 v[210:211], v[210:211], v[218:219]
    v_pk_add_f32 v[212:213], v[212:213], v[220:221]
    v_pk_add_f32 v[214:215], v[214:215], v[222:223]
    s_waitcnt vmcnt(24)
    v_lshlrev_b32 v216, 16, v44
    v_and_b32 v217, s24, v44
    v_lshlrev_b32 v218, 16, v45
    v_and_b32 v219, s24, v45
    v_lshlrev_b32 v220, 16, v46
    v_and_b32 v221, s24, v46
    v_lshlrev_b32 v222, 16, v47
    v_and_b32 v223, s24, v47
    v_pk_add_f32 v[208:209], v[208:209], v[216:217]
    v_pk_add_f32 v[210:211], v[210:211], v[218:219]
    v_pk_add_f32 v[212:213], v[212:213], v[220:221]
    v_pk_add_f32 v[214:215], v[214:215], v[222:223]
    s_waitcnt vmcnt(23)
    v_lshlrev_b32 v216, 16, v48
    v_and_b32 v217, s24, v48
    v_lshlrev_b32 v218, 16, v49
    v_and_b32 v219, s24, v49
    v_lshlrev_b32 v220, 16, v50
    v_and_b32 v221, s24, v50
    v_lshlrev_b32 v222, 16, v51
    v_and_b32 v223, s24, v51
    v_pk_add_f32 v[208:209], v[208:209], v[216:217]
    v_pk_add_f32 v[210:211], v[210:211], v[218:219]
    v_pk_add_f32 v[212:213], v[212:213], v[220:221]
    v_pk_add_f32 v[214:215], v[214:215], v[222:223]
    s_waitcnt vmcnt(22)
    v_lshlrev_b32 v216, 16, v52
    v_and_b32 v217, s24, v52
    v_lshlrev_b32 v218, 16, v53
    v_and_b32 v219, s24, v53
    v_lshlrev_b32 v220, 16, v54
    v_and_b32 v221, s24, v54
    v_lshlrev_b32 v222, 16, v55
    v_and_b32 v223, s24, v55
    v_pk_add_f32 v[208:209], v[208:209], v[216:217]
    v_pk_add_f32 v[210:211], v[210:211], v[218:219]
    v_pk_add_f32 v[212:213], v[212:213], v[220:221]
    v_pk_add_f32 v[214:215], v[214:215], v[222:223]
    s_waitcnt vmcnt(21)
    v_lshlrev_b32 v216, 16, v56
    v_and_b32 v217, s24, v56
    v_lshlrev_b32 v218, 16, v57
    v_and_b32 v219, s24, v57
    v_lshlrev_b32 v220, 16, v58
    v_and_b32 v221, s24, v58
    v_lshlrev_b32 v222, 16, v59
    v_and_b32 v223, s24, v59
    v_pk_add_f32 v[208:209], v[208:209], v[216:217]
    v_pk_add_f32 v[210:211], v[210:211], v[218:219]
    v_pk_add_f32 v[212:213], v[212:213], v[220:221]
    v_pk_add_f32 v[214:215], v[214:215], v[222:223]
    s_waitcnt vmcnt(20)
    v_lshlrev_b32 v216, 16, v60
    v_and_b32 v217, s24, v60
    v_lshlrev_b32 v218, 16, v61
    v_and_b32 v219, s24, v61
    v_lshlrev_b32 v220, 16, v62
    v_and_b32 v221, s24, v62
    v_lshlrev_b32 v222, 16, v63
    v_and_b32 v223, s24, v63
    v_pk_add_f32 v[208:209], v[208:209], v[216:217]
    v_pk_add_f32 v[210:211], v[210:211], v[218:219]
    v_pk_add_f32 v[212:213], v[212:213], v[220:221]
    v_pk_add_f32 v[214:215], v[214:215], v[222:223]
    s_waitcnt vmcnt(19)
    v_lshlrev_b32 v216, 16, v64
    v_and_b32 v217, s24, v64
    v_lshlrev_b32 v218, 16, v65
    v_and_b32 v219, s24, v65
    v_lshlrev_b32 v220, 16, v66
    v_and_b32 v221, s24, v66
    v_lshlrev_b32 v222, 16, v67
    v_and_b32 v223, s24, v67
    v_pk_add_f32 v[208:209], v[208:209], v[216:217]
    v_pk_add_f32 v[210:211], v[210:211], v[218:219]
    v_pk_add_f32 v[212:213], v[212:213], v[220:221]
    v_pk_add_f32 v[214:215], v[214:215], v[222:223]
    s_waitcnt vmcnt(18)
    v_lshlrev_b32 v216, 16, v68
    v_and_b32 v217, s24, v68
    v_lshlrev_b32 v218, 16, v69
    v_and_b32 v219, s24, v69
    v_lshlrev_b32 v220, 16, v70
    v_and_b32 v221, s24, v70
    v_lshlrev_b32 v222, 16, v71
    v_and_b32 v223, s24, v71
    v_pk_add_f32 v[208:209], v[208:209], v[216:217]
    v_pk_add_f32 v[210:211], v[210:211], v[218:219]
    v_pk_add_f32 v[212:213], v[212:213], v[220:221]
    v_pk_add_f32 v[214:215], v[214:215], v[222:223]
    s_waitcnt vmcnt(17)
    v_lshlrev_b32 v216, 16, v72
    v_and_b32 v217, s24, v72
    v_lshlrev_b32 v218, 16, v73
    v_and_b32 v219, s24, v73
    v_lshlrev_b32 v220, 16, v74
    v_and_b32 v221, s24, v74
    v_lshlrev_b32 v222, 16, v75
    v_and_b32 v223, s24, v75
    v_pk_add_f32 v[208:209], v[208:209], v[216:217]
    v_pk_add_f32 v[210:211], v[210:211], v[218:219]
    v_pk_add_f32 v[212:213], v[212:213], v[220:221]
    v_pk_add_f32 v[214:215], v[214:215], v[222:223]
    s_waitcnt vmcnt(16)
    v_lshlrev_b32 v216, 16, v76
    v_and_b32 v217, s24, v76
    v_lshlrev_b32 v218, 16, v77
    v_and_b32 v219, s24, v77
    v_lshlrev_b32 v220, 16, v78
    v_and_b32 v221, s24, v78
    v_lshlrev_b32 v222, 16, v79
    v_and_b32 v223, s24, v79
    v_pk_add_f32 v[208:209], v[208:209], v[216:217]
    v_pk_add_f32 v[210:211], v[210:211], v[218:219]
    v_pk_add_f32 v[212:213], v[212:213], v[220:221]
    v_pk_add_f32 v[214:215], v[214:215], v[222:223]
    v_cvt_pk_bf16_f32 v216, v208, v209
    v_cvt_pk_bf16_f32 v217, v210, v211
    v_cvt_pk_bf16_f32 v218, v212, v213
    v_cvt_pk_bf16_f32 v219, v214, v215
    v_cndmask_b32 v224, v216, v218, vcc
    v_cndmask_b32 v225, v217, v219, vcc
    v_cndmask_b32 v226, v218, v216, vcc
    v_cndmask_b32 v227, v219, v217, vcc
    s_nop 1
    buffer_store_dwordx4 v[224:227], v9, s[28:31], s36 offen
    s_waitcnt vmcnt(16)
    v_lshlrev_b32 v208, 16, v80
    v_and_b32 v209, s24, v80
    v_lshlrev_b32 v210, 16, v81
    v_and_b32 v211, s24, v81
    v_lshlrev_b32 v212, 16, v82
    v_and_b32 v213, s24, v82
    v_lshlrev_b32 v214, 16, v83
    v_and_b32 v215, s24, v83
    s_waitcnt vmcnt(15)
    v_lshlrev_b32 v216, 16, v84
    v_and_b32 v217, s24, v84
    v_lshlrev_b32 v218, 16, v85
    v_and_b32 v219, s24, v85
    v_lshlrev_b32 v220, 16, v86
    v_and_b32 v221, s24, v86
    v_lshlrev_b32 v222, 16, v87
    v_and_b32 v223, s24, v87
    v_pk_add_f32 v[208:209], v[208:209], v[216:217]
    v_pk_add_f32 v[210:211], v[210:211], v[218:219]
    v_pk_add_f32 v[212:213], v[212:213], v[220:221]
    v_pk_add_f32 v[214:215], v[214:215], v[222:223]
    s_waitcnt vmcnt(14)
    v_lshlrev_b32 v216, 16, v88
    v_and_b32 v217, s24, v88
    v_lshlrev_b32 v218, 16, v89
    v_and_b32 v219, s24, v89
    v_lshlrev_b32 v220, 16, v90
    v_and_b32 v221, s24, v90
    v_lshlrev_b32 v222, 16, v91
    v_and_b32 v223, s24, v91
    v_pk_add_f32 v[208:209], v[208:209], v[216:217]
    v_pk_add_f32 v[210:211], v[210:211], v[218:219]
    v_pk_add_f32 v[212:213], v[212:213], v[220:221]
    v_pk_add_f32 v[214:215], v[214:215], v[222:223]
    s_waitcnt vmcnt(13)
    v_lshlrev_b32 v216, 16, v92
    v_and_b32 v217, s24, v92
    v_lshlrev_b32 v218, 16, v93
    v_and_b32 v219, s24, v93
    v_lshlrev_b32 v220, 16, v94
    v_and_b32 v221, s24, v94
    v_lshlrev_b32 v222, 16, v95
    v_and_b32 v223, s24, v95
    v_pk_add_f32 v[208:209], v[208:209], v[216:217]
    v_pk_add_f32 v[210:211], v[210:211], v[218:219]
    v_pk_add_f32 v[212:213], v[212:213], v[220:221]
    v_pk_add_f32 v[214:215], v[214:215], v[222:223]
    s_waitcnt vmcnt(12)
    v_lshlrev_b32 v216, 16, v96
    v_and_b32 v217, s24, v96
    v_lshlrev_b32 v218, 16, v97
    v_and_b32 v219, s24, v97
    v_lshlrev_b32 v220, 16, v98
    v_and_b32 v221, s24, v98
    v_lshlrev_b32 v222, 16, v99
    v_and_b32 v223, s24, v99
    v_pk_add_f32 v[208:209], v[208:209], v[216:217]
    v_pk_add_f32 v[210:211], v[210:211], v[218:219]
    v_pk_add_f32 v[212:213], v[212:213], v[220:221]
    v_pk_add_f32 v[214:215], v[214:215], v[222:223]
    s_waitcnt vmcnt(11)
    v_lshlrev_b32 v216, 16, v100
    v_and_b32 v217, s24, v100
    v_lshlrev_b32 v218, 16, v101
    v_and_b32 v219, s24, v101
    v_lshlrev_b32 v220, 16, v102
    v_and_b32 v221, s24, v102
    v_lshlrev_b32 v222, 16, v103
    v_and_b32 v223, s24, v103
    v_pk_add_f32 v[208:209], v[208:209], v[216:217]
    v_pk_add_f32 v[210:211], v[210:211], v[218:219]
    v_pk_add_f32 v[212:213], v[212:213], v[220:221]
    v_pk_add_f32 v[214:215], v[214:215], v[222:223]
    s_waitcnt vmcnt(10)
    v_lshlrev_b32 v216, 16, v104
    v_and_b32 v217, s24, v104
    v_lshlrev_b32 v218, 16, v105
    v_and_b32 v219, s24, v105
    v_lshlrev_b32 v220, 16, v106
    v_and_b32 v221, s24, v106
    v_lshlrev_b32 v222, 16, v107
    v_and_b32 v223, s24, v107
    v_pk_add_f32 v[208:209], v[208:209], v[216:217]
    v_pk_add_f32 v[210:211], v[210:211], v[218:219]
    v_pk_add_f32 v[212:213], v[212:213], v[220:221]
    v_pk_add_f32 v[214:215], v[214:215], v[222:223]
    s_waitcnt vmcnt(9)
    v_lshlrev_b32 v216, 16, v108
    v_and_b32 v217, s24, v108
    v_lshlrev_b32 v218, 16, v109
    v_and_b32 v219, s24, v109
    v_lshlrev_b32 v220, 16, v110
    v_and_b32 v221, s24, v110
    v_lshlrev_b32 v222, 16, v111
    v_and_b32 v223, s24, v111
    v_pk_add_f32 v[208:209], v[208:209], v[216:217]
    v_pk_add_f32 v[210:211], v[210:211], v[218:219]
    v_pk_add_f32 v[212:213], v[212:213], v[220:221]
    v_pk_add_f32 v[214:215], v[214:215], v[222:223]
    s_waitcnt vmcnt(8)
    v_lshlrev_b32 v216, 16, v112
    v_and_b32 v217, s24, v112
    v_lshlrev_b32 v218, 16, v113
    v_and_b32 v219, s24, v113
    v_lshlrev_b32 v220, 16, v114
    v_and_b32 v221, s24, v114
    v_lshlrev_b32 v222, 16, v115
    v_and_b32 v223, s24, v115
    v_pk_add_f32 v[208:209], v[208:209], v[216:217]
    v_pk_add_f32 v[210:211], v[210:211], v[218:219]
    v_pk_add_f32 v[212:213], v[212:213], v[220:221]
    v_pk_add_f32 v[214:215], v[214:215], v[222:223]
    s_waitcnt vmcnt(7)
    v_lshlrev_b32 v216, 16, v116
    v_and_b32 v217, s24, v116
    v_lshlrev_b32 v218, 16, v117
    v_and_b32 v219, s24, v117
    v_lshlrev_b32 v220, 16, v118
    v_and_b32 v221, s24, v118
    v_lshlrev_b32 v222, 16, v119
    v_and_b32 v223, s24, v119
    v_pk_add_f32 v[208:209], v[208:209], v[216:217]
    v_pk_add_f32 v[210:211], v[210:211], v[218:219]
    v_pk_add_f32 v[212:213], v[212:213], v[220:221]
    v_pk_add_f32 v[214:215], v[214:215], v[222:223]
    s_waitcnt vmcnt(6)
    v_lshlrev_b32 v216, 16, v120
    v_and_b32 v217, s24, v120
    v_lshlrev_b32 v218, 16, v121
    v_and_b32 v219, s24, v121
    v_lshlrev_b32 v220, 16, v122
    v_and_b32 v221, s24, v122
    v_lshlrev_b32 v222, 16, v123
    v_and_b32 v223, s24, v123
    v_pk_add_f32 v[208:209], v[208:209], v[216:217]
    v_pk_add_f32 v[210:211], v[210:211], v[218:219]
    v_pk_add_f32 v[212:213], v[212:213], v[220:221]
    v_pk_add_f32 v[214:215], v[214:215], v[222:223]
    s_waitcnt vmcnt(5)
    v_lshlrev_b32 v216, 16, v124
    v_and_b32 v217, s24, v124
    v_lshlrev_b32 v218, 16, v125
    v_and_b32 v219, s24, v125
    v_lshlrev_b32 v220, 16, v126
    v_and_b32 v221, s24, v126
    v_lshlrev_b32 v222, 16, v127
    v_and_b32 v223, s24, v127
    v_pk_add_f32 v[208:209], v[208:209], v[216:217]
    v_pk_add_f32 v[210:211], v[210:211], v[218:219]
    v_pk_add_f32 v[212:213], v[212:213], v[220:221]
    v_pk_add_f32 v[214:215], v[214:215], v[222:223]
    s_waitcnt vmcnt(4)
    v_lshlrev_b32 v216, 16, v128
    v_and_b32 v217, s24, v128
    v_lshlrev_b32 v218, 16, v129
    v_and_b32 v219, s24, v129
    v_lshlrev_b32 v220, 16, v130
    v_and_b32 v221, s24, v130
    v_lshlrev_b32 v222, 16, v131
    v_and_b32 v223, s24, v131
    v_pk_add_f32 v[208:209], v[208:209], v[216:217]
    v_pk_add_f32 v[210:211], v[210:211], v[218:219]
    v_pk_add_f32 v[212:213], v[212:213], v[220:221]
    v_pk_add_f32 v[214:215], v[214:215], v[222:223]
    s_waitcnt vmcnt(3)
    v_lshlrev_b32 v216, 16, v132
    v_and_b32 v217, s24, v132
    v_lshlrev_b32 v218, 16, v133
    v_and_b32 v219, s24, v133
    v_lshlrev_b32 v220, 16, v134
    v_and_b32 v221, s24, v134
    v_lshlrev_b32 v222, 16, v135
    v_and_b32 v223, s24, v135
    v_pk_add_f32 v[208:209], v[208:209], v[216:217]
    v_pk_add_f32 v[210:211], v[210:211], v[218:219]
    v_pk_add_f32 v[212:213], v[212:213], v[220:221]
    v_pk_add_f32 v[214:215], v[214:215], v[222:223]
    s_waitcnt vmcnt(2)
    v_lshlrev_b32 v216, 16, v136
    v_and_b32 v217, s24, v136
    v_lshlrev_b32 v218, 16, v137
    v_and_b32 v219, s24, v137
    v_lshlrev_b32 v220, 16, v138
    v_and_b32 v221, s24, v138
    v_lshlrev_b32 v222, 16, v139
    v_and_b32 v223, s24, v139
    v_pk_add_f32 v[208:209], v[208:209], v[216:217]
    v_pk_add_f32 v[210:211], v[210:211], v[218:219]
    v_pk_add_f32 v[212:213], v[212:213], v[220:221]
    v_pk_add_f32 v[214:215], v[214:215], v[222:223]
    s_waitcnt vmcnt(1)
    v_lshlrev_b32 v216, 16, v140
    v_and_b32 v217, s24, v140
    v_lshlrev_b32 v218, 16, v141
    v_and_b32 v219, s24, v141
    v_lshlrev_b32 v220, 16, v142
    v_and_b32 v221, s24, v142
    v_lshlrev_b32 v222, 16, v143
    v_and_b32 v223, s24, v143
    v_pk_add_f32 v[208:209], v[208:209], v[216:217]
    v_pk_add_f32 v[210:211], v[210:211], v[218:219]
    v_pk_add_f32 v[212:213], v[212:213], v[220:221]
    v_pk_add_f32 v[214:215], v[214:215], v[222:223]
    v_cvt_pk_bf16_f32 v216, v208, v209
    v_cvt_pk_bf16_f32 v217, v210, v211
    v_cvt_pk_bf16_f32 v218, v212, v213
    v_cvt_pk_bf16_f32 v219, v214, v215
    v_cndmask_b32 v228, v216, v218, vcc
    v_cndmask_b32 v229, v217, v219, vcc
    v_cndmask_b32 v230, v218, v216, vcc
    v_cndmask_b32 v231, v219, v217, vcc
    s_nop 1
    buffer_store_dwordx4 v[228:231], v9, s[28:31], s37 offen
    s_branch L3_next
L3_loop:
    s_cmp_eq_u32 s16, 0
    s_cbranch_scc1 L3_next
    s_ff1_i32_b32 s17, s16
    s_bitset0_b32 s16, s17
    s_cmp_ge_u32 s17, 14
    s_cbranch_scc1 L3_loop
    s_lshl_b32 s27, s17, 2
    s_mul_i32 s3, s27, 37
    s_lshr_b32 s3, s3, 9
    s_mul_i32 s4, s3, 14
    s_sub_u32 s4, s27, s4
    s_mul_i32 s20, s3, 28672
    s_lshl_b32 s7, s4, 10
    s_add_u32 s20, s20, s7
    s_lshl_b32 s36, s3, 8
    s_and_b32 s7, s4, 1
    s_lshl_b32 s7, s7, 6
    s_add_u32 s36, s36, s7
    s_lshr_b32 s7, s4, 1
    s_mul_i32 s7, s7, 28672
    s_add_u32 s36, s36, s7
    s_add_u32 s36, s36, s33
    s_add_u32 s27, s27, 1
    s_mul_i32 s3, s27, 37
    s_lshr_b32 s3, s3, 9
    s_mul_i32 s4, s3, 14
    s_sub_u32 s4, s27, s4
    s_mul_i32 s21, s3, 28672
    s_lshl_b32 s7, s4, 10
    s_add_u32 s21, s21, s7
    s_lshl_b32 s37, s3, 8
    s_and_b32 s7, s4, 1
    s_lshl_b32 s7, s7, 6
    s_add_u32 s37, s37, s7
    s_lshr_b32 s7, s4, 1
    s_mul_i32 s7, s7, 28672
    s_add_u32 s37, s37, s7
    s_add_u32 s37, s37, s33
    s_add_u32 s27, s27, 1
    s_mul_i32 s3, s27, 37
    s_lshr_b32 s3, s3, 9
    s_mul_i32 s4, s3, 14
    s_sub_u32 s4, s27, s4
    s_mul_i32 s22, s3, 28672
    s_lshl_b32 s7, s4, 10
    s_add_u32 s22, s22, s7
    s_lshl_b32 s38, s3, 8
    s_and_b32 s7, s4, 1
    s_lshl_b32 s7, s7, 6
    s_add_u32 s38, s38, s7
    s_lshr_b32 s7, s4, 1
    s_mul_i32 s7, s7, 28672
    s_add_u32 s38, s38, s7
    s_add_u32 s38, s38, s33
    s_add_u32 s27, s27, 1
    s_mul_i32 s3, s27, 37
    s_lshr_b32 s3, s3, 9
    s_mul_i32 s4, s3, 14
    s_sub_u32 s4, s27, s4
    s_mul_i32 s23, s3, 28672
    s_lshl_b32 s7, s4, 10
    s_add_u32 s23, s23, s7
    s_lshl_b32 s39, s3, 8
    s_and_b32 s7, s4, 1
    s_lshl_b32 s7, s7, 6
    s_add_u32 s39, s39, s7
    s_lshr_b32 s7, s4, 1
    s_mul_i32 s7, s7, 28672
    s_add_u32 s39, s39, s7
    s_add_u32 s39, s39, s33
    buffer_load_dwordx4 v[16:19], v0, s[48:51], s20 offen sc1
    s_add_u32 s20, s20, 100352
    buffer_load_dwordx4 v[20:23], v0, s[48:51], s20 offen sc1
    s_add_u32 s20, s20, 100352
    buffer_load_dwordx4 v[24:27], v0, s[48:51], s20 offen sc1
    s_add_u32 s20, s20, 100352
    buffer_load_dwordx4 v[28:31], v0, s[48:51], s20 offen sc1
    s_add_u32 s20, s20, 100352
    buffer_load_dwordx4 v[32:35], v0, s[48:51], s20 offen sc1
    s_add_u32 s20, s20, 100352
    buffer_load_dwordx4 v[36:39], v0, s[48:51], s20 offen sc1
    s_add_u32 s20, s20, 100352
    buffer_load_dwordx4 v[40:43], v0, s[48:51], s20 offen sc1
    s_add_u32 s20, s20, 100352
    buffer_load_dwordx4 v[44:47], v0, s[48:51], s20 offen sc1
    s_add_u32 s20, s20, 100352
    buffer_load_dwordx4 v[48:51], v0, s[48:51], s20 offen sc1
    s_add_u32 s20, s20, 100352
    buffer_load_dwordx4 v[52:55], v0, s[48:51], s20 offen sc1
    s_add_u32 s20, s20, 100352
    buffer_load_dwordx4 v[56:59], v0, s[48:51], s20 offen sc1
    s_add_u32 s20, s20, 100352
    buffer_load_dwordx4 v[60:63], v0, s[48:51], s20 offen sc1
    s_add_u32 s20, s20, 100352
    buffer_load_dwordx4 v[64:67], v0, s[48:51], s20 offen sc1
    s_add_u32 s20, s20, 100352
    buffer_load_dwordx4 v[68:71], v0, s[48:51], s20 offen sc1
    s_add_u32 s20, s20, 100352
    buffer_load_dwordx4 v[72:75], v0, s[48:51], s20 offen sc1
    s_add_u32 s20, s20, 100352
    buffer_load_dwordx4 v[76:79], v0, s[48:51], s20 offen sc1
    buffer_load_dwordx4 v[80:83], v0, s[48:51], s21 offen sc1
    s_add_u32 s21, s21, 100352
    buffer_load_dwordx4 v[84:87], v0, s[48:51], s21 offen sc1
    s_add_u32 s21, s21, 100352
    buffer_load_dwordx4 v[88:91], v0, s[48:51], s21 offen sc1
    s_add_u32 s21, s21, 100352
    buffer_load_dwordx4 v[92:95], v0, s[48:51], s21 offen sc1
    s_add_u32 s21, s21, 100352
    buffer_load_dwordx4 v[96:99], v0, s[48:51], s21 offen sc1
    s_add_u32 s21, s21, 100352
    buffer_load_dwordx4 v[100:103], v0, s[48:51], s21 offen sc1
    s_add_u32 s21, s21, 100352
    buffer_load_dwordx4 v[104:107], v0, s[48:51], s21 offen sc1
    s_add_u32 s21, s21, 100352
    buffer_load_dwordx4 v[108:111], v0, s[48:51], s21 offen sc1
    s_add_u32 s21, s21, 100352
    buffer_load_dwordx4 v[112:115], v0, s[48:51], s21 offen sc1
    s_add_u32 s21, s21, 100352
    buffer_load_dwordx4 v[116:119], v0, s[48:51], s21 offen sc1
    s_add_u32 s21, s21, 100352
    buffer_load_dwordx4 v[120:123], v0, s[48:51], s21 offen sc1
    s_add_u32 s21, s21, 100352
    buffer_load_dwordx4 v[124:127], v0, s[48:51], s21 offen sc1
    s_add_u32 s21, s21, 100352
    buffer_load_dwordx4 v[128:131], v0, s[48:51], s21 offen sc1
    s_add_u32 s21, s21, 100352
    buffer_load_dwordx4 v[132:135], v0, s[48:51], s21 offen sc1
    s_add_u32 s21, s21, 100352
    buffer_load_dwordx4 v[136:139], v0, s[48:51], s21 offen sc1
    s_add_u32 s21, s21, 100352
    buffer_load_dwordx4 v[140:143], v0, s[48:51], s21 offen sc1
    buffer_load_dwordx4 v[144:147], v0, s[48:51], s22 offen sc1
    s_add_u32 s22, s22, 100352
    buffer_load_dwordx4 v[148:151], v0, s[48:51], s22 offen sc1
    s_add_u32 s22, s22, 100352
    buffer_load_dwordx4 v[152:155], v0, s[48:51], s22 offen sc1
    s_add_u32 s22, s22, 100352
    buffer_load_dwordx4 v[156:159], v0, s[48:51], s22 offen sc1
    s_add_u32 s22, s22, 100352
    buffer_load_dwordx4 v[160:163], v0, s[48:51], s22 offen sc1
    s_add_u32 s22, s22, 100352
    buffer_load_dwordx4 v[164:167], v0, s[48:51], s22 offen sc1
    s_add_u32 s22, s22, 100352
    buffer_load_dwordx4 v[168:171], v0, s[48:51], s22 offen sc1
    s_add_u32 s22, s22, 100352
    buffer_load_dwordx4 v[172:175], v0, s[48:51], s22 offen sc1
    s_add_u32 s22, s22, 100352
    buffer_load_dwordx4 v[176:179], v0, s[48:51], s22 offen sc1
    s_add_u32 s22, s22, 100352
    buffer_load_dwordx4 v[180:183], v0, s[48:51], s22 offen sc1
    s_add_u32 s22, s22, 100352
    buffer_load_dwordx4 v[184:187], v0, s[48:51], s22 offen sc1
    s_add_u32 s22, s22, 100352
    buffer_load_dwordx4 v[188:191], v0, s[48:51], s22 offen sc1
    s_add_u32 s22, s22, 100352
    buffer_load_dwordx4 v[192:195], v0, s[48:51], s22 offen sc1
    s_add_u32 s22, s22, 100352
    buffer_load_dwordx4 v[196:199], v0, s[48:51], s22 offen sc1
    s_add_u32 s22, s22, 100352
    buffer_load_dwordx4 v[200:203], v0, s[48:51], s22 offen sc1
    s_add_u32 s22, s22, 100352
    buffer_load_dwordx4 v[204:207], v0, s[48:51], s22 offen sc1
    s_waitcnt vmcnt(47)
    v_lshlrev_b32 v208, 16, v16
    v_and_b32 v209, s24, v16
    v_lshlrev_b32 v210, 16, v17
    v_and_b32 v211, s24, v17
    v_lshlrev_b32 v212, 16, v18
    v_and_b32 v213, s24, v18
    v_lshlrev_b32 v214, 16, v19
    v_and_b32 v215, s24, v19
    s_waitcnt vmcnt(46)
    v_lshlrev_b32 v216, 16, v20
    v_and_b32 v217, s24, v20
    v_lshlrev_b32 v218, 16, v21
    v_and_b32 v219, s24, v21
    v_lshlrev_b32 v220, 16, v22
    v_and_b32 v221, s24, v22
    v_lshlrev_b32 v222, 16, v23
    v_and_b32 v223, s24, v23
    v_pk_add_f32 v[208:209], v[208:209], v[216:217]
    v_pk_add_f32 v[210:211], v[210:211], v[218:219]
    v_pk_add_f32 v[212:213], v[212:213], v[220:221]
    v_pk_add_f32 v[214:215], v[214:215], v[222:223]
    s_waitcnt vmcnt(45)
    v_lshlrev_b32 v216, 16, v24
    v_and_b32 v217, s24, v24
    v_lshlrev_b32 v218, 16, v25
    v_and_b32 v219, s24, v25
    v_lshlrev_b32 v220, 16, v26
    v_and_b32 v221, s24, v26
    v_lshlrev_b32 v222, 16, v27
    v_and_b32 v223, s24, v27
    v_pk_add_f32 v[208:209], v[208:209], v[216:217]
    v_pk_add_f32 v[210:211], v[210:211], v[218:219]
    v_pk_add_f32 v[212:213], v[212:213], v[220:221]
    v_pk_add_f32 v[214:215], v[214:215], v[222:223]
    s_waitcnt vmcnt(44)
    v_lshlrev_b32 v216, 16, v28
    v_and_b32 v217, s24, v28
    v_lshlrev_b32 v218, 16, v29
    v_and_b32 v219, s24, v29
    v_lshlrev_b32 v220, 16, v30
    v_and_b32 v221, s24, v30
    v_lshlrev_b32 v222, 16, v31
    v_and_b32 v223, s24, v31
    v_pk_add_f32 v[208:209], v[208:209], v[216:217]
    v_pk_add_f32 v[210:211], v[210:211], v[218:219]
    v_pk_add_f32 v[212:213], v[212:213], v[220:221]
    v_pk_add_f32 v[214:215], v[214:215], v[222:223]
    s_waitcnt vmcnt(43)
    v_lshlrev_b32 v216, 16, v32
    v_and_b32 v217, s24, v32
    v_lshlrev_b32 v218, 16, v33
    v_and_b32 v219, s24, v33
    v_lshlrev_b32 v220, 16, v34
    v_and_b32 v221, s24, v34
    v_lshlrev_b32 v222, 16, v35
    v_and_b32 v223, s24, v35
    v_pk_add_f32 v[208:209], v[208:209], v[216:217]
    v_pk_add_f32 v[210:211], v[210:211], v[218:219]
    v_pk_add_f32 v[212:213], v[212:213], v[220:221]
    v_pk_add_f32 v[214:215], v[214:215], v[222:223]
    s_waitcnt vmcnt(42)
    v_lshlrev_b32 v216, 16, v36
    v_and_b32 v217, s24, v36
    v_lshlrev_b32 v218, 16, v37
    v_and_b32 v219, s24, v37
    v_lshlrev_b32 v220, 16, v38
    v_and_b32 v221, s24, v38
    v_lshlrev_b32 v222, 16, v39
    v_and_b32 v223, s24, v39
    v_pk_add_f32 v[208:209], v[208:209], v[216:217]
    v_pk_add_f32 v[210:211], v[210:211], v[218:219]
    v_pk_add_f32 v[212:213], v[212:213], v[220:221]
    v_pk_add_f32 v[214:215], v[214:215], v[222:223]
    s_waitcnt vmcnt(41)
    v_lshlrev_b32 v216, 16, v40
    v_and_b32 v217, s24, v40
    v_lshlrev_b32 v218, 16, v41
    v_and_b32 v219, s24, v41
    v_lshlrev_b32 v220, 16, v42
    v_and_b32 v221, s24, v42
    v_lshlrev_b32 v222, 16, v43
    v_and_b32 v223, s24, v43
    v_pk_add_f32 v[208:209], v[208:209], v[216:217]
    v_pk_add_f32 v[210:211], v[210:211], v[218:219]
    v_pk_add_f32 v[212:213], v[212:213], v[220:221]
    v_pk_add_f32 v[214:215], v[214:215], v[222:223]
    s_waitcnt vmcnt(40)
    v_lshlrev_b32 v216, 16, v44
    v_and_b32 v217, s24, v44
    v_lshlrev_b32 v218, 16, v45
    v_and_b32 v219, s24, v45
    v_lshlrev_b32 v220, 16, v46
    v_and_b32 v221, s24, v46
    v_lshlrev_b32 v222, 16, v47
    v_and_b32 v223, s24, v47
    v_pk_add_f32 v[208:209], v[208:209], v[216:217]
    v_pk_add_f32 v[210:211], v[210:211], v[218:219]
    v_pk_add_f32 v[212:213], v[212:213], v[220:221]
    v_pk_add_f32 v[214:215], v[214:215], v[222:223]
    s_waitcnt vmcnt(39)
    v_lshlrev_b32 v216, 16, v48
    v_and_b32 v217, s24, v48
    v_lshlrev_b32 v218, 16, v49
    v_and_b32 v219, s24, v49
    v_lshlrev_b32 v220, 16, v50
    v_and_b32 v221, s24, v50
    v_lshlrev_b32 v222, 16, v51
    v_and_b32 v223, s24, v51
    v_pk_add_f32 v[208:209], v[208:209], v[216:217]
    v_pk_add_f32 v[210:211], v[210:211], v[218:219]
    v_pk_add_f32 v[212:213], v[212:213], v[220:221]
    v_pk_add_f32 v[214:215], v[214:215], v[222:223]
    s_waitcnt vmcnt(38)
    v_lshlrev_b32 v216, 16, v52
    v_and_b32 v217, s24, v52
    v_lshlrev_b32 v218, 16, v53
    v_and_b32 v219, s24, v53
    v_lshlrev_b32 v220, 16, v54
    v_and_b32 v221, s24, v54
    v_lshlrev_b32 v222, 16, v55
    v_and_b32 v223, s24, v55
    v_pk_add_f32 v[208:209], v[208:209], v[216:217]
    v_pk_add_f32 v[210:211], v[210:211], v[218:219]
    v_pk_add_f32 v[212:213], v[212:213], v[220:221]
    v_pk_add_f32 v[214:215], v[214:215], v[222:223]
    s_waitcnt vmcnt(37)
    v_lshlrev_b32 v216, 16, v56
    v_and_b32 v217, s24, v56
    v_lshlrev_b32 v218, 16, v57
    v_and_b32 v219, s24, v57
    v_lshlrev_b32 v220, 16, v58
    v_and_b32 v221, s24, v58
    v_lshlrev_b32 v222, 16, v59
    v_and_b32 v223, s24, v59
    v_pk_add_f32 v[208:209], v[208:209], v[216:217]
    v_pk_add_f32 v[210:211], v[210:211], v[218:219]
    v_pk_add_f32 v[212:213], v[212:213], v[220:221]
    v_pk_add_f32 v[214:215], v[214:215], v[222:223]
    s_waitcnt vmcnt(36)
    v_lshlrev_b32 v216, 16, v60
    v_and_b32 v217, s24, v60
    v_lshlrev_b32 v218, 16, v61
    v_and_b32 v219, s24, v61
    v_lshlrev_b32 v220, 16, v62
    v_and_b32 v221, s24, v62
    v_lshlrev_b32 v222, 16, v63
    v_and_b32 v223, s24, v63
    v_pk_add_f32 v[208:209], v[208:209], v[216:217]
    v_pk_add_f32 v[210:211], v[210:211], v[218:219]
    v_pk_add_f32 v[212:213], v[212:213], v[220:221]
    v_pk_add_f32 v[214:215], v[214:215], v[222:223]
    s_waitcnt vmcnt(35)
    v_lshlrev_b32 v216, 16, v64
    v_and_b32 v217, s24, v64
    v_lshlrev_b32 v218, 16, v65
    v_and_b32 v219, s24, v65
    v_lshlrev_b32 v220, 16, v66
    v_and_b32 v221, s24, v66
    v_lshlrev_b32 v222, 16, v67
    v_and_b32 v223, s24, v67
    v_pk_add_f32 v[208:209], v[208:209], v[216:217]
    v_pk_add_f32 v[210:211], v[210:211], v[218:219]
    v_pk_add_f32 v[212:213], v[212:213], v[220:221]
    v_pk_add_f32 v[214:215], v[214:215], v[222:223]
    s_waitcnt vmcnt(34)
    v_lshlrev_b32 v216, 16, v68
    v_and_b32 v217, s24, v68
    v_lshlrev_b32 v218, 16, v69
    v_and_b32 v219, s24, v69
    v_lshlrev_b32 v220, 16, v70
    v_and_b32 v221, s24, v70
    v_lshlrev_b32 v222, 16, v71
    v_and_b32 v223, s24, v71
    v_pk_add_f32 v[208:209], v[208:209], v[216:217]
    v_pk_add_f32 v[210:211], v[210:211], v[218:219]
    v_pk_add_f32 v[212:213], v[212:213], v[220:221]
    v_pk_add_f32 v[214:215], v[214:215], v[222:223]
    s_waitcnt vmcnt(33)
    v_lshlrev_b32 v216, 16, v72
    v_and_b32 v217, s24, v72
    v_lshlrev_b32 v218, 16, v73
    v_and_b32 v219, s24, v73
    v_lshlrev_b32 v220, 16, v74
    v_and_b32 v221, s24, v74
    v_lshlrev_b32 v222, 16, v75
    v_and_b32 v223, s24, v75
    v_pk_add_f32 v[208:209], v[208:209], v[216:217]
    v_pk_add_f32 v[210:211], v[210:211], v[218:219]
    v_pk_add_f32 v[212:213], v[212:213], v[220:221]
    v_pk_add_f32 v[214:215], v[214:215], v[222:223]
    s_waitcnt vmcnt(32)
    v_lshlrev_b32 v216, 16, v76
    v_and_b32 v217, s24, v76
    v_lshlrev_b32 v218, 16, v77
    v_and_b32 v219, s24, v77
    v_lshlrev_b32 v220, 16, v78
    v_and_b32 v221, s24, v78
    v_lshlrev_b32 v222, 16, v79
    v_and_b32 v223, s24, v79
    v_pk_add_f32 v[208:209], v[208:209], v[216:217]
    v_pk_add_f32 v[210:211], v[210:211], v[218:219]
    v_pk_add_f32 v[212:213], v[212:213], v[220:221]
    v_pk_add_f32 v[214:215], v[214:215], v[222:223]
    v_cvt_pk_bf16_f32 v216, v208, v209
    v_cvt_pk_bf16_f32 v217, v210, v211
    v_cvt_pk_bf16_f32 v218, v212, v213
    v_cvt_pk_bf16_f32 v219, v214, v215
    v_cndmask_b32 v224, v216, v218, vcc
    v_cndmask_b32 v225, v217, v219, vcc
    v_cndmask_b32 v226, v218, v216, vcc
    v_cndmask_b32 v227, v219, v217, vcc
    s_nop 1
    buffer_store_dwordx4 v[224:227], v9, s[28:31], s36 offen
    buffer_load_dwordx4 v[16:19], v0, s[48:51], s23 offen sc1
    s_add_u32 s23, s23, 100352
    buffer_load_dwordx4 v[20:23], v0, s[48:51], s23 offen sc1
    s_add_u32 s23, s23, 100352
    buffer_load_dwordx4 v[24:27], v0, s[48:51], s23 offen sc1
    s_add_u32 s23, s23, 100352
    buffer_load_dwordx4 v[28:31], v0, s[48:51], s23 offen sc1
    s_add_u32 s23, s23, 100352
    buffer_load_dwordx4 v[32:35], v0, s[48:51], s23 offen sc1
    s_add_u32 s23, s23, 100352
    buffer_load_dwordx4 v[36:39], v0, s[48:51], s23 offen sc1
    s_add_u32 s23, s23, 100352
    buffer_load_dwordx4 v[40:43], v0, s[48:51], s23 offen sc1
    s_add_u32 s23, s23, 100352
    buffer_load_dwordx4 v[44:47], v0, s[48:51], s23 offen sc1
    s_add_u32 s23, s23, 100352
    buffer_load_dwordx4 v[48:51], v0, s[48:51], s23 offen sc1
    s_add_u32 s23, s23, 100352
    buffer_load_dwordx4 v[52:55], v0, s[48:51], s23 offen sc1
    s_add_u32 s23, s23, 100352
    buffer_load_dwordx4 v[56:59], v0, s[48:51], s23 offen sc1
    s_add_u32 s23, s23, 100352
    buffer_load_dwordx4 v[60:63], v0, s[48:51], s23 offen sc1
    s_add_u32 s23, s23, 100352
    buffer_load_dwordx4 v[64:67], v0, s[48:51], s23 offen sc1
    s_add_u32 s23, s23, 100352
    buffer_load_dwordx4 v[68:71], v0, s[48:51], s23 offen sc1
    s_add_u32 s23, s23, 100352
    buffer_load_dwordx4 v[72:75], v0, s[48:51], s23 offen sc1
    s_add_u32 s23, s23, 100352
    buffer_load_dwordx4 v[76:79], v0, s[48:51], s23 offen sc1
    s_waitcnt vmcnt(48)
    v_lshlrev_b32 v208, 16, v80
    v_and_b32 v209, s24, v80
    v_lshlrev_b32 v210, 16, v81
    v_and_b32 v211, s24, v81
    v_lshlrev_b32 v212, 16, v82
    v_and_b32 v213, s24, v82
    v_lshlrev_b32 v214, 16, v83
    v_and_b32 v215, s24, v83
    s_waitcnt vmcnt(47)
    v_lshlrev_b32 v216, 16, v84
    v_and_b32 v217, s24, v84
    v_lshlrev_b32 v218, 16, v85
    v_and_b32 v219, s24, v85
    v_lshlrev_b32 v220, 16, v86
    v_and_b32 v221, s24, v86
    v_lshlrev_b32 v222, 16, v87
    v_and_b32 v223, s24, v87
    v_pk_add_f32 v[208:209], v[208:209], v[216:217]
    v_pk_add_f32 v[210:211], v[210:211], v[218:219]
    v_pk_add_f32 v[212:213], v[212:213], v[220:221]
    v_pk_add_f32 v[214:215], v[214:215], v[222:223]
    s_waitcnt vmcnt(46)
    v_lshlrev_b32 v216, 16, v88
    v_and_b32 v217, s24, v88
    v_lshlrev_b32 v218, 16, v89
    v_and_b32 v219, s24, v89
    v_lshlrev_b32 v220, 16, v90
    v_and_b32 v221, s24, v90
    v_lshlrev_b32 v222, 16, v91
    v_and_b32 v223, s24, v91
    v_pk_add_f32 v[208:209], v[208:209], v[216:217]
    v_pk_add_f32 v[210:211], v[210:211], v[218:219]
    v_pk_add_f32 v[212:213], v[212:213], v[220:221]
    v_pk_add_f32 v[214:215], v[214:215], v[222:223]
    s_waitcnt vmcnt(45)
    v_lshlrev_b32 v216, 16, v92
    v_and_b32 v217, s24, v92
    v_lshlrev_b32 v218, 16, v93
    v_and_b32 v219, s24, v93
    v_lshlrev_b32 v220, 16, v94
    v_and_b32 v221, s24, v94
    v_lshlrev_b32 v222, 16, v95
    v_and_b32 v223, s24, v95
    v_pk_add_f32 v[208:209], v[208:209], v[216:217]
    v_pk_add_f32 v[210:211], v[210:211], v[218:219]
    v_pk_add_f32 v[212:213], v[212:213], v[220:221]
    v_pk_add_f32 v[214:215], v[214:215], v[222:223]
    s_waitcnt vmcnt(44)
    v_lshlrev_b32 v216, 16, v96
    v_and_b32 v217, s24, v96
    v_lshlrev_b32 v218, 16, v97
    v_and_b32 v219, s24, v97
    v_lshlrev_b32 v220, 16, v98
    v_and_b32 v221, s24, v98
    v_lshlrev_b32 v222, 16, v99
    v_and_b32 v223, s24, v99
    v_pk_add_f32 v[208:209], v[208:209], v[216:217]
    v_pk_add_f32 v[210:211], v[210:211], v[218:219]
    v_pk_add_f32 v[212:213], v[212:213], v[220:221]
    v_pk_add_f32 v[214:215], v[214:215], v[222:223]
    s_waitcnt vmcnt(43)
    v_lshlrev_b32 v216, 16, v100
    v_and_b32 v217, s24, v100
    v_lshlrev_b32 v218, 16, v101
    v_and_b32 v219, s24, v101
    v_lshlrev_b32 v220, 16, v102
    v_and_b32 v221, s24, v102
    v_lshlrev_b32 v222, 16, v103
    v_and_b32 v223, s24, v103
    v_pk_add_f32 v[208:209], v[208:209], v[216:217]
    v_pk_add_f32 v[210:211], v[210:211], v[218:219]
    v_pk_add_f32 v[212:213], v[212:213], v[220:221]
    v_pk_add_f32 v[214:215], v[214:215], v[222:223]
    s_waitcnt vmcnt(42)
    v_lshlrev_b32 v216, 16, v104
    v_and_b32 v217, s24, v104
    v_lshlrev_b32 v218, 16, v105
    v_and_b32 v219, s24, v105
    v_lshlrev_b32 v220, 16, v106
    v_and_b32 v221, s24, v106
    v_lshlrev_b32 v222, 16, v107
    v_and_b32 v223, s24, v107
    v_pk_add_f32 v[208:209], v[208:209], v[216:217]
    v_pk_add_f32 v[210:211], v[210:211], v[218:219]
    v_pk_add_f32 v[212:213], v[212:213], v[220:221]
    v_pk_add_f32 v[214:215], v[214:215], v[222:223]
    s_waitcnt vmcnt(41)
    v_lshlrev_b32 v216, 16, v108
    v_and_b32 v217, s24, v108
    v_lshlrev_b32 v218, 16, v109
    v_and_b32 v219, s24, v109
    v_lshlrev_b32 v220, 16, v110
    v_and_b32 v221, s24, v110
    v_lshlrev_b32 v222, 16, v111
    v_and_b32 v223, s24, v111
    v_pk_add_f32 v[208:209], v[208:209], v[216:217]
    v_pk_add_f32 v[210:211], v[210:211], v[218:219]
    v_pk_add_f32 v[212:213], v[212:213], v[220:221]
    v_pk_add_f32 v[214:215], v[214:215], v[222:223]
    s_waitcnt vmcnt(40)
    v_lshlrev_b32 v216, 16, v112
    v_and_b32 v217, s24, v112
    v_lshlrev_b32 v218, 16, v113
    v_and_b32 v219, s24, v113
    v_lshlrev_b32 v220, 16, v114
    v_and_b32 v221, s24, v114
    v_lshlrev_b32 v222, 16, v115
    v_and_b32 v223, s24, v115
    v_pk_add_f32 v[208:209], v[208:209], v[216:217]
    v_pk_add_f32 v[210:211], v[210:211], v[218:219]
    v_pk_add_f32 v[212:213], v[212:213], v[220:221]
    v_pk_add_f32 v[214:215], v[214:215], v[222:223]
    s_waitcnt vmcnt(39)
    v_lshlrev_b32 v216, 16, v116
    v_and_b32 v217, s24, v116
    v_lshlrev_b32 v218, 16, v117
    v_and_b32 v219, s24, v117
    v_lshlrev_b32 v220, 16, v118
    v_and_b32 v221, s24, v118
    v_lshlrev_b32 v222, 16, v119
    v_and_b32 v223, s24, v119
    v_pk_add_f32 v[208:209], v[208:209], v[216:217]
    v_pk_add_f32 v[210:211], v[210:211], v[218:219]
    v_pk_add_f32 v[212:213], v[212:213], v[220:221]
    v_pk_add_f32 v[214:215], v[214:215], v[222:223]
    s_waitcnt vmcnt(38)
    v_lshlrev_b32 v216, 16, v120
    v_and_b32 v217, s24, v120
    v_lshlrev_b32 v218, 16, v121
    v_and_b32 v219, s24, v121
    v_lshlrev_b32 v220, 16, v122
    v_and_b32 v221, s24, v122
    v_lshlrev_b32 v222, 16, v123
    v_and_b32 v223, s24, v123
    v_pk_add_f32 v[208:209], v[208:209], v[216:217]
    v_pk_add_f32 v[210:211], v[210:211], v[218:219]
    v_pk_add_f32 v[212:213], v[212:213], v[220:221]
    v_pk_add_f32 v[214:215], v[214:215], v[222:223]
    s_waitcnt vmcnt(37)
    v_lshlrev_b32 v216, 16, v124
    v_and_b32 v217, s24, v124
    v_lshlrev_b32 v218, 16, v125
    v_and_b32 v219, s24, v125
    v_lshlrev_b32 v220, 16, v126
    v_and_b32 v221, s24, v126
    v_lshlrev_b32 v222, 16, v127
    v_and_b32 v223, s24, v127
    v_pk_add_f32 v[208:209], v[208:209], v[216:217]
    v_pk_add_f32 v[210:211], v[210:211], v[218:219]
    v_pk_add_f32 v[212:213], v[212:213], v[220:221]
    v_pk_add_f32 v[214:215], v[214:215], v[222:223]
    s_waitcnt vmcnt(36)
    v_lshlrev_b32 v216, 16, v128
    v_and_b32 v217, s24, v128
    v_lshlrev_b32 v218, 16, v129
    v_and_b32 v219, s24, v129
    v_lshlrev_b32 v220, 16, v130
    v_and_b32 v221, s24, v130
    v_lshlrev_b32 v222, 16, v131
    v_and_b32 v223, s24, v131
    v_pk_add_f32 v[208:209], v[208:209], v[216:217]
    v_pk_add_f32 v[210:211], v[210:211], v[218:219]
    v_pk_add_f32 v[212:213], v[212:213], v[220:221]
    v_pk_add_f32 v[214:215], v[214:215], v[222:223]
    s_waitcnt vmcnt(35)
    v_lshlrev_b32 v216, 16, v132
    v_and_b32 v217, s24, v132
    v_lshlrev_b32 v218, 16, v133
    v_and_b32 v219, s24, v133
    v_lshlrev_b32 v220, 16, v134
    v_and_b32 v221, s24, v134
    v_lshlrev_b32 v222, 16, v135
    v_and_b32 v223, s24, v135
    v_pk_add_f32 v[208:209], v[208:209], v[216:217]
    v_pk_add_f32 v[210:211], v[210:211], v[218:219]
    v_pk_add_f32 v[212:213], v[212:213], v[220:221]
    v_pk_add_f32 v[214:215], v[214:215], v[222:223]
    s_waitcnt vmcnt(34)
    v_lshlrev_b32 v216, 16, v136
    v_and_b32 v217, s24, v136
    v_lshlrev_b32 v218, 16, v137
    v_and_b32 v219, s24, v137
    v_lshlrev_b32 v220, 16, v138
    v_and_b32 v221, s24, v138
    v_lshlrev_b32 v222, 16, v139
    v_and_b32 v223, s24, v139
    v_pk_add_f32 v[208:209], v[208:209], v[216:217]
    v_pk_add_f32 v[210:211], v[210:211], v[218:219]
    v_pk_add_f32 v[212:213], v[212:213], v[220:221]
    v_pk_add_f32 v[214:215], v[214:215], v[222:223]
    s_waitcnt vmcnt(33)
    v_lshlrev_b32 v216, 16, v140
    v_and_b32 v217, s24, v140
    v_lshlrev_b32 v218, 16, v141
    v_and_b32 v219, s24, v141
    v_lshlrev_b32 v220, 16, v142
    v_and_b32 v221, s24, v142
    v_lshlrev_b32 v222, 16, v143
    v_and_b32 v223, s24, v143
    v_pk_add_f32 v[208:209], v[208:209], v[216:217]
    v_pk_add_f32 v[210:211], v[210:211], v[218:219]
    v_pk_add_f32 v[212:213], v[212:213], v[220:221]
    v_pk_add_f32 v[214:215], v[214:215], v[222:223]
    v_cvt_pk_bf16_f32 v216, v208, v209
    v_cvt_pk_bf16_f32 v217, v210, v211
    v_cvt_pk_bf16_f32 v218, v212, v213
    v_cvt_pk_bf16_f32 v219, v214, v215
    v_cndmask_b32 v228, v216, v218, vcc
    v_cndmask_b32 v229, v217, v219, vcc
    v_cndmask_b32 v230, v218, v216, vcc
    v_cndmask_b32 v231, v219, v217, vcc
    s_nop 1
    buffer_store_dwordx4 v[228:231], v9, s[28:31], s37 offen
    s_waitcnt vmcnt(33)
    v_lshlrev_b32 v208, 16, v144
    v_and_b32 v209, s24, v144
    v_lshlrev_b32 v210, 16, v145
    v_and_b32 v211, s24, v145
    v_lshlrev_b32 v212, 16, v146
    v_and_b32 v213, s24, v146
    v_lshlrev_b32 v214, 16, v147
    v_and_b32 v215, s24, v147
    s_waitcnt vmcnt(32)
    v_lshlrev_b32 v216, 16, v148
    v_and_b32 v217, s24, v148
    v_lshlrev_b32 v218, 16, v149
    v_and_b32 v219, s24, v149
    v_lshlrev_b32 v220, 16, v150
    v_and_b32 v221, s24, v150
    v_lshlrev_b32 v222, 16, v151
    v_and_b32 v223, s24, v151
    v_pk_add_f32 v[208:209], v[208:209], v[216:217]
    v_pk_add_f32 v[210:211], v[210:211], v[218:219]
    v_pk_add_f32 v[212:213], v[212:213], v[220:221]
    v_pk_add_f32 v[214:215], v[214:215], v[222:223]
    s_waitcnt vmcnt(31)
    v_lshlrev_b32 v216, 16, v152
    v_and_b32 v217, s24, v152
    v_lshlrev_b32 v218, 16, v153
    v_and_b32 v219, s24, v153
    v_lshlrev_b32 v220, 16, v154
    v_and_b32 v221, s24, v154
    v_lshlrev_b32 v222, 16, v155
    v_and_b32 v223, s24, v155
    v_pk_add_f32 v[208:209], v[208:209], v[216:217]
    v_pk_add_f32 v[210:211], v[210:211], v[218:219]
    v_pk_add_f32 v[212:213], v[212:213], v[220:221]
    v_pk_add_f32 v[214:215], v[214:215], v[222:223]
    s_waitcnt vmcnt(30)
    v_lshlrev_b32 v216, 16, v156
    v_and_b32 v217, s24, v156
    v_lshlrev_b32 v218, 16, v157
    v_and_b32 v219, s24, v157
    v_lshlrev_b32 v220, 16, v158
    v_and_b32 v221, s24, v158
    v_lshlrev_b32 v222, 16, v159
    v_and_b32 v223, s24, v159
    v_pk_add_f32 v[208:209], v[208:209], v[216:217]
    v_pk_add_f32 v[210:211], v[210:211], v[218:219]
    v_pk_add_f32 v[212:213], v[212:213], v[220:221]
    v_pk_add_f32 v[214:215], v[214:215], v[222:223]
    s_waitcnt vmcnt(29)
    v_lshlrev_b32 v216, 16, v160
    v_and_b32 v217, s24, v160
    v_lshlrev_b32 v218, 16, v161
    v_and_b32 v219, s24, v161
    v_lshlrev_b32 v220, 16, v162
    v_and_b32 v221, s24, v162
    v_lshlrev_b32 v222, 16, v163
    v_and_b32 v223, s24, v163
    v_pk_add_f32 v[208:209], v[208:209], v[216:217]
    v_pk_add_f32 v[210:211], v[210:211], v[218:219]
    v_pk_add_f32 v[212:213], v[212:213], v[220:221]
    v_pk_add_f32 v[214:215], v[214:215], v[222:223]
    s_waitcnt vmcnt(28)
    v_lshlrev_b32 v216, 16, v164
    v_and_b32 v217, s24, v164
    v_lshlrev_b32 v218, 16, v165
    v_and_b32 v219, s24, v165
    v_lshlrev_b32 v220, 16, v166
    v_and_b32 v221, s24, v166
    v_lshlrev_b32 v222, 16, v167
    v_and_b32 v223, s24, v167
    v_pk_add_f32 v[208:209], v[208:209], v[216:217]
    v_pk_add_f32 v[210:211], v[210:211], v[218:219]
    v_pk_add_f32 v[212:213], v[212:213], v[220:221]
    v_pk_add_f32 v[214:215], v[214:215], v[222:223]
    s_waitcnt vmcnt(27)
    v_lshlrev_b32 v216, 16, v168
    v_and_b32 v217, s24, v168
    v_lshlrev_b32 v218, 16, v169
    v_and_b32 v219, s24, v169
    v_lshlrev_b32 v220, 16, v170
    v_and_b32 v221, s24, v170
    v_lshlrev_b32 v222, 16, v171
    v_and_b32 v223, s24, v171
    v_pk_add_f32 v[208:209], v[208:209], v[216:217]
    v_pk_add_f32 v[210:211], v[210:211], v[218:219]
    v_pk_add_f32 v[212:213], v[212:213], v[220:221]
    v_pk_add_f32 v[214:215], v[214:215], v[222:223]
    s_waitcnt vmcnt(26)
    v_lshlrev_b32 v216, 16, v172
    v_and_b32 v217, s24, v172
    v_lshlrev_b32 v218, 16, v173
    v_and_b32 v219, s24, v173
    v_lshlrev_b32 v220, 16, v174
    v_and_b32 v221, s24, v174
    v_lshlrev_b32 v222, 16, v175
    v_and_b32 v223, s24, v175
    v_pk_add_f32 v[208:209], v[208:209], v[216:217]
    v_pk_add_f32 v[210:211], v[210:211], v[218:219]
    v_pk_add_f32 v[212:213], v[212:213], v[220:221]
    v_pk_add_f32 v[214:215], v[214:215], v[222:223]
    s_waitcnt vmcnt(25)
    v_lshlrev_b32 v216, 16, v176
    v_and_b32 v217, s24, v176
    v_lshlrev_b32 v218, 16, v177
    v_and_b32 v219, s24, v177
    v_lshlrev_b32 v220, 16, v178
    v_and_b32 v221, s24, v178
    v_lshlrev_b32 v222, 16, v179
    v_and_b32 v223, s24, v179
    v_pk_add_f32 v[208:209], v[208:209], v[216:217]
    v_pk_add_f32 v[210:211], v[210:211], v[218:219]
    v_pk_add_f32 v[212:213], v[212:213], v[220:221]
    v_pk_add_f32 v[214:215], v[214:215], v[222:223]
    s_waitcnt vmcnt(24)
    v_lshlrev_b32 v216, 16, v180
    v_and_b32 v217, s24, v180
    v_lshlrev_b32 v218, 16, v181
    v_and_b32 v219, s24, v181
    v_lshlrev_b32 v220, 16, v182
    v_and_b32 v221, s24, v182
    v_lshlrev_b32 v222, 16, v183
    v_and_b32 v223, s24, v183
    v_pk_add_f32 v[208:209], v[208:209], v[216:217]
    v_pk_add_f32 v[210:211], v[210:211], v[218:219]
    v_pk_add_f32 v[212:213], v[212:213], v[220:221]
    v_pk_add_f32 v[214:215], v[214:215], v[222:223]
    s_waitcnt vmcnt(23)
    v_lshlrev_b32 v216, 16, v184
    v_and_b32 v217, s24, v184
    v_lshlrev_b32 v218, 16, v185
    v_and_b32 v219, s24, v185
    v_lshlrev_b32 v220, 16, v186
    v_and_b32 v221, s24, v186
    v_lshlrev_b32 v222, 16, v187
    v_and_b32 v223, s24, v187
    v_pk_add_f32 v[208:209], v[208:209], v[216:217]
    v_pk_add_f32 v[210:211], v[210:211], v[218:219]
    v_pk_add_f32 v[212:213], v[212:213], v[220:221]
    v_pk_add_f32 v[214:215], v[214:215], v[222:223]
    s_waitcnt vmcnt(22)
    v_lshlrev_b32 v216, 16, v188
    v_and_b32 v217, s24, v188
    v_lshlrev_b32 v218, 16, v189
    v_and_b32 v219, s24, v189
    v_lshlrev_b32 v220, 16, v190
    v_and_b32 v221, s24, v190
    v_lshlrev_b32 v222, 16, v191
    v_and_b32 v223, s24, v191
    v_pk_add_f32 v[208:209], v[208:209], v[216:217]
    v_pk_add_f32 v[210:211], v[210:211], v[218:219]
    v_pk_add_f32 v[212:213], v[212:213], v[220:221]
    v_pk_add_f32 v[214:215], v[214:215], v[222:223]
    s_waitcnt vmcnt(21)
    v_lshlrev_b32 v216, 16, v192
    v_and_b32 v217, s24, v192
    v_lshlrev_b32 v218, 16, v193
    v_and_b32 v219, s24, v193
    v_lshlrev_b32 v220, 16, v194
    v_and_b32 v221, s24, v194
    v_lshlrev_b32 v222, 16, v195
    v_and_b32 v223, s24, v195
    v_pk_add_f32 v[208:209], v[208:209], v[216:217]
    v_pk_add_f32 v[210:211], v[210:211], v[218:219]
    v_pk_add_f32 v[212:213], v[212:213], v[220:221]
    v_pk_add_f32 v[214:215], v[214:215], v[222:223]
    s_waitcnt vmcnt(20)
    v_lshlrev_b32 v216, 16, v196
    v_and_b32 v217, s24, v196
    v_lshlrev_b32 v218, 16, v197
    v_and_b32 v219, s24, v197
    v_lshlrev_b32 v220, 16, v198
    v_and_b32 v221, s24, v198
    v_lshlrev_b32 v222, 16, v199
    v_and_b32 v223, s24, v199
    v_pk_add_f32 v[208:209], v[208:209], v[216:217]
    v_pk_add_f32 v[210:211], v[210:211], v[218:219]
    v_pk_add_f32 v[212:213], v[212:213], v[220:221]
    v_pk_add_f32 v[214:215], v[214:215], v[222:223]
    s_waitcnt vmcnt(19)
    v_lshlrev_b32 v216, 16, v200
    v_and_b32 v217, s24, v200
    v_lshlrev_b32 v218, 16, v201
    v_and_b32 v219, s24, v201
    v_lshlrev_b32 v220, 16, v202
    v_and_b32 v221, s24, v202
    v_lshlrev_b32 v222, 16, v203
    v_and_b32 v223, s24, v203
    v_pk_add_f32 v[208:209], v[208:209], v[216:217]
    v_pk_add_f32 v[210:211], v[210:211], v[218:219]
    v_pk_add_f32 v[212:213], v[212:213], v[220:221]
    v_pk_add_f32 v[214:215], v[214:215], v[222:223]
    s_waitcnt vmcnt(18)
    v_lshlrev_b32 v216, 16, v204
    v_and_b32 v217, s24, v204
    v_lshlrev_b32 v218, 16, v205
    v_and_b32 v219, s24, v205
    v_lshlrev_b32 v220, 16, v206
    v_and_b32 v221, s24, v206
    v_lshlrev_b32 v222, 16, v207
    v_and_b32 v223, s24, v207
    v_pk_add_f32 v[208:209], v[208:209], v[216:217]
    v_pk_add_f32 v[210:211], v[210:211], v[218:219]
    v_pk_add_f32 v[212:213], v[212:213], v[220:221]
    v_pk_add_f32 v[214:215], v[214:215], v[222:223]
    v_cvt_pk_bf16_f32 v216, v208, v209
    v_cvt_pk_bf16_f32 v217, v210, v211
    v_cvt_pk_bf16_f32 v218, v212, v213
    v_cvt_pk_bf16_f32 v219, v214, v215
    v_cndmask_b32 v232, v216, v218, vcc
    v_cndmask_b32 v233, v217, v219, vcc
    v_cndmask_b32 v234, v218, v216, vcc
    v_cndmask_b32 v235, v219, v217, vcc
    s_nop 1
    buffer_store_dwordx4 v[232:235], v9, s[28:31], s38 offen
    s_waitcnt vmcnt(17)
    v_lshlrev_b32 v208, 16, v16
    v_and_b32 v209, s24, v16
    v_lshlrev_b32 v210, 16, v17
    v_and_b32 v211, s24, v17
    v_lshlrev_b32 v212, 16, v18
    v_and_b32 v213, s24, v18
    v_lshlrev_b32 v214, 16, v19
    v_and_b32 v215, s24, v19
    s_waitcnt vmcnt(16)
    v_lshlrev_b32 v216, 16, v20
    v_and_b32 v217, s24, v20
    v_lshlrev_b32 v218, 16, v21
    v_and_b32 v219, s24, v21
    v_lshlrev_b32 v220, 16, v22
    v_and_b32 v221, s24, v22
    v_lshlrev_b32 v222, 16, v23
    v_and_b32 v223, s24, v23
    v_pk_add_f32 v[208:209], v[208:209], v[216:217]
    v_pk_add_f32 v[210:211], v[210:211], v[218:219]
    v_pk_add_f32 v[212:213], v[212:213], v[220:221]
    v_pk_add_f32 v[214:215], v[214:215], v[222:223]
    s_waitcnt vmcnt(15)
    v_lshlrev_b32 v216, 16, v24
    v_and_b32 v217, s24, v24
    v_lshlrev_b32 v218, 16, v25
    v_and_b32 v219, s24, v25
    v_lshlrev_b32 v220, 16, v26
    v_and_b32 v221, s24, v26
    v_lshlrev_b32 v222, 16, v27
    v_and_b32 v223, s24, v27
    v_pk_add_f32 v[208:209], v[208:209], v[216:217]
    v_pk_add_f32 v[210:211], v[210:211], v[218:219]
    v_pk_add_f32 v[212:213], v[212:213], v[220:221]
    v_pk_add_f32 v[214:215], v[214:215], v[222:223]
    s_waitcnt vmcnt(14)
    v_lshlrev_b32 v216, 16, v28
    v_and_b32 v217, s24, v28
    v_lshlrev_b32 v218, 16, v29
    v_and_b32 v219, s24, v29
    v_lshlrev_b32 v220, 16, v30
    v_and_b32 v221, s24, v30
    v_lshlrev_b32 v222, 16, v31
    v_and_b32 v223, s24, v31
    v_pk_add_f32 v[208:209], v[208:209], v[216:217]
    v_pk_add_f32 v[210:211], v[210:211], v[218:219]
    v_pk_add_f32 v[212:213], v[212:213], v[220:221]
    v_pk_add_f32 v[214:215], v[214:215], v[222:223]
    s_waitcnt vmcnt(13)
    v_lshlrev_b32 v216, 16, v32
    v_and_b32 v217, s24, v32
    v_lshlrev_b32 v218, 16, v33
    v_and_b32 v219, s24, v33
    v_lshlrev_b32 v220, 16, v34
    v_and_b32 v221, s24, v34
    v_lshlrev_b32 v222, 16, v35
    v_and_b32 v223, s24, v35
    v_pk_add_f32 v[208:209], v[208:209], v[216:217]
    v_pk_add_f32 v[210:211], v[210:211], v[218:219]
    v_pk_add_f32 v[212:213], v[212:213], v[220:221]
    v_pk_add_f32 v[214:215], v[214:215], v[222:223]
    s_waitcnt vmcnt(12)
    v_lshlrev_b32 v216, 16, v36
    v_and_b32 v217, s24, v36
    v_lshlrev_b32 v218, 16, v37
    v_and_b32 v219, s24, v37
    v_lshlrev_b32 v220, 16, v38
    v_and_b32 v221, s24, v38
    v_lshlrev_b32 v222, 16, v39
    v_and_b32 v223, s24, v39
    v_pk_add_f32 v[208:209], v[208:209], v[216:217]
    v_pk_add_f32 v[210:211], v[210:211], v[218:219]
    v_pk_add_f32 v[212:213], v[212:213], v[220:221]
    v_pk_add_f32 v[214:215], v[214:215], v[222:223]
    s_waitcnt vmcnt(11)
    v_lshlrev_b32 v216, 16, v40
    v_and_b32 v217, s24, v40
    v_lshlrev_b32 v218, 16, v41
    v_and_b32 v219, s24, v41
    v_lshlrev_b32 v220, 16, v42
    v_and_b32 v221, s24, v42
    v_lshlrev_b32 v222, 16, v43
    v_and_b32 v223, s24, v43
    v_pk_add_f32 v[208:209], v[208:209], v[216:217]
    v_pk_add_f32 v[210:211], v[210:211], v[218:219]
    v_pk_add_f32 v[212:213], v[212:213], v[220:221]
    v_pk_add_f32 v[214:215], v[214:215], v[222:223]
    s_waitcnt vmcnt(10)
    v_lshlrev_b32 v216, 16, v44
    v_and_b32 v217, s24, v44
    v_lshlrev_b32 v218, 16, v45
    v_and_b32 v219, s24, v45
    v_lshlrev_b32 v220, 16, v46
    v_and_b32 v221, s24, v46
    v_lshlrev_b32 v222, 16, v47
    v_and_b32 v223, s24, v47
    v_pk_add_f32 v[208:209], v[208:209], v[216:217]
    v_pk_add_f32 v[210:211], v[210:211], v[218:219]
    v_pk_add_f32 v[212:213], v[212:213], v[220:221]
    v_pk_add_f32 v[214:215], v[214:215], v[222:223]
    s_waitcnt vmcnt(9)
    v_lshlrev_b32 v216, 16, v48
    v_and_b32 v217, s24, v48
    v_lshlrev_b32 v218, 16, v49
    v_and_b32 v219, s24, v49
    v_lshlrev_b32 v220, 16, v50
    v_and_b32 v221, s24, v50
    v_lshlrev_b32 v222, 16, v51
    v_and_b32 v223, s24, v51
    v_pk_add_f32 v[208:209], v[208:209], v[216:217]
    v_pk_add_f32 v[210:211], v[210:211], v[218:219]
    v_pk_add_f32 v[212:213], v[212:213], v[220:221]
    v_pk_add_f32 v[214:215], v[214:215], v[222:223]
    s_waitcnt vmcnt(8)
    v_lshlrev_b32 v216, 16, v52
    v_and_b32 v217, s24, v52
    v_lshlrev_b32 v218, 16, v53
    v_and_b32 v219, s24, v53
    v_lshlrev_b32 v220, 16, v54
    v_and_b32 v221, s24, v54
    v_lshlrev_b32 v222, 16, v55
    v_and_b32 v223, s24, v55
    v_pk_add_f32 v[208:209], v[208:209], v[216:217]
    v_pk_add_f32 v[210:211], v[210:211], v[218:219]
    v_pk_add_f32 v[212:213], v[212:213], v[220:221]
    v_pk_add_f32 v[214:215], v[214:215], v[222:223]
    s_waitcnt vmcnt(7)
    v_lshlrev_b32 v216, 16, v56
    v_and_b32 v217, s24, v56
    v_lshlrev_b32 v218, 16, v57
    v_and_b32 v219, s24, v57
    v_lshlrev_b32 v220, 16, v58
    v_and_b32 v221, s24, v58
    v_lshlrev_b32 v222, 16, v59
    v_and_b32 v223, s24, v59
    v_pk_add_f32 v[208:209], v[208:209], v[216:217]
    v_pk_add_f32 v[210:211], v[210:211], v[218:219]
    v_pk_add_f32 v[212:213], v[212:213], v[220:221]
    v_pk_add_f32 v[214:215], v[214:215], v[222:223]
    s_waitcnt vmcnt(6)
    v_lshlrev_b32 v216, 16, v60
    v_and_b32 v217, s24, v60
    v_lshlrev_b32 v218, 16, v61
    v_and_b32 v219, s24, v61
    v_lshlrev_b32 v220, 16, v62
    v_and_b32 v221, s24, v62
    v_lshlrev_b32 v222, 16, v63
    v_and_b32 v223, s24, v63
    v_pk_add_f32 v[208:209], v[208:209], v[216:217]
    v_pk_add_f32 v[210:211], v[210:211], v[218:219]
    v_pk_add_f32 v[212:213], v[212:213], v[220:221]
    v_pk_add_f32 v[214:215], v[214:215], v[222:223]
    s_waitcnt vmcnt(5)
    v_lshlrev_b32 v216, 16, v64
    v_and_b32 v217, s24, v64
    v_lshlrev_b32 v218, 16, v65
    v_and_b32 v219, s24, v65
    v_lshlrev_b32 v220, 16, v66
    v_and_b32 v221, s24, v66
    v_lshlrev_b32 v222, 16, v67
    v_and_b32 v223, s24, v67
    v_pk_add_f32 v[208:209], v[208:209], v[216:217]
    v_pk_add_f32 v[210:211], v[210:211], v[218:219]
    v_pk_add_f32 v[212:213], v[212:213], v[220:221]
    v_pk_add_f32 v[214:215], v[214:215], v[222:223]
    s_waitcnt vmcnt(4)
    v_lshlrev_b32 v216, 16, v68
    v_and_b32 v217, s24, v68
    v_lshlrev_b32 v218, 16, v69
    v_and_b32 v219, s24, v69
    v_lshlrev_b32 v220, 16, v70
    v_and_b32 v221, s24, v70
    v_lshlrev_b32 v222, 16, v71
    v_and_b32 v223, s24, v71
    v_pk_add_f32 v[208:209], v[208:209], v[216:217]
    v_pk_add_f32 v[210:211], v[210:211], v[218:219]
    v_pk_add_f32 v[212:213], v[212:213], v[220:221]
    v_pk_add_f32 v[214:215], v[214:215], v[222:223]
    s_waitcnt vmcnt(3)
    v_lshlrev_b32 v216, 16, v72
    v_and_b32 v217, s24, v72
    v_lshlrev_b32 v218, 16, v73
    v_and_b32 v219, s24, v73
    v_lshlrev_b32 v220, 16, v74
    v_and_b32 v221, s24, v74
    v_lshlrev_b32 v222, 16, v75
    v_and_b32 v223, s24, v75
    v_pk_add_f32 v[208:209], v[208:209], v[216:217]
    v_pk_add_f32 v[210:211], v[210:211], v[218:219]
    v_pk_add_f32 v[212:213], v[212:213], v[220:221]
    v_pk_add_f32 v[214:215], v[214:215], v[222:223]
    s_waitcnt vmcnt(2)
    v_lshlrev_b32 v216, 16, v76
    v_and_b32 v217, s24, v76
    v_lshlrev_b32 v218, 16, v77
    v_and_b32 v219, s24, v77
    v_lshlrev_b32 v220, 16, v78
    v_and_b32 v221, s24, v78
    v_lshlrev_b32 v222, 16, v79
    v_and_b32 v223, s24, v79
    v_pk_add_f32 v[208:209], v[208:209], v[216:217]
    v_pk_add_f32 v[210:211], v[210:211], v[218:219]
    v_pk_add_f32 v[212:213], v[212:213], v[220:221]
    v_pk_add_f32 v[214:215], v[214:215], v[222:223]
    v_cvt_pk_bf16_f32 v216, v208, v209
    v_cvt_pk_bf16_f32 v217, v210, v211
    v_cvt_pk_bf16_f32 v218, v212, v213
    v_cvt_pk_bf16_f32 v219, v214, v215
    v_cndmask_b32 v236, v216, v218, vcc
    v_cndmask_b32 v237, v217, v219, vcc
    v_cndmask_b32 v238, v218, v216, vcc
    v_cndmask_b32 v239, v219, v217, vcc
    s_nop 1
    buffer_store_dwordx4 v[236:239], v9, s[28:31], s39 offen
    s_branch L3_loop
L3_next:
    s_cmp_lg_u32 s25, 0
    s_cbranch_scc1 L_fin
    s_mov_b32 s25, 1
    v_mov_b32 v5, 161792
L3_go:
    ds_read_b32 v6, v5 offset:8
    s_waitcnt lgkmcnt(0)
    v_readfirstlane_b32 s16, v6
    s_nop 1
    s_bitcmp1_b32 s16, 31
    s_cbranch_scc1 L3_got
    s_sleep 2
    s_branch L3_go
L3_got:
    s_and_b32 s16, s16, 0xffff
    s_andn2_b32 s16, s16, s26
    s_branch L3_loop
L_done:
    s_waitcnt vmcnt(0) lgkmcnt(0)
    s_mov_b64 exec, 1
    ds_add_u32 v156, v157 offset:4
    s_cmp_lg_u32 s66, 0
    s_cbranch_scc1 L_spin
L_a1:
    ds_read_b32 v6, v156 offset:4
    s_waitcnt lgkmcnt(0)
    v_readfirstlane_b32 s3, v6
    s_nop 1
    s_cmp_eq_u32 s3, 4
    s_cbranch_scc0 L_a1
    ds_read_b64 v[164:165], v156 offset:16
    s_lshl_b32 s16, 1, s34
    s_movk_i32 s17, 1000
    v_add_u32 v167, 4096, v167
    s_waitcnt lgkmcnt(0)
    global_store_dwordx2 v167, v[164:165], s[14:15] sc1
    v_readfirstlane_b32 s20, v164
    v_readfirstlane_b32 s21, v165
    s_mov_b64 exec, 0xffff
    v_mov_b32 v164, s20
    v_mov_b32 v165, s21
    v_add_u32 v166, 4096, v166
    s_waitcnt vmcnt(0)
L_poll:
    global_load_dwordx2 v[6:7], v166, s[14:15] sc1
    global_load_dword v4, v158, s[10:11] offset:8 sc1
    s_waitcnt vmcnt(0)
    v_cmp_eq_u64 vcc, v[6:7], v[164:165]
    v_readfirstlane_b32 s3, v4
    s_nop 1
    s_cmp_eq_u32 vcc_lo, 0xffff
    s_cbranch_scc1 L_all
    s_sub_u32 s17, s17, 1
    s_cmp_lg_u32 s17, 0
    s_cbranch_scc1 L_poll
    v_mov_b32 v4, s16
    s_mov_b64 exec, 1
    global_atomic_or v5, v158, v4, s[10:11] offset:8 sc0
    s_waitcnt vmcnt(0)
    s_mov_b64 exec, 0xffff
    global_load_dwordx2 v[6:7], v166, s[14:15] sc1
    s_waitcnt vmcnt(0)
    v_cmp_eq_u64 vcc, v[6:7], v[164:165]
    s_nop 1
    s_cmp_eq_u32 vcc_lo, 0xffff
    s_cselect_b32 s16, s16, 0
    s_mov_b64 exec, 1
    s_branch L_bc
L_all:
    s_or_b32 s16, s16, s3
    s_mov_b64 exec, 1
L_bc:
    s_or_b32 s3, s16, 0x80000000
    v_mov_b32 v4, s3
    s_nop 0
    ds_write_b32 v156, v4 offset:8
    s_branch L_go
L_spin:
    ds_read_b32 v6, v156 offset:12
    s_waitcnt lgkmcnt(0)
    v_readfirstlane_b32 s16, v6
    s_nop 1
    s_bitcmp1_b32 s16, 31
    s_cbranch_scc1 L_s0got
    s_sleep 1
    s_branch L_spin
L_s0got:
    s_and_b32 s16, s16, 0xffff
    s_cmp_eq_u32 s16, 0
    s_cbranch_scc1 L_spin1
    s_cmp_ge_u32 s34, 14
    s_cbranch_scc1 L_spin1
    s_mov_b64 exec, -1
    s_lshl_b32 s27, s34, 2
    s_add_u32 s27, s27, s66
    s_add_u32 s27, s27, 1
    v_lshrrev_b32 v8, 4, v0
    v_and_b32 v9, 15, v8
    v_bfe_u32 v11, v8, 4, 2
    v_lshlrev_b32 v11, 4, v11
    v_mul_u32_u24 v9, 1792, v9
    v_add_u32 v9, v9, v11
    v_and_b32 v12, 16, v8
    v_cmp_ne_u32 vcc, 0, v12
    s_mov_b32 s28, s8
    s_and_b32 s29, s9, 0xffff
    s_mov_b32 s30, 1605632
    s_mov_b32 s31, 0x20000
    s_mov_b32 s24, 0xffff0000
    s_mul_i32 s3, s27, 37
    s_lshr_b32 s3, s3, 9
    s_mul_i32 s4, s3, 14
    s_sub_u32 s4, s27, s4
    s_mul_i32 s20, s3, 28672
    s_lshl_b32 s7, s4, 10
    s_add_u32 s20, s20, s7
    s_lshl_b32 s36, s3, 8
    s_and_b32 s7, s4, 1
    s_lshl_b32 s7, s7, 6
    s_add_u32 s36, s36, s7
    s_lshr_b32 s7, s4, 1
    s_mul_i32 s7, s7, 28672
    s_add_u32 s36, s36, s7
    s_add_u32 s36, s36, s33
    buffer_load_dwordx4 v[16:19], v0, s[48:51], s20 offen sc1
    s_add_u32 s20, s20, 100352
    buffer_load_dwordx4 v[20:23], v0, s[48:51], s20 offen sc1
    s_add_u32 s20, s20, 100352
    buffer_load_dwordx4 v[24:27], v0, s[48:51], s20 offen sc1
    s_add_u32 s20, s20, 100352
    buffer_load_dwordx4 v[28:31], v0, s[48:51], s20 offen sc1
    s_add_u32 s20, s20, 100352
    buffer_load_dwordx4 v[32:35], v0, s[48:51], s20 offen sc1
    s_add_u32 s20, s20, 100352
    buffer_load_dwordx4 v[36:39], v0, s[48:51], s20 offen sc1
    s_add_u32 s20, s20, 100352
    buffer_load_dwordx4 v[40:43], v0, s[48:51], s20 offen sc1
    s_add_u32 s20, s20, 100352
    buffer_load_dwordx4 v[44:47], v0, s[48:51], s20 offen sc1
    s_add_u32 s20, s20, 100352
    buffer_load_dwordx4 v[48:51], v0, s[48:51], s20 offen sc1
    s_add_u32 s20, s20, 100352
    buffer_load_dwordx4 v[52:55], v0, s[48:51], s20 offen sc1
    s_add_u32 s20, s20, 100352
    buffer_load_dwordx4 v[56:59], v0, s[48:51], s20 offen sc1
    s_add_u32 s20, s20, 100352
    buffer_load_dwordx4 v[60:63], v0, s[48:51], s20 offen sc1
    s_add_u32 s20, s20, 100352
    buffer_load_dwordx4 v[64:67], v0, s[48:51], s20 offen sc1
    s_add_u32 s20, s20, 100352
    buffer_load_dwordx4 v[68:71], v0, s[48:51], s20 offen sc1
    s_add_u32 s20, s20, 100352
    buffer_load_dwordx4 v[72:75], v0, s[48:51], s20 offen sc1
    s_add_u32 s20, s20, 100352
    buffer_load_dwordx4 v[76:79], v0, s[48:51], s20 offen sc1
    s_waitcnt vmcnt(15)
    v_lshlrev_b32 v208, 16, v16
    v_and_b32 v209, s24, v16
    v_lshlrev_b32 v210, 16, v17
    v_and_b32 v211, s24, v17
    v_lshlrev_b32 v212, 16, v18
    v_and_b32 v213, s24, v18
    v_lshlrev_b32 v214, 16, v19
    v_and_b32 v215, s24, v19
    s_waitcnt vmcnt(14)
    v_lshlrev_b32 v216, 16, v20
    v_and_b32 v217, s24, v20
    v_lshlrev_b32 v218, 16, v21
    v_and_b32 v219, s24, v21
    v_lshlrev_b32 v220, 16, v22
    v_and_b32 v221, s24, v22
    v_lshlrev_b32 v222, 16, v23
    v_and_b32 v223, s24, v23
    v_pk_add_f32 v[208:209], v[208:209], v[216:217]
    v_pk_add_f32 v[210:211], v[210:211], v[218:219]
    v_pk_add_f32 v[212:213], v[212:213], v[220:221]
    v_pk_add_f32 v[214:215], v[214:215], v[222:223]
    s_waitcnt vmcnt(13)
    v_lshlrev_b32 v216, 16, v24
    v_and_b32 v217, s24, v24
    v_lshlrev_b32 v218, 16, v25
    v_and_b32 v219, s24, v25
    v_lshlrev_b32 v220, 16, v26
    v_and_b32 v221, s24, v26
    v_lshlrev_b32 v222, 16, v27
    v_and_b32 v223, s24, v27
    v_pk_add_f32 v[208:209], v[208:209], v[216:217]
    v_pk_add_f32 v[210:211], v[210:211], v[218:219]
    v_pk_add_f32 v[212:213], v[212:213], v[220:221]
    v_pk_add_f32 v[214:215], v[214:215], v[222:223]
    s_waitcnt vmcnt(12)
    v_lshlrev_b32 v216, 16, v28
    v_and_b32 v217, s24, v28
    v_lshlrev_b32 v218, 16, v29
    v_and_b32 v219, s24, v29
    v_lshlrev_b32 v220, 16, v30
    v_and_b32 v221, s24, v30
    v_lshlrev_b32 v222, 16, v31
    v_and_b32 v223, s24, v31
    v_pk_add_f32 v[208:209], v[208:209], v[216:217]
    v_pk_add_f32 v[210:211], v[210:211], v[218:219]
    v_pk_add_f32 v[212:213], v[212:213], v[220:221]
    v_pk_add_f32 v[214:215], v[214:215], v[222:223]
    s_waitcnt vmcnt(11)
    v_lshlrev_b32 v216, 16, v32
    v_and_b32 v217, s24, v32
    v_lshlrev_b32 v218, 16, v33
    v_and_b32 v219, s24, v33
    v_lshlrev_b32 v220, 16, v34
    v_and_b32 v221, s24, v34
    v_lshlrev_b32 v222, 16, v35
    v_and_b32 v223, s24, v35
    v_pk_add_f32 v[208:209], v[208:209], v[216:217]
    v_pk_add_f32 v[210:211], v[210:211], v[218:219]
    v_pk_add_f32 v[212:213], v[212:213], v[220:221]
    v_pk_add_f32 v[214:215], v[214:215], v[222:223]
    s_waitcnt vmcnt(10)
    v_lshlrev_b32 v216, 16, v36
    v_and_b32 v217, s24, v36
    v_lshlrev_b32 v218, 16, v37
    v_and_b32 v219, s24, v37
    v_lshlrev_b32 v220, 16, v38
    v_and_b32 v221, s24, v38
    v_lshlrev_b32 v222, 16, v39
    v_and_b32 v223, s24, v39
    v_pk_add_f32 v[208:209], v[208:209], v[216:217]
    v_pk_add_f32 v[210:211], v[210:211], v[218:219]
    v_pk_add_f32 v[212:213], v[212:213], v[220:221]
    v_pk_add_f32 v[214:215], v[214:215], v[222:223]
    s_waitcnt vmcnt(9)
    v_lshlrev_b32 v216, 16, v40
    v_and_b32 v217, s24, v40
    v_lshlrev_b32 v218, 16, v41
    v_and_b32 v219, s24, v41
    v_lshlrev_b32 v220, 16, v42
    v_and_b32 v221, s24, v42
    v_lshlrev_b32 v222, 16, v43
    v_and_b32 v223, s24, v43
    v_pk_add_f32 v[208:209], v[208:209], v[216:217]
    v_pk_add_f32 v[210:211], v[210:211], v[218:219]
    v_pk_add_f32 v[212:213], v[212:213], v[220:221]
    v_pk_add_f32 v[214:215], v[214:215], v[222:223]
    s_waitcnt vmcnt(8)
    v_lshlrev_b32 v216, 16, v44
    v_and_b32 v217, s24, v44
    v_lshlrev_b32 v218, 16, v45
    v_and_b32 v219, s24, v45
    v_lshlrev_b32 v220, 16, v46
    v_and_b32 v221, s24, v46
    v_lshlrev_b32 v222, 16, v47
    v_and_b32 v223, s24, v47
    v_pk_add_f32 v[208:209], v[208:209], v[216:217]
    v_pk_add_f32 v[210:211], v[210:211], v[218:219]
    v_pk_add_f32 v[212:213], v[212:213], v[220:221]
    v_pk_add_f32 v[214:215], v[214:215], v[222:223]
    s_waitcnt vmcnt(7)
    v_lshlrev_b32 v216, 16, v48
    v_and_b32 v217, s24, v48
    v_lshlrev_b32 v218, 16, v49
    v_and_b32 v219, s24, v49
    v_lshlrev_b32 v220, 16, v50
    v_and_b32 v221, s24, v50
    v_lshlrev_b32 v222, 16, v51
    v_and_b32 v223, s24, v51
    v_pk_add_f32 v[208:209], v[208:209], v[216:217]
    v_pk_add_f32 v[210:211], v[210:211], v[218:219]
    v_pk_add_f32 v[212:213], v[212:213], v[220:221]
    v_pk_add_f32 v[214:215], v[214:215], v[222:223]
    s_waitcnt vmcnt(6)
    v_lshlrev_b32 v216, 16, v52
    v_and_b32 v217, s24, v52
    v_lshlrev_b32 v218, 16, v53
    v_and_b32 v219, s24, v53
    v_lshlrev_b32 v220, 16, v54
    v_and_b32 v221, s24, v54
    v_lshlrev_b32 v222, 16, v55
    v_and_b32 v223, s24, v55
    v_pk_add_f32 v[208:209], v[208:209], v[216:217]
    v_pk_add_f32 v[210:211], v[210:211], v[218:219]
    v_pk_add_f32 v[212:213], v[212:213], v[220:221]
    v_pk_add_f32 v[214:215], v[214:215], v[222:223]
    s_waitcnt vmcnt(5)
    v_lshlrev_b32 v216, 16, v56
    v_and_b32 v217, s24, v56
    v_lshlrev_b32 v218, 16, v57
    v_and_b32 v219, s24, v57
    v_lshlrev_b32 v220, 16, v58
    v_and_b32 v221, s24, v58
    v_lshlrev_b32 v222, 16, v59
    v_and_b32 v223, s24, v59
    v_pk_add_f32 v[208:209], v[208:209], v[216:217]
    v_pk_add_f32 v[210:211], v[210:211], v[218:219]
    v_pk_add_f32 v[212:213], v[212:213], v[220:221]
    v_pk_add_f32 v[214:215], v[214:215], v[222:223]
    s_waitcnt vmcnt(4)
    v_lshlrev_b32 v216, 16, v60
    v_and_b32 v217, s24, v60
    v_lshlrev_b32 v218, 16, v61
    v_and_b32 v219, s24, v61
    v_lshlrev_b32 v220, 16, v62
    v_and_b32 v221, s24, v62
    v_lshlrev_b32 v222, 16, v63
    v_and_b32 v223, s24, v63
    v_pk_add_f32 v[208:209], v[208:209], v[216:217]
    v_pk_add_f32 v[210:211], v[210:211], v[218:219]
    v_pk_add_f32 v[212:213], v[212:213], v[220:221]
    v_pk_add_f32 v[214:215], v[214:215], v[222:223]
    s_waitcnt vmcnt(3)
    v_lshlrev_b32 v216, 16, v64
    v_and_b32 v217, s24, v64
    v_lshlrev_b32 v218, 16, v65
    v_and_b32 v219, s24, v65
    v_lshlrev_b32 v220, 16, v66
    v_and_b32 v221, s24, v66
    v_lshlrev_b32 v222, 16, v67
    v_and_b32 v223, s24, v67
    v_pk_add_f32 v[208:209], v[208:209], v[216:217]
    v_pk_add_f32 v[210:211], v[210:211], v[218:219]
    v_pk_add_f32 v[212:213], v[212:213], v[220:221]
    v_pk_add_f32 v[214:215], v[214:215], v[222:223]
    s_waitcnt vmcnt(2)
    v_lshlrev_b32 v216, 16, v68
    v_and_b32 v217, s24, v68
    v_lshlrev_b32 v218, 16, v69
    v_and_b32 v219, s24, v69
    v_lshlrev_b32 v220, 16, v70
    v_and_b32 v221, s24, v70
    v_lshlrev_b32 v222, 16, v71
    v_and_b32 v223, s24, v71
    v_pk_add_f32 v[208:209], v[208:209], v[216:217]
    v_pk_add_f32 v[210:211], v[210:211], v[218:219]
    v_pk_add_f32 v[212:213], v[212:213], v[220:221]
    v_pk_add_f32 v[214:215], v[214:215], v[222:223]
    s_waitcnt vmcnt(1)
    v_lshlrev_b32 v216, 16, v72
    v_and_b32 v217, s24, v72
    v_lshlrev_b32 v218, 16, v73
    v_and_b32 v219, s24, v73
    v_lshlrev_b32 v220, 16, v74
    v_and_b32 v221, s24, v74
    v_lshlrev_b32 v222, 16, v75
    v_and_b32 v223, s24, v75
    v_pk_add_f32 v[208:209], v[208:209], v[216:217]
    v_pk_add_f32 v[210:211], v[210:211], v[218:219]
    v_pk_add_f32 v[212:213], v[212:213], v[220:221]
    v_pk_add_f32 v[214:215], v[214:215], v[222:223]
    s_waitcnt vmcnt(0)
    v_lshlrev_b32 v216, 16, v76
    v_and_b32 v217, s24, v76
    v_lshlrev_b32 v218, 16, v77
    v_and_b32 v219, s24, v77
    v_lshlrev_b32 v220, 16, v78
    v_and_b32 v221, s24, v78
    v_lshlrev_b32 v222, 16, v79
    v_and_b32 v223, s24, v79
    v_pk_add_f32 v[208:209], v[208:209], v[216:217]
    v_pk_add_f32 v[210:211], v[210:211], v[218:219]
    v_pk_add_f32 v[212:213], v[212:213], v[220:221]
    v_pk_add_f32 v[214:215], v[214:215], v[222:223]
    v_cvt_pk_bf16_f32 v216, v208, v209
    v_cvt_pk_bf16_f32 v217, v210, v211
    v_cvt_pk_bf16_f32 v218, v212, v213
    v_cvt_pk_bf16_f32 v219, v214, v215
    v_cndmask_b32 v228, v216, v218, vcc
    v_cndmask_b32 v229, v217, v219, vcc
    v_cndmask_b32 v230, v218, v216, vcc
    v_cndmask_b32 v231, v219, v217, vcc
    s_nop 1
    buffer_store_dwordx4 v[228:231], v9, s[28:31], s36 offen
    s_mov_b64 exec, 1
L_spin1:
    ds_read_b32 v6, v156 offset:8
    s_waitcnt lgkmcnt(0)
    v_readfirstlane_b32 s16, v6
    s_nop 1
    s_bitcmp1_b32 s16, 31
    s_cbranch_scc1 L_sgot
    s_sleep 1
    s_branch L_spin1
L_sgot:
    s_and_b32 s16, s16, 0xffff
L_go:
    s_mov_b64 exec, -1
    v_lshrrev_b32 v8, 4, v0
    v_and_b32 v9, 15, v8
    v_bfe_u32 v11, v8, 4, 2
    v_lshlrev_b32 v11, 4, v11
    v_mul_u32_u24 v9, 1792, v9
    v_add_u32 v9, v9, v11
    v_and_b32 v12, 16, v8
    v_cmp_ne_u32 vcc, 0, v12
    s_mov_b32 s28, s8
    s_and_b32 s29, s9, 0xffff
    s_mov_b32 s30, 1605632
    s_mov_b32 s31, 0x20000
    s_mov_b32 s24, 0xffff0000
L_piece:
    s_cmp_eq_u32 s16, 0
    s_cbranch_scc1 L_fin
    s_ff1_i32_b32 s17, s16
    s_bitset0_b32 s16, s17
    s_cmp_ge_u32 s17, 14
    s_cbranch_scc1 L_piece
    s_mul_i32 s27, s17, 3
    s_add_u32 s27, s27, s66
    s_mul_i32 s3, s27, 37
    s_lshr_b32 s3, s3, 9
    s_mul_i32 s4, s3, 14
    s_sub_u32 s4, s27, s4
    s_mul_i32 s20, s3, 28672
    s_lshl_b32 s7, s4, 10
    s_add_u32 s20, s20, s7
    s_add_u32 s20, s20, 14336
    s_lshl_b32 s36, s3, 8
    s_and_b32 s7, s4, 1
    s_lshl_b32 s7, s7, 6
    s_add_u32 s36, s36, s7
    s_lshr_b32 s7, s4, 1
    s_mul_i32 s7, s7, 28672
    s_add_u32 s36, s36, s7
    s_add_u32 s36, s36, s33
    s_add_u32 s36, s36, 128
    buffer_load_dwordx4 v[16:19], v0, s[48:51], s20 offen sc1
    s_add_u32 s20, s20, 100352
    buffer_load_dwordx4 v[20:23], v0, s[48:51], s20 offen sc1
    s_add_u32 s20, s20, 100352
    buffer_load_dwordx4 v[24:27], v0, s[48:51], s20 offen sc1
    s_add_u32 s20, s20, 100352
    buffer_load_dwordx4 v[28:31], v0, s[48:51], s20 offen sc1
    s_add_u32 s20, s20, 100352
    buffer_load_dwordx4 v[32:35], v0, s[48:51], s20 offen sc1
    s_add_u32 s20, s20, 100352
    buffer_load_dwordx4 v[36:39], v0, s[48:51], s20 offen sc1
    s_add_u32 s20, s20, 100352
    buffer_load_dwordx4 v[40:43], v0, s[48:51], s20 offen sc1
    s_add_u32 s20, s20, 100352
    buffer_load_dwordx4 v[44:47], v0, s[48:51], s20 offen sc1
    s_add_u32 s20, s20, 100352
    buffer_load_dwordx4 v[48:51], v0, s[48:51], s20 offen sc1
    s_add_u32 s20, s20, 100352
    buffer_load_dwordx4 v[52:55], v0, s[48:51], s20 offen sc1
    s_add_u32 s20, s20, 100352
    buffer_load_dwordx4 v[56:59], v0, s[48:51], s20 offen sc1
    s_add_u32 s20, s20, 100352
    buffer_load_dwordx4 v[60:63], v0, s[48:51], s20 offen sc1
    s_add_u32 s20, s20, 100352
    buffer_load_dwordx4 v[64:67], v0, s[48:51], s20 offen sc1
    s_add_u32 s20, s20, 100352
    buffer_load_dwordx4 v[68:71], v0, s[48:51], s20 offen sc1
    s_add_u32 s20, s20, 100352
    buffer_load_dwordx4 v[72:75], v0, s[48:51], s20 offen sc1
    s_add_u32 s20, s20, 100352
    buffer_load_dwordx4 v[76:79], v0, s[48:51], s20 offen sc1
    s_waitcnt vmcnt(15)
    v_lshlrev_b32 v208, 16, v16
    v_and_b32 v209, s24, v16
    v_lshlrev_b32 v210, 16, v17
    v_and_b32 v211, s24, v17
    v_lshlrev_b32 v212, 16, v18
    v_and_b32 v213, s24, v18
    v_lshlrev_b32 v214, 16, v19
    v_and_b32 v215, s24, v19
    s_waitcnt vmcnt(14)
    v_lshlrev_b32 v216, 16, v20
    v_and_b32 v217, s24, v20
    v_lshlrev_b32 v218, 16, v21
    v_and_b32 v219, s24, v21
    v_lshlrev_b32 v220, 16, v22
    v_and_b32 v221, s24, v22
    v_lshlrev_b32 v222, 16, v23
    v_and_b32 v223, s24, v23
    v_pk_add_f32 v[208:209], v[208:209], v[216:217]
    v_pk_add_f32 v[210:211], v[210:211], v[218:219]
    v_pk_add_f32 v[212:213], v[212:213], v[220:221]
    v_pk_add_f32 v[214:215], v[214:215], v[222:223]
    s_waitcnt vmcnt(13)
    v_lshlrev_b32 v216, 16, v24
    v_and_b32 v217, s24, v24
    v_lshlrev_b32 v218, 16, v25
    v_and_b32 v219, s24, v25
    v_lshlrev_b32 v220, 16, v26
    v_and_b32 v221, s24, v26
    v_lshlrev_b32 v222, 16, v27
    v_and_b32 v223, s24, v27
    v_pk_add_f32 v[208:209], v[208:209], v[216:217]
    v_pk_add_f32 v[210:211], v[210:211], v[218:219]
    v_pk_add_f32 v[212:213], v[212:213], v[220:221]
    v_pk_add_f32 v[214:215], v[214:215], v[222:223]
    s_waitcnt vmcnt(12)
    v_lshlrev_b32 v216, 16, v28
    v_and_b32 v217, s24, v28
    v_lshlrev_b32 v218, 16, v29
    v_and_b32 v219, s24, v29
    v_lshlrev_b32 v220, 16, v30
    v_and_b32 v221, s24, v30
    v_lshlrev_b32 v222, 16, v31
    v_and_b32 v223, s24, v31
    v_pk_add_f32 v[208:209], v[208:209], v[216:217]
    v_pk_add_f32 v[210:211], v[210:211], v[218:219]
    v_pk_add_f32 v[212:213], v[212:213], v[220:221]
    v_pk_add_f32 v[214:215], v[214:215], v[222:223]
    s_waitcnt vmcnt(11)
    v_lshlrev_b32 v216, 16, v32
    v_and_b32 v217, s24, v32
    v_lshlrev_b32 v218, 16, v33
    v_and_b32 v219, s24, v33
    v_lshlrev_b32 v220, 16, v34
    v_and_b32 v221, s24, v34
    v_lshlrev_b32 v222, 16, v35
    v_and_b32 v223, s24, v35
    v_pk_add_f32 v[208:209], v[208:209], v[216:217]
    v_pk_add_f32 v[210:211], v[210:211], v[218:219]
    v_pk_add_f32 v[212:213], v[212:213], v[220:221]
    v_pk_add_f32 v[214:215], v[214:215], v[222:223]
    s_waitcnt vmcnt(10)
    v_lshlrev_b32 v216, 16, v36
    v_and_b32 v217, s24, v36
    v_lshlrev_b32 v218, 16, v37
    v_and_b32 v219, s24, v37
    v_lshlrev_b32 v220, 16, v38
    v_and_b32 v221, s24, v38
    v_lshlrev_b32 v222, 16, v39
    v_and_b32 v223, s24, v39
    v_pk_add_f32 v[208:209], v[208:209], v[216:217]
    v_pk_add_f32 v[210:211], v[210:211], v[218:219]
    v_pk_add_f32 v[212:213], v[212:213], v[220:221]
    v_pk_add_f32 v[214:215], v[214:215], v[222:223]
    s_waitcnt vmcnt(9)
    v_lshlrev_b32 v216, 16, v40
    v_and_b32 v217, s24, v40
    v_lshlrev_b32 v218, 16, v41
    v_and_b32 v219, s24, v41
    v_lshlrev_b32 v220, 16, v42
    v_and_b32 v221, s24, v42
    v_lshlrev_b32 v222, 16, v43
    v_and_b32 v223, s24, v43
    v_pk_add_f32 v[208:209], v[208:209], v[216:217]
    v_pk_add_f32 v[210:211], v[210:211], v[218:219]
    v_pk_add_f32 v[212:213], v[212:213], v[220:221]
    v_pk_add_f32 v[214:215], v[214:215], v[222:223]
    s_waitcnt vmcnt(8)
    v_lshlrev_b32 v216, 16, v44
    v_and_b32 v217, s24, v44
    v_lshlrev_b32 v218, 16, v45
    v_and_b32 v219, s24, v45
    v_lshlrev_b32 v220, 16, v46
    v_and_b32 v221, s24, v46
    v_lshlrev_b32 v222, 16, v47
    v_and_b32 v223, s24, v47
    v_pk_add_f32 v[208:209], v[208:209], v[216:217]
    v_pk_add_f32 v[210:211], v[210:211], v[218:219]
    v_pk_add_f32 v[212:213], v[212:213], v[220:221]
    v_pk_add_f32 v[214:215], v[214:215], v[222:223]
    s_waitcnt vmcnt(7)
    v_lshlrev_b32 v216, 16, v48
    v_and_b32 v217, s24, v48
    v_lshlrev_b32 v218, 16, v49
    v_and_b32 v219, s24, v49
    v_lshlrev_b32 v220, 16, v50
    v_and_b32 v221, s24, v50
    v_lshlrev_b32 v222, 16, v51
    v_and_b32 v223, s24, v51
    v_pk_add_f32 v[208:209], v[208:209], v[216:217]
    v_pk_add_f32 v[210:211], v[210:211], v[218:219]
    v_pk_add_f32 v[212:213], v[212:213], v[220:221]
    v_pk_add_f32 v[214:215], v[214:215], v[222:223]
    s_waitcnt vmcnt(6)
    v_lshlrev_b32 v216, 16, v52
    v_and_b32 v217, s24, v52
    v_lshlrev_b32 v218, 16, v53
    v_and_b32 v219, s24, v53
    v_lshlrev_b32 v220, 16, v54
    v_and_b32 v221, s24, v54
    v_lshlrev_b32 v222, 16, v55
    v_and_b32 v223, s24, v55
    v_pk_add_f32 v[208:209], v[208:209], v[216:217]
    v_pk_add_f32 v[210:211], v[210:211], v[218:219]
    v_pk_add_f32 v[212:213], v[212:213], v[220:221]
    v_pk_add_f32 v[214:215], v[214:215], v[222:223]
    s_waitcnt vmcnt(5)
    v_lshlrev_b32 v216, 16, v56
    v_and_b32 v217, s24, v56
    v_lshlrev_b32 v218, 16, v57
    v_and_b32 v219, s24, v57
    v_lshlrev_b32 v220, 16, v58
    v_and_b32 v221, s24, v58
    v_lshlrev_b32 v222, 16, v59
    v_and_b32 v223, s24, v59
    v_pk_add_f32 v[208:209], v[208:209], v[216:217]
    v_pk_add_f32 v[210:211], v[210:211], v[218:219]
    v_pk_add_f32 v[212:213], v[212:213], v[220:221]
    v_pk_add_f32 v[214:215], v[214:215], v[222:223]
    s_waitcnt vmcnt(4)
    v_lshlrev_b32 v216, 16, v60
    v_and_b32 v217, s24, v60
    v_lshlrev_b32 v218, 16, v61
    v_and_b32 v219, s24, v61
    v_lshlrev_b32 v220, 16, v62
    v_and_b32 v221, s24, v62
    v_lshlrev_b32 v222, 16, v63
    v_and_b32 v223, s24, v63
    v_pk_add_f32 v[208:209], v[208:209], v[216:217]
    v_pk_add_f32 v[210:211], v[210:211], v[218:219]
    v_pk_add_f32 v[212:213], v[212:213], v[220:221]
    v_pk_add_f32 v[214:215], v[214:215], v[222:223]
    s_waitcnt vmcnt(3)
    v_lshlrev_b32 v216, 16, v64
    v_and_b32 v217, s24, v64
    v_lshlrev_b32 v218, 16, v65
    v_and_b32 v219, s24, v65
    v_lshlrev_b32 v220, 16, v66
    v_and_b32 v221, s24, v66
    v_lshlrev_b32 v222, 16, v67
    v_and_b32 v223, s24, v67
    v_pk_add_f32 v[208:209], v[208:209], v[216:217]
    v_pk_add_f32 v[210:211], v[210:211], v[218:219]
    v_pk_add_f32 v[212:213], v[212:213], v[220:221]
    v_pk_add_f32 v[214:215], v[214:215], v[222:223]
    s_waitcnt vmcnt(2)
    v_lshlrev_b32 v216, 16, v68
    v_and_b32 v217, s24, v68
    v_lshlrev_b32 v218, 16, v69
    v_and_b32 v219, s24, v69
    v_lshlrev_b32 v220, 16, v70
    v_and_b32 v221, s24, v70
    v_lshlrev_b32 v222, 16, v71
    v_and_b32 v223, s24, v71
    v_pk_add_f32 v[208:209], v[208:209], v[216:217]
    v_pk_add_f32 v[210:211], v[210:211], v[218:219]
    v_pk_add_f32 v[212:213], v[212:213], v[220:221]
    v_pk_add_f32 v[214:215], v[214:215], v[222:223]
    s_waitcnt vmcnt(1)
    v_lshlrev_b32 v216, 16, v72
    v_and_b32 v217, s24, v72
    v_lshlrev_b32 v218, 16, v73
    v_and_b32 v219, s24, v73
    v_lshlrev_b32 v220, 16, v74
    v_and_b32 v221, s24, v74
    v_lshlrev_b32 v222, 16, v75
    v_and_b32 v223, s24, v75
    v_pk_add_f32 v[208:209], v[208:209], v[216:217]
    v_pk_add_f32 v[210:211], v[210:211], v[218:219]
    v_pk_add_f32 v[212:213], v[212:213], v[220:221]
    v_pk_add_f32 v[214:215], v[214:215], v[222:223]
    s_waitcnt vmcnt(0)
    v_lshlrev_b32 v216, 16, v76
    v_and_b32 v217, s24, v76
    v_lshlrev_b32 v218, 16, v77
    v_and_b32 v219, s24, v77
    v_lshlrev_b32 v220, 16, v78
    v_and_b32 v221, s24, v78
    v_lshlrev_b32 v222, 16, v79
    v_and_b32 v223, s24, v79
    v_pk_add_f32 v[208:209], v[208:209], v[216:217]
    v_pk_add_f32 v[210:211], v[210:211], v[218:219]
    v_pk_add_f32 v[212:213], v[212:213], v[220:221]
    v_pk_add_f32 v[214:215], v[214:215], v[222:223]
    v_cvt_pk_bf16_f32 v216, v208, v209
    v_cvt_pk_bf16_f32 v217, v210, v211
    v_cvt_pk_bf16_f32 v218, v212, v213
    v_cvt_pk_bf16_f32 v219, v214, v215
    v_cndmask_b32 v224, v216, v218, vcc
    v_cndmask_b32 v225, v217, v219, vcc
    v_cndmask_b32 v226, v218, v216, vcc
    v_cndmask_b32 v227, v219, v217, vcc
    s_nop 1
    buffer_store_dwordx4 v[224:227], v9, s[28:31], s36 offen
    s_branch L_piece
L_fin:
L_exit:
    s_endpgm
.section .rodata,"a"
.p2align 6
.amdhsa_kernel concat_heads__gqa_block_cached__mha_block_cached__near_ridge_kernel
  .amdhsa_next_free_vgpr 512
  .amdhsa_next_free_sgpr 102
  .amdhsa_accum_offset 256
  .amdhsa_group_segment_fixed_size 0
  .amdhsa_kernarg_size 104
  .amdhsa_user_sgpr_count 2
  .amdhsa_user_sgpr_kernarg_segment_ptr 1
  .amdhsa_system_sgpr_workgroup_id_x 1
.end_amdhsa_kernel
```
